```python
import torch

def _softmax(x, axis=-1):
    return torch.softmax(x, dim=axis)
def _gelu(x):
    return torch.nn.functional.gelu(x, approximate="tanh")
def _silu(x):
    return torch.nn.functional.silu(x)
def _sigmoid(x):
    return torch.sigmoid(x)
def _layernorm(x, axis=-1, eps=1e-5):
    m = x.mean(dim=axis, keepdim=True)
    v = x.var(dim=axis, keepdim=True, unbiased=False)
    return (x - m) / torch.sqrt(v + eps)
def _scatter_add(tgt, idx, src, axis=0):
    return tgt.clone().index_add_(axis, idx, src)
def _segment_sum(src, seg, n):
    out = torch.zeros((n,) + src.shape[1:], dtype=src.dtype)
    return out.index_add_(0, seg, src)
def _pad(x, pw):
    flat = tuple(v for pair in reversed(pw) for v in pair)
    return torch.nn.functional.pad(x, flat)

kernel_name = 'standalone__mha_block_cached__near_ridge'

def setup_inputs():

    _w = (lambda a: (lambda t: t.to(torch.bfloat16) if t.is_floating_point() else t)(torch.as_tensor(a)))
    B, Sq, D = 8, 160, 640
    H, Sk, Dh = 32, 512, 192
    return {
        "x": _w((lambda *s: torch.randn(*s, dtype=torch.bfloat16) * 0.8)(B, Sq, D)),
        "k_cache": _w((lambda *s: torch.randn(*s, dtype=torch.bfloat16) * 0.8)(B, H, Sk, Dh)),
        "v_cache": _w((lambda *s: torch.randn(*s, dtype=torch.bfloat16) * 0.05)(B, H, Sk, Dh)),
        "wq": _w((lambda *s: torch.randn(*s, dtype=torch.bfloat16) * 0.8)(D, H * Dh) * (D ** -0.5)),
        "wo": _w((lambda *s: torch.randn(*s, dtype=torch.bfloat16) * 0.05)(H * Dh, D) * ((H * Dh) ** -0.5)),
    }

def reference(x, k_cache, v_cache, wq, wo):
    B, Sq, D = x.shape
    H, Dh = 32, 192
    q = (lambda x, *d: x.permute(*d))((x @ wq).reshape(B, Sq, H, Dh), 0, 2, 1, 3)
    scores = torch.einsum("bhqd,bhkd->bhqk", q, k_cache) * (Dh ** -0.5)
    p = _softmax(scores, axis=-1)
    o = torch.einsum("bhqk,bhkd->bhqd", p, v_cache)
    return (lambda x, *d: x.permute(*d))(o, 0, 2, 1, 3).reshape(B, Sq, H * Dh) @ wo
```

```asm
; @launch grid=(256,1,1) block=(256,1,1) lds=163840
.amdgcn_target "amdgcn-amd-amdhsa--gfx950"
.text
.globl standalone__mha_block_cached__near_ridge_kernel
.p2align 8
.type standalone__mha_block_cached__near_ridge_kernel,@function
standalone__mha_block_cached__near_ridge_kernel:
    s_cmp_ge_u32 s2, 256
    s_cbranch_scc1 L_END
    s_load_dwordx16 s[80:95], s[0:1], 0
    v_lshrrev_b32 v1, 6, v0
    v_and_b32 v0, 63, v0
    v_readfirstlane_b32 s28, v1
    s_and_b32 s74, s2, 7
    s_lshr_b32 s3, s2, 3
    s_and_b32 s75, s3, 3
    s_lshl_b32 s31, s74, 2
    s_add_u32 s30, s31, s75
    s_lshr_b32 s29, s3, 2
    s_mul_i32 s48, s75, 3
    s_add_u32 s48, s48, s29
    s_cmp_ge_u32 s48, 10
    s_cselect_b32 s49, 10, 0
    s_sub_u32 s34, s48, s49
    s_lshl_b32 s32, s34, 1
    s_lshl_b32 s35, s34, 7
    s_mul_i32 s33, s32, 393216
    s_mov_b32 s51, 0x3dd53b95
    s_mov_b32 s6, s51
    s_mov_b32 s7, s51
    s_mov_b32 s36, 0
    s_mov_b32 s37, 20480
    s_mov_b32 s38, 40960
    v_and_b32 v2, 15, v0
    v_lshrrev_b32 v3, 4, v0
    v_mov_b32 v16, 0
    v_mov_b32 v17, 0
    v_mov_b32 v18, 0
    v_mov_b32 v19, 0
    v_mov_b32 v20, 0
    v_mov_b32 v21, 0
    v_mov_b32 v24, 0
    v_mov_b32 v25, 0
    v_mov_b32 v26, 0
    v_mov_b32 v27, 0
    s_cmp_eq_u32 s28, 2
    s_cbranch_scc1 L_PRE_X
    s_cmp_eq_u32 s28, 3
    s_cbranch_scc1 L_PRE_K
    s_lshl_b32 s48, s28, 4
    s_mul_i32 s55, s28, 6144
    v_add_u32 v1, 0, v0
    v_mul_u32_u24 v4, 0xaab, v1
    v_lshrrev_b32 v4, 16, v4
    v_mul_u32_u24 v6, 24, v4
    v_sub_u32 v5, v1, v6
    v_add_u32 v4, s48, v4
    v_bfe_u32 v7, v4, 1, 1
    v_bfe_u32 v6, v4, 3, 1
    v_lshl_or_b32 v7, v6, 1, v7
    v_lshrrev_b32 v6, 1, v5
    v_xor_b32 v6, v6, v7
    v_and_b32 v5, 1, v5
    v_lshlrev_b32 v5, 4, v5
    v_lshl_or_b32 v6, v6, 5, v5
    v_mul_u32_u24 v4, 0x3000, v4
    v_add_u32 v16, v4, v6
    v_add_u32 v1, 64, v0
    v_mul_u32_u24 v4, 0xaab, v1
    v_lshrrev_b32 v4, 16, v4
    v_mul_u32_u24 v6, 24, v4
    v_sub_u32 v5, v1, v6
    v_add_u32 v4, s48, v4
    v_bfe_u32 v7, v4, 1, 1
    v_bfe_u32 v6, v4, 3, 1
    v_lshl_or_b32 v7, v6, 1, v7
    v_lshrrev_b32 v6, 1, v5
    v_xor_b32 v6, v6, v7
    v_and_b32 v5, 1, v5
    v_lshlrev_b32 v5, 4, v5
    v_lshl_or_b32 v6, v6, 5, v5
    v_mul_u32_u24 v4, 0x3000, v4
    v_add_u32 v17, v4, v6
    v_subrev_u32 v17, 0x400, v17
    v_add_u32 v1, 0x80, v0
    v_mul_u32_u24 v4, 0xaab, v1
    v_lshrrev_b32 v4, 16, v4
    v_mul_u32_u24 v6, 24, v4
    v_sub_u32 v5, v1, v6
    v_add_u32 v4, s48, v4
    v_bfe_u32 v7, v4, 1, 1
    v_bfe_u32 v6, v4, 3, 1
    v_lshl_or_b32 v7, v6, 1, v7
    v_lshrrev_b32 v6, 1, v5
    v_xor_b32 v6, v6, v7
    v_and_b32 v5, 1, v5
    v_lshlrev_b32 v5, 4, v5
    v_lshl_or_b32 v6, v6, 5, v5
    v_mul_u32_u24 v4, 0x3000, v4
    v_add_u32 v18, v4, v6
    v_subrev_u32 v18, 0x800, v18
    v_add_u32 v1, 0xc0, v0
    v_mul_u32_u24 v4, 0xaab, v1
    v_lshrrev_b32 v4, 16, v4
    v_mul_u32_u24 v6, 24, v4
    v_sub_u32 v5, v1, v6
    v_add_u32 v4, s48, v4
    v_bfe_u32 v7, v4, 1, 1
    v_bfe_u32 v6, v4, 3, 1
    v_lshl_or_b32 v7, v6, 1, v7
    v_lshrrev_b32 v6, 1, v5
    v_xor_b32 v6, v6, v7
    v_and_b32 v5, 1, v5
    v_lshlrev_b32 v5, 4, v5
    v_lshl_or_b32 v6, v6, 5, v5
    v_mul_u32_u24 v4, 0x3000, v4
    v_add_u32 v19, v4, v6
    v_subrev_u32 v19, 0xc00, v19
    v_add_u32 v1, 0x100, v0
    v_mul_u32_u24 v4, 0xaab, v1
    v_lshrrev_b32 v4, 16, v4
    v_mul_u32_u24 v6, 24, v4
    v_sub_u32 v5, v1, v6
    v_add_u32 v4, s48, v4
    v_bfe_u32 v7, v4, 1, 1
    v_bfe_u32 v6, v4, 3, 1
    v_lshl_or_b32 v7, v6, 1, v7
    v_lshrrev_b32 v6, 1, v5
    v_xor_b32 v6, v6, v7
    v_and_b32 v5, 1, v5
    v_lshlrev_b32 v5, 4, v5
    v_lshl_or_b32 v6, v6, 5, v5
    v_mul_u32_u24 v4, 0x3000, v4
    v_add_u32 v20, v4, v6
    v_add_u32 v1, 0x140, v0
    v_mul_u32_u24 v4, 0xaab, v1
    v_lshrrev_b32 v4, 16, v4
    v_mul_u32_u24 v6, 24, v4
    v_sub_u32 v5, v1, v6
    v_add_u32 v4, s48, v4
    v_bfe_u32 v7, v4, 1, 1
    v_bfe_u32 v6, v4, 3, 1
    v_lshl_or_b32 v7, v6, 1, v7
    v_lshrrev_b32 v6, 1, v5
    v_xor_b32 v6, v6, v7
    v_and_b32 v5, 1, v5
    v_lshlrev_b32 v5, 4, v5
    v_lshl_or_b32 v6, v6, 5, v5
    v_mul_u32_u24 v4, 0x3000, v4
    v_add_u32 v21, v4, v6
    v_subrev_u32 v21, 0x400, v21
    s_waitcnt lgkmcnt(0)
    s_mul_i32 s48, s30, 384
    s_sub_u32 s49, 7864320, s48
    s_add_u32 s12, s86, s48
    s_addc_u32 s13, s87, 0
    s_mov_b32 s14, s49
    s_mov_b32 s15, 0x20000
    s_add_u32 m0, s55, 110592
    s_nop 0
    buffer_load_dwordx4 v16, s[12:15], s33 offen lds
    buffer_load_dwordx4 v17, s[12:15], s33 offen offset:1024 lds
    buffer_load_dwordx4 v18, s[12:15], s33 offen offset:2048 lds
    buffer_load_dwordx4 v19, s[12:15], s33 offen offset:3072 lds
    s_add_u32 m0, s55, 114688
    s_nop 0
    buffer_load_dwordx4 v20, s[12:15], s33 offen lds
    buffer_load_dwordx4 v21, s[12:15], s33 offen offset:1024 lds
    s_add_u32 s32, s32, 1
    s_cmp_eq_u32 s32, 20
    s_cselect_b32 s32, 0, s32
    s_mul_i32 s33, s32, 393216
    s_add_u32 m0, s55, 122880
    s_nop 0
    buffer_load_dwordx4 v16, s[12:15], s33 offen lds
    buffer_load_dwordx4 v17, s[12:15], s33 offen offset:1024 lds
    buffer_load_dwordx4 v18, s[12:15], s33 offen offset:2048 lds
    buffer_load_dwordx4 v19, s[12:15], s33 offen offset:3072 lds
    s_add_u32 m0, s55, 126976
    s_nop 0
    buffer_load_dwordx4 v20, s[12:15], s33 offen lds
    buffer_load_dwordx4 v21, s[12:15], s33 offen offset:1024 lds
    s_add_u32 s32, s32, 1
    s_cmp_eq_u32 s32, 20
    s_cselect_b32 s32, 0, s32
    s_mul_i32 s33, s32, 393216
    s_mul_i32 s48, s29, 204800
    s_add_u32 s8, s80, s48
    s_addc_u32 s9, s81, 0
    s_mov_b32 s10, 204800
    s_mov_b32 s11, 0x20000
    s_branch L_COMMON1
L_PRE_X:
    v_lshrrev_b32 v4, 3, v0
    v_and_b32 v5, 7, v0
    v_lshrrev_b32 v6, 4, v0
    v_xor_b32 v5, v5, v6
    v_lshlrev_b32 v5, 4, v5
    v_mul_u32_u24 v4, 0x500, v4
    v_add_u32 v16, v4, v5
    v_lshrrev_b32 v4, 3, v0
    v_and_b32 v5, 7, v0
    v_lshrrev_b32 v6, 4, v0
    v_add_u32 v6, 4, v6
    v_xor_b32 v5, v5, v6
    v_lshlrev_b32 v5, 4, v5
    v_mul_u32_u24 v4, 0x500, v4
    v_add_u32 v17, v4, v5
    v_add_u32 v27, 0x16400, v17
    v_add_u32 v26, 0x14000, v16
    v_add_u32 v25, 0x10c00, v17
    v_add_u32 v24, 0xe800, v16
    v_add_u32 v21, 0xc400, v17
    v_add_u32 v20, 0xa000, v16
    v_add_u32 v19, 0x6c00, v17
    v_add_u32 v18, 0x4800, v16
    v_add_u32 v17, 0x2400, v17
    s_waitcnt lgkmcnt(0)
    s_mul_i32 s48, s29, 204800
    s_add_u32 s8, s80, s48
    s_addc_u32 s9, s81, 0
    s_mov_b32 s10, 204800
    s_mov_b32 s11, 0x20000
    s_add_u32 m0, s36, 49152
    s_nop 0
    buffer_load_dwordx4 v16, s[8:11], s35 offen lds
    buffer_load_dwordx4 v17, s[8:11], s35 offen offset:1024 lds
    buffer_load_dwordx4 v18, s[8:11], s35 offen offset:2048 lds
    buffer_load_dwordx4 v19, s[8:11], s35 offen offset:3072 lds
    s_add_u32 m0, s36, 53248
    s_nop 0
    buffer_load_dwordx4 v20, s[8:11], s35 offen lds
    buffer_load_dwordx4 v21, s[8:11], s35 offen offset:1024 lds
    buffer_load_dwordx4 v24, s[8:11], s35 offen offset:2048 lds
    buffer_load_dwordx4 v25, s[8:11], s35 offen offset:3072 lds
    s_add_u32 m0, s36, 57344
    s_nop 0
    buffer_load_dwordx4 v26, s[8:11], s35 offen lds
    buffer_load_dwordx4 v27, s[8:11], s35 offen offset:1024 lds
    s_add_u32 s48, s35, 102400
    s_add_u32 m0, s36, 59392
    s_nop 0
    buffer_load_dwordx4 v16, s[8:11], s48 offen lds
    buffer_load_dwordx4 v17, s[8:11], s48 offen offset:1024 lds
    buffer_load_dwordx4 v18, s[8:11], s48 offen offset:2048 lds
    buffer_load_dwordx4 v19, s[8:11], s48 offen offset:3072 lds
    s_add_u32 m0, s36, 63488
    s_nop 0
    buffer_load_dwordx4 v20, s[8:11], s48 offen lds
    buffer_load_dwordx4 v21, s[8:11], s48 offen offset:1024 lds
    buffer_load_dwordx4 v24, s[8:11], s48 offen offset:2048 lds
    buffer_load_dwordx4 v25, s[8:11], s48 offen offset:3072 lds
    s_add_u32 m0, s36, 67584
    s_nop 0
    buffer_load_dwordx4 v26, s[8:11], s48 offen lds
    buffer_load_dwordx4 v27, s[8:11], s48 offen offset:1024 lds
    s_add_u32 s34, s34, 1
    s_cmp_eq_u32 s34, 10
    s_cselect_b32 s34, 0, s34
    s_lshl_b32 s35, s34, 7
    s_add_u32 s34, s34, 1
    s_cmp_eq_u32 s34, 10
    s_cselect_b32 s34, 0, s34
    s_lshl_b32 s35, s34, 7
    s_mul_i32 s48, s30, 384
    s_sub_u32 s49, 7864320, s48
    s_add_u32 s12, s86, s48
    s_addc_u32 s13, s87, 0
    s_mov_b32 s14, s49
    s_mov_b32 s15, 0x20000
    s_branch L_COMMON1
L_PRE_K:
    v_lshrrev_b32 v4, 3, v0
    v_and_b32 v5, 7, v0
    v_lshrrev_b32 v6, 4, v0
    v_xor_b32 v5, v5, v6
    v_lshlrev_b32 v5, 4, v5
    v_mul_u32_u24 v4, 0x500, v4
    v_add_u32 v16, v4, v5
    v_lshrrev_b32 v4, 3, v0
    v_and_b32 v5, 7, v0
    v_lshrrev_b32 v6, 4, v0
    v_add_u32 v6, 4, v6
    v_xor_b32 v5, v5, v6
    v_lshlrev_b32 v5, 4, v5
    v_mul_u32_u24 v4, 0x500, v4
    v_add_u32 v17, v4, v5
    v_add_u32 v27, 0x16400, v17
    v_add_u32 v26, 0x14000, v16
    v_add_u32 v25, 0x10c00, v17
    v_add_u32 v24, 0xe800, v16
    v_add_u32 v21, 0xc400, v17
    v_add_u32 v20, 0xa000, v16
    v_add_u32 v19, 0x6c00, v17
    v_add_u32 v18, 0x4800, v16
    v_add_u32 v17, 0x2400, v17
    s_waitcnt lgkmcnt(0)
    s_mul_i32 s48, s29, 204800
    s_add_u32 s8, s80, s48
    s_addc_u32 s9, s81, 0
    s_mov_b32 s10, 204800
    s_mov_b32 s11, 0x20000
    s_add_u32 s34, s34, 1
    s_cmp_eq_u32 s34, 10
    s_cselect_b32 s34, 0, s34
    s_lshl_b32 s35, s34, 7
    s_add_u32 m0, s37, 49152
    s_nop 0
    buffer_load_dwordx4 v16, s[8:11], s35 offen lds
    buffer_load_dwordx4 v17, s[8:11], s35 offen offset:1024 lds
    buffer_load_dwordx4 v18, s[8:11], s35 offen offset:2048 lds
    buffer_load_dwordx4 v19, s[8:11], s35 offen offset:3072 lds
    s_add_u32 m0, s37, 53248
    s_nop 0
    buffer_load_dwordx4 v20, s[8:11], s35 offen lds
    buffer_load_dwordx4 v21, s[8:11], s35 offen offset:1024 lds
    buffer_load_dwordx4 v24, s[8:11], s35 offen offset:2048 lds
    buffer_load_dwordx4 v25, s[8:11], s35 offen offset:3072 lds
    s_add_u32 m0, s37, 57344
    s_nop 0
    buffer_load_dwordx4 v26, s[8:11], s35 offen lds
    buffer_load_dwordx4 v27, s[8:11], s35 offen offset:1024 lds
    s_add_u32 s48, s35, 102400
    s_add_u32 m0, s37, 59392
    s_nop 0
    buffer_load_dwordx4 v16, s[8:11], s48 offen lds
    buffer_load_dwordx4 v17, s[8:11], s48 offen offset:1024 lds
    buffer_load_dwordx4 v18, s[8:11], s48 offen offset:2048 lds
    buffer_load_dwordx4 v19, s[8:11], s48 offen offset:3072 lds
    s_add_u32 m0, s37, 63488
    s_nop 0
    buffer_load_dwordx4 v20, s[8:11], s48 offen lds
    buffer_load_dwordx4 v21, s[8:11], s48 offen offset:1024 lds
    buffer_load_dwordx4 v24, s[8:11], s48 offen offset:2048 lds
    buffer_load_dwordx4 v25, s[8:11], s48 offen offset:3072 lds
    s_add_u32 m0, s37, 67584
    s_nop 0
    buffer_load_dwordx4 v26, s[8:11], s48 offen lds
    buffer_load_dwordx4 v27, s[8:11], s48 offen offset:1024 lds
    s_add_u32 s34, s34, 1
    s_cmp_eq_u32 s34, 10
    s_cselect_b32 s34, 0, s34
    s_lshl_b32 s35, s34, 7
    s_mul_i32 s48, s30, 384
    s_sub_u32 s49, 7864320, s48
    s_add_u32 s12, s86, s48
    s_addc_u32 s13, s87, 0
    s_mov_b32 s14, s49
    s_mov_b32 s15, 0x20000
L_COMMON1:
    s_lshl_b32 s48, s29, 5
    s_add_u32 s48, s48, s30
    s_mul_i32 s59, s48, 61440
    s_mul_i32 s48, s48, 196608
    s_add_u32 s16, s82, s48
    s_addc_u32 s17, s83, 0
    s_mov_b32 s18, 196608
    s_mov_b32 s19, 0x20000
    s_add_u32 s20, s84, s48
    s_addc_u32 s21, s85, 0
    s_mov_b32 s22, 196608
    s_mov_b32 s23, 0x20000
    s_mov_b32 s24, s94
    s_mov_b32 s25, s95
    s_mov_b32 s26, 268435456
    s_mov_b32 s27, 0x20000
    s_mov_b32 s60, s92
    s_mov_b32 s61, s93
    s_mov_b32 s62, 256
    s_mov_b32 s63, 0x20000
    s_mov_b32 s44, s90
    s_mov_b32 s45, s91
    s_mov_b32 s46, 1638400
    s_mov_b32 s47, 0x20000
    s_mul_i32 s48, s75, 320
    s_sub_u32 s49, 7864320, s48
    s_add_u32 s40, s88, s48
    s_addc_u32 s41, s89, 0
    s_mov_b32 s42, s49
    s_mov_b32 s43, 0x20000
    s_lshl_b32 s48, s29, 3
    s_add_u32 s48, s48, s74
    s_lshl_b32 s48, s48, 7
    s_add_u32 s76, s48, 50331648
    s_lshl_b32 s48, s29, 2
    s_add_u32 s48, s48, s75
    s_lshl_b32 s48, s48, 9
    s_add_u32 s77, s48, 50348032
    s_add_u32 s48, s75, 0
    s_and_b32 s48, s48, 3
    s_lshl_b32 s49, s74, 2
    s_add_u32 s48, s48, s49
    s_mul_i32 s66, s48, 245760
    s_lshl_b32 s49, s29, 5
    s_add_u32 s48, s48, s49
    s_mul_i32 s70, s48, 61440
    s_add_u32 s48, s75, 1
    s_and_b32 s48, s48, 3
    s_lshl_b32 s49, s74, 2
    s_add_u32 s48, s48, s49
    s_mul_i32 s67, s48, 245760
    s_lshl_b32 s49, s29, 5
    s_add_u32 s48, s48, s49
    s_mul_i32 s71, s48, 61440
    s_add_u32 s48, s75, 2
    s_and_b32 s48, s48, 3
    s_lshl_b32 s49, s74, 2
    s_add_u32 s48, s48, s49
    s_mul_i32 s68, s48, 245760
    s_lshl_b32 s49, s29, 5
    s_add_u32 s48, s48, s49
    s_mul_i32 s72, s48, 61440
    s_add_u32 s48, s75, 3
    s_and_b32 s48, s48, 3
    s_lshl_b32 s49, s74, 2
    s_add_u32 s48, s48, s49
    s_mul_i32 s69, s48, 245760
    s_lshl_b32 s49, s29, 5
    s_add_u32 s48, s48, s49
    s_mul_i32 s73, s48, 61440
    s_mul_i32 s78, s28, 5120
    s_and_b32 s96, s28, 1
    s_lshr_b32 s97, s28, 1
    v_lshrrev_b32 v1, 2, v2
    v_and_b32 v4, 3, v2
    v_lshl_add_u32 v5, v3, 3, v1
    v_mul_u32_u24 v5, 0x180, v5
    v_lshl_add_u32 v5, v4, 3, v5
    v_add_u32 v5, 0x1b000, v5
    v_bfe_u32 v7, v2, 3, 1
    v_and_b32 v6, 1, v3
    v_lshl_or_b32 v7, v6, 1, v7
    s_mul_i32 s50, s97, 6
    s_add_u32 s31, s50, 0
    v_xor_b32 v6, s31, v7
    v_lshl_add_u32 v8, v6, 5, v5
    s_add_u32 s31, s50, 1
    v_xor_b32 v6, s31, v7
    v_lshl_add_u32 v9, v6, 5, v5
    s_add_u32 s31, s50, 2
    v_xor_b32 v6, s31, v7
    v_lshl_add_u32 v10, v6, 5, v5
    s_add_u32 s31, s50, 3
    v_xor_b32 v6, s31, v7
    v_lshl_add_u32 v11, v6, 5, v5
    s_add_u32 s31, s50, 4
    v_xor_b32 v6, s31, v7
    v_lshl_add_u32 v12, v6, 5, v5
    s_add_u32 s31, s50, 5
    v_xor_b32 v6, s31, v7
    v_lshl_add_u32 v13, v6, 5, v5
    s_mul_i32 s31, s96, 10240
    s_add_u32 s31, s31, 49152
    v_lshlrev_b32 v1, 7, v2
    v_add_u32 v1, s31, v1
    v_bfe_u32 v7, v2, 1, 3
    v_xor_b32 v4, v3, v7
    v_lshl_add_u32 v14, v4, 4, v1
    v_xor_b32 v15, 64, v14
    s_cmp_eq_u32 s28, 3
    s_cbranch_scc1 L_PRE2_K
    s_cmp_eq_u32 s28, 2
    s_cbranch_scc1 L_PRE2_X
    s_add_u32 m0, s55, 135168
    s_nop 0
    buffer_load_dwordx4 v16, s[12:15], s33 offen lds
    buffer_load_dwordx4 v17, s[12:15], s33 offen offset:1024 lds
    buffer_load_dwordx4 v18, s[12:15], s33 offen offset:2048 lds
    buffer_load_dwordx4 v19, s[12:15], s33 offen offset:3072 lds
    s_add_u32 m0, s55, 139264
    s_nop 0
    buffer_load_dwordx4 v20, s[12:15], s33 offen lds
    buffer_load_dwordx4 v21, s[12:15], s33 offen offset:1024 lds
    s_add_u32 s32, s32, 1
    s_cmp_eq_u32 s32, 20
    s_cselect_b32 s32, 0, s32
    s_mul_i32 s33, s32, 393216
    s_add_u32 m0, s55, 147456
    s_nop 0
    buffer_load_dwordx4 v16, s[12:15], s33 offen lds
    buffer_load_dwordx4 v17, s[12:15], s33 offen offset:1024 lds
    buffer_load_dwordx4 v18, s[12:15], s33 offen offset:2048 lds
    buffer_load_dwordx4 v19, s[12:15], s33 offen offset:3072 lds
    s_add_u32 m0, s55, 151552
    s_nop 0
    buffer_load_dwordx4 v20, s[12:15], s33 offen lds
    buffer_load_dwordx4 v21, s[12:15], s33 offen offset:1024 lds
    s_add_u32 s32, s32, 1
    s_cmp_eq_u32 s32, 20
    s_cselect_b32 s32, 0, s32
    s_mul_i32 s33, s32, 393216
    v_mov_b32 v48, 0
    v_mov_b32 v49, 0
    v_mov_b32 v50, 0
    v_mov_b32 v51, 0
    v_mov_b32 v52, 0
    v_mov_b32 v53, 0
    v_mov_b32 v54, 0
    v_mov_b32 v55, 0
    v_mov_b32 v56, 0
    v_mov_b32 v57, 0
    v_mov_b32 v58, 0
    v_mov_b32 v59, 0
    v_mov_b32 v60, 0
    v_mov_b32 v61, 0
    v_mov_b32 v62, 0
    v_mov_b32 v63, 0
    v_mov_b32 v64, 0
    v_mov_b32 v65, 0
    v_mov_b32 v66, 0
    v_mov_b32 v67, 0
    v_mov_b32 v68, 0
    v_mov_b32 v69, 0
    v_mov_b32 v70, 0
    v_mov_b32 v71, 0
    v_mov_b32 v72, 0
    v_mov_b32 v73, 0
    v_mov_b32 v74, 0
    v_mov_b32 v75, 0
    v_mov_b32 v76, 0
    v_mov_b32 v77, 0
    v_mov_b32 v78, 0
    v_mov_b32 v79, 0
    v_mov_b32 v80, 0
    v_mov_b32 v81, 0
    v_mov_b32 v82, 0
    v_mov_b32 v83, 0
    v_mov_b32 v84, 0
    v_mov_b32 v85, 0
    v_mov_b32 v86, 0
    v_mov_b32 v87, 0
    v_mov_b32 v88, 0
    v_mov_b32 v89, 0
    v_mov_b32 v90, 0
    v_mov_b32 v91, 0
    v_mov_b32 v92, 0
    v_mov_b32 v93, 0
    v_mov_b32 v94, 0
    v_mov_b32 v95, 0
    v_mov_b32 v96, 0
    v_mov_b32 v97, 0
    v_mov_b32 v98, 0
    v_mov_b32 v99, 0
    v_mov_b32 v100, 0
    v_mov_b32 v101, 0
    v_mov_b32 v102, 0
    v_mov_b32 v103, 0
    v_mov_b32 v104, 0
    v_mov_b32 v105, 0
    v_mov_b32 v106, 0
    v_mov_b32 v107, 0
    v_mov_b32 v108, 0
    v_mov_b32 v109, 0
    v_mov_b32 v110, 0
    v_mov_b32 v111, 0
    v_mov_b32 v112, 0
    v_mov_b32 v113, 0
    v_mov_b32 v114, 0
    v_mov_b32 v115, 0
    v_mov_b32 v116, 0
    v_mov_b32 v117, 0
    v_mov_b32 v118, 0
    v_mov_b32 v119, 0
    v_mov_b32 v120, 0
    v_mov_b32 v121, 0
    v_mov_b32 v122, 0
    v_mov_b32 v123, 0
    v_mov_b32 v124, 0
    v_mov_b32 v125, 0
    v_mov_b32 v126, 0
    v_mov_b32 v127, 0
    v_mov_b32 v128, 0
    v_mov_b32 v129, 0
    v_mov_b32 v130, 0
    v_mov_b32 v131, 0
    v_mov_b32 v132, 0
    v_mov_b32 v133, 0
    v_mov_b32 v134, 0
    v_mov_b32 v135, 0
    v_mov_b32 v136, 0
    v_mov_b32 v137, 0
    v_mov_b32 v138, 0
    v_mov_b32 v139, 0
    v_mov_b32 v140, 0
    v_mov_b32 v141, 0
    v_mov_b32 v142, 0
    v_mov_b32 v143, 0
    v_mov_b32 v144, 0
    v_mov_b32 v145, 0
    v_mov_b32 v146, 0
    v_mov_b32 v147, 0
    v_mov_b32 v148, 0
    v_mov_b32 v149, 0
    v_mov_b32 v150, 0
    v_mov_b32 v151, 0
    v_mov_b32 v152, 0
    v_mov_b32 v153, 0
    v_mov_b32 v154, 0
    v_mov_b32 v155, 0
    v_mov_b32 v156, 0
    v_mov_b32 v157, 0
    v_mov_b32 v158, 0
    v_mov_b32 v159, 0
    v_mov_b32 v160, 0
    v_mov_b32 v161, 0
    v_mov_b32 v162, 0
    v_mov_b32 v163, 0
    v_mov_b32 v164, 0
    v_mov_b32 v165, 0
    v_mov_b32 v166, 0
    v_mov_b32 v167, 0
    s_waitcnt vmcnt(18)
    s_branch L_P
L_PRE2_X:
    v_mov_b32 v48, 0
    v_mov_b32 v49, 0
    v_mov_b32 v50, 0
    v_mov_b32 v51, 0
    v_mov_b32 v52, 0
    v_mov_b32 v53, 0
    v_mov_b32 v54, 0
    v_mov_b32 v55, 0
    v_mov_b32 v56, 0
    v_mov_b32 v57, 0
    v_mov_b32 v58, 0
    v_mov_b32 v59, 0
    v_mov_b32 v60, 0
    v_mov_b32 v61, 0
    v_mov_b32 v62, 0
    v_mov_b32 v63, 0
    v_mov_b32 v64, 0
    v_mov_b32 v65, 0
    v_mov_b32 v66, 0
    v_mov_b32 v67, 0
    v_mov_b32 v68, 0
    v_mov_b32 v69, 0
    v_mov_b32 v70, 0
    v_mov_b32 v71, 0
    v_mov_b32 v72, 0
    v_mov_b32 v73, 0
    v_mov_b32 v74, 0
    v_mov_b32 v75, 0
    v_mov_b32 v76, 0
    v_mov_b32 v77, 0
    v_mov_b32 v78, 0
    v_mov_b32 v79, 0
    v_mov_b32 v80, 0
    v_mov_b32 v81, 0
    v_mov_b32 v82, 0
    v_mov_b32 v83, 0
    v_mov_b32 v84, 0
    v_mov_b32 v85, 0
    v_mov_b32 v86, 0
    v_mov_b32 v87, 0
    v_mov_b32 v88, 0
    v_mov_b32 v89, 0
    v_mov_b32 v90, 0
    v_mov_b32 v91, 0
    v_mov_b32 v92, 0
    v_mov_b32 v93, 0
    v_mov_b32 v94, 0
    v_mov_b32 v95, 0
    v_mov_b32 v96, 0
    v_mov_b32 v97, 0
    v_mov_b32 v98, 0
    v_mov_b32 v99, 0
    v_mov_b32 v100, 0
    v_mov_b32 v101, 0
    v_mov_b32 v102, 0
    v_mov_b32 v103, 0
    v_mov_b32 v104, 0
    v_mov_b32 v105, 0
    v_mov_b32 v106, 0
    v_mov_b32 v107, 0
    v_mov_b32 v108, 0
    v_mov_b32 v109, 0
    v_mov_b32 v110, 0
    v_mov_b32 v111, 0
    v_mov_b32 v112, 0
    v_mov_b32 v113, 0
    v_mov_b32 v114, 0
    v_mov_b32 v115, 0
    v_mov_b32 v116, 0
    v_mov_b32 v117, 0
    v_mov_b32 v118, 0
    v_mov_b32 v119, 0
    v_mov_b32 v120, 0
    v_mov_b32 v121, 0
    v_mov_b32 v122, 0
    v_mov_b32 v123, 0
    v_mov_b32 v124, 0
    v_mov_b32 v125, 0
    v_mov_b32 v126, 0
    v_mov_b32 v127, 0
    v_mov_b32 v128, 0
    v_mov_b32 v129, 0
    v_mov_b32 v130, 0
    v_mov_b32 v131, 0
    v_mov_b32 v132, 0
    v_mov_b32 v133, 0
    v_mov_b32 v134, 0
    v_mov_b32 v135, 0
    v_mov_b32 v136, 0
    v_mov_b32 v137, 0
    v_mov_b32 v138, 0
    v_mov_b32 v139, 0
    v_mov_b32 v140, 0
    v_mov_b32 v141, 0
    v_mov_b32 v142, 0
    v_mov_b32 v143, 0
    v_mov_b32 v144, 0
    v_mov_b32 v145, 0
    v_mov_b32 v146, 0
    v_mov_b32 v147, 0
    v_mov_b32 v148, 0
    v_mov_b32 v149, 0
    v_mov_b32 v150, 0
    v_mov_b32 v151, 0
    v_mov_b32 v152, 0
    v_mov_b32 v153, 0
    v_mov_b32 v154, 0
    v_mov_b32 v155, 0
    v_mov_b32 v156, 0
    v_mov_b32 v157, 0
    v_mov_b32 v158, 0
    v_mov_b32 v159, 0
    v_mov_b32 v160, 0
    v_mov_b32 v161, 0
    v_mov_b32 v162, 0
    v_mov_b32 v163, 0
    v_mov_b32 v164, 0
    v_mov_b32 v165, 0
    v_mov_b32 v166, 0
    v_mov_b32 v167, 0
    s_waitcnt vmcnt(0)
    s_branch L_P
L_PRE2_K:
    v_mov_b32 v1, 0
    s_lshl_b32 s48, s75, 2
    s_add_u32 s48, s48, s76
    v_and_b32 v5, 1, v0
    v_lshlrev_b32 v5, 4, v5
    buffer_store_dword v1, v5, s[24:27], s48 offen sc1
    s_lshl_b32 s49, s74, 2
    s_add_u32 s49, s49, s77
    v_and_b32 v4, 3, v0
    v_lshlrev_b32 v4, 7, v4
    buffer_store_dword v1, v4, s[24:27], s49 offen sc1
    buffer_load_dword a200, v1, s[16:19], 0 offen
    buffer_load_dword a201, v1, s[20:23], 0 offen
    s_mov_b32 s48, 98304
    buffer_load_dword a202, v1, s[20:23], s48 offen
    s_getpc_b64 s[4:5]
L_PC:
    s_lshr_b32 s3, s2, 3
    s_and_b32 s3, s3, 31
    s_lshl_b32 s3, s3, 11
    s_min_u32 s3, s3, L_CODE_END-L_PC-2048
    v_lshlrev_b32 v4, 4, v0
    v_add_u32 v4, s3, v4
    global_load_dwordx4 a[204:207], v4, s[4:5]
    global_load_dwordx4 a[208:211], v4, s[4:5] offset:1024
    v_add_u32 v1, 0, v0
    v_mul_u32_u24 v4, 0xaab, v1
    v_lshrrev_b32 v4, 16, v4
    v_mul_u32_u24 v6, 24, v4
    v_sub_u32 v5, v1, v6
    v_lshrrev_b32 v7, 1, v4
    v_xor_b32 v5, v5, v7
    v_lshlrev_b32 v5, 4, v5
    v_mul_u32_u24 v4, 0x180, v4
    v_add_u32 v16, v4, v5
    v_add_u32 v1, 64, v0
    v_mul_u32_u24 v4, 0xaab, v1
    v_lshrrev_b32 v4, 16, v4
    v_mul_u32_u24 v6, 24, v4
    v_sub_u32 v5, v1, v6
    v_lshrrev_b32 v7, 1, v4
    v_xor_b32 v5, v5, v7
    v_lshlrev_b32 v5, 4, v5
    v_mul_u32_u24 v4, 0x180, v4
    v_add_u32 v17, v4, v5
    v_subrev_u32 v17, 0x400, v17
    v_add_u32 v1, 0x80, v0
    v_mul_u32_u24 v4, 0xaab, v1
    v_lshrrev_b32 v4, 16, v4
    v_mul_u32_u24 v6, 24, v4
    v_sub_u32 v5, v1, v6
    v_lshrrev_b32 v7, 1, v4
    v_xor_b32 v5, v5, v7
    v_lshlrev_b32 v5, 4, v5
    v_mul_u32_u24 v4, 0x180, v4
    v_add_u32 v18, v4, v5
    v_subrev_u32 v18, 0x800, v18
    v_add_u32 v1, 0, v0
    v_mul_u32_u24 v4, 0xaab, v1
    v_lshrrev_b32 v4, 16, v4
    v_mul_u32_u24 v6, 24, v4
    v_sub_u32 v5, v1, v6
    v_lshrrev_b32 v7, 1, v4
    v_add_u32 v7, 4, v7
    v_xor_b32 v5, v5, v7
    v_lshlrev_b32 v5, 4, v5
    v_mul_u32_u24 v4, 0x180, v4
    v_add_u32 v19, v4, v5
    v_add_u32 v1, 64, v0
    v_mul_u32_u24 v4, 0xaab, v1
    v_lshrrev_b32 v4, 16, v4
    v_mul_u32_u24 v6, 24, v4
    v_sub_u32 v5, v1, v6
    v_lshrrev_b32 v7, 1, v4
    v_add_u32 v7, 4, v7
    v_xor_b32 v5, v5, v7
    v_lshlrev_b32 v5, 4, v5
    v_mul_u32_u24 v4, 0x180, v4
    v_add_u32 v20, v4, v5
    v_subrev_u32 v20, 0x400, v20
    v_add_u32 v1, 0x80, v0
    v_mul_u32_u24 v4, 0xaab, v1
    v_lshrrev_b32 v4, 16, v4
    v_mul_u32_u24 v6, 24, v4
    v_sub_u32 v5, v1, v6
    v_lshrrev_b32 v7, 1, v4
    v_add_u32 v7, 4, v7
    v_xor_b32 v5, v5, v7
    v_lshlrev_b32 v5, 4, v5
    v_mul_u32_u24 v4, 0x180, v4
    v_add_u32 v21, v4, v5
    v_subrev_u32 v21, 0x800, v21
    s_mov_b32 s57, 0
    s_mov_b32 s58, 0
    v_mov_b32 v48, 0
    v_mov_b32 v49, 0
    v_mov_b32 v50, 0
    v_mov_b32 v51, 0
    v_mov_b32 v52, 0
    v_mov_b32 v53, 0
    v_mov_b32 v54, 0
    v_mov_b32 v55, 0
    v_mov_b32 v56, 0
    v_mov_b32 v57, 0
    v_mov_b32 v58, 0
    v_mov_b32 v59, 0
    v_mov_b32 v60, 0
    v_mov_b32 v61, 0
    v_mov_b32 v62, 0
    v_mov_b32 v63, 0
    v_mov_b32 v64, 0
    v_mov_b32 v65, 0
    v_mov_b32 v66, 0
    v_mov_b32 v67, 0
    v_mov_b32 v68, 0
    v_mov_b32 v69, 0
    v_mov_b32 v70, 0
    v_mov_b32 v71, 0
    v_mov_b32 v72, 0
    v_mov_b32 v73, 0
    v_mov_b32 v74, 0
    v_mov_b32 v75, 0
    v_mov_b32 v76, 0
    v_mov_b32 v77, 0
    v_mov_b32 v78, 0
    v_mov_b32 v79, 0
    v_mov_b32 v80, 0
    v_mov_b32 v81, 0
    v_mov_b32 v82, 0
    v_mov_b32 v83, 0
    v_mov_b32 v84, 0
    v_mov_b32 v85, 0
    v_mov_b32 v86, 0
    v_mov_b32 v87, 0
    v_mov_b32 v88, 0
    v_mov_b32 v89, 0
    v_mov_b32 v90, 0
    v_mov_b32 v91, 0
    v_mov_b32 v92, 0
    v_mov_b32 v93, 0
    v_mov_b32 v94, 0
    v_mov_b32 v95, 0
    v_mov_b32 v96, 0
    v_mov_b32 v97, 0
    v_mov_b32 v98, 0
    v_mov_b32 v99, 0
    v_mov_b32 v100, 0
    v_mov_b32 v101, 0
    v_mov_b32 v102, 0
    v_mov_b32 v103, 0
    v_mov_b32 v104, 0
    v_mov_b32 v105, 0
    v_mov_b32 v106, 0
    v_mov_b32 v107, 0
    v_mov_b32 v108, 0
    v_mov_b32 v109, 0
    v_mov_b32 v110, 0
    v_mov_b32 v111, 0
    v_mov_b32 v112, 0
    v_mov_b32 v113, 0
    v_mov_b32 v114, 0
    v_mov_b32 v115, 0
    v_mov_b32 v116, 0
    v_mov_b32 v117, 0
    v_mov_b32 v118, 0
    v_mov_b32 v119, 0
    v_mov_b32 v120, 0
    v_mov_b32 v121, 0
    v_mov_b32 v122, 0
    v_mov_b32 v123, 0
    v_mov_b32 v124, 0
    v_mov_b32 v125, 0
    v_mov_b32 v126, 0
    v_mov_b32 v127, 0
    v_mov_b32 v128, 0
    v_mov_b32 v129, 0
    v_mov_b32 v130, 0
    v_mov_b32 v131, 0
    v_mov_b32 v132, 0
    v_mov_b32 v133, 0
    v_mov_b32 v134, 0
    v_mov_b32 v135, 0
    v_mov_b32 v136, 0
    v_mov_b32 v137, 0
    v_mov_b32 v138, 0
    v_mov_b32 v139, 0
    v_mov_b32 v140, 0
    v_mov_b32 v141, 0
    v_mov_b32 v142, 0
    v_mov_b32 v143, 0
    v_mov_b32 v144, 0
    v_mov_b32 v145, 0
    v_mov_b32 v146, 0
    v_mov_b32 v147, 0
    v_mov_b32 v148, 0
    v_mov_b32 v149, 0
    v_mov_b32 v150, 0
    v_mov_b32 v151, 0
    v_mov_b32 v152, 0
    v_mov_b32 v153, 0
    v_mov_b32 v154, 0
    v_mov_b32 v155, 0
    v_mov_b32 v156, 0
    v_mov_b32 v157, 0
    v_mov_b32 v158, 0
    v_mov_b32 v159, 0
    v_mov_b32 v160, 0
    v_mov_b32 v161, 0
    v_mov_b32 v162, 0
    v_mov_b32 v163, 0
    v_mov_b32 v164, 0
    v_mov_b32 v165, 0
    v_mov_b32 v166, 0
    v_mov_b32 v167, 0
    s_waitcnt vmcnt(7)
L_P:
    s_barrier
    v_add_u32 v44, s36, v14
    ds_read_b128 v[216:219], v44
    ds_read_b64_tr_b16 v[168:169], v8
    ds_read_b64_tr_b16 v[170:171], v8 offset:1536
    ds_read_b128 v[220:223], v44 offset:2048
    ds_read_b128 v[224:227], v44 offset:4096
    ds_read_b64_tr_b16 v[172:173], v9
    ds_read_b64_tr_b16 v[174:175], v9 offset:1536
    ds_read_b128 v[228:231], v44 offset:6144
    ds_read_b128 v[232:235], v44 offset:8192
    ds_read_b64_tr_b16 v[176:177], v10
    ds_read_b64_tr_b16 v[178:179], v10 offset:1536
    ds_read_b64_tr_b16 v[180:181], v11
    ds_read_b64_tr_b16 v[182:183], v11 offset:1536
    ds_read_b64_tr_b16 v[184:185], v12
    ds_read_b64_tr_b16 v[186:187], v12 offset:1536
    ds_read_b64_tr_b16 v[188:189], v13
    ds_read_b64_tr_b16 v[190:191], v13 offset:1536
    s_waitcnt vmcnt(12) lgkmcnt(0)
    s_barrier
    s_mov_b32 s56, 4
    s_cmp_eq_u32 s28, 2
    s_cbranch_scc1 L_LOOP_X
    s_cmp_eq_u32 s28, 3
    s_cbranch_scc1 L_LOOP_K
L_LOOP_WQ:
    v_mfma_f32_16x16x32_bf16 v[48:51], v[168:171], v[216:219], v[48:51]
    v_add_u32 v44, s36, v15
    v_mfma_f32_16x16x32_bf16 v[52:55], v[168:171], v[220:223], v[52:55]
    ds_read_b128 v[236:239], v44
    s_add_u32 m0, s55, 110592
    v_mfma_f32_16x16x32_bf16 v[56:59], v[168:171], v[224:227], v[56:59]
    ds_read_b64_tr_b16 v[192:193], v8 offset:12288
    v_mfma_f32_16x16x32_bf16 v[60:63], v[168:171], v[228:231], v[60:63]
    ds_read_b64_tr_b16 v[194:195], v8 offset:13824
    buffer_load_dwordx4 v16, s[12:15], s33 offen lds
    v_mfma_f32_16x16x32_bf16 v[64:67], v[168:171], v[232:235], v[64:67]
    ds_read_b128 v[240:243], v44 offset:2048
    v_mfma_f32_16x16x32_bf16 v[68:71], v[172:175], v[216:219], v[68:71]
    v_mfma_f32_16x16x32_bf16 v[72:75], v[172:175], v[220:223], v[72:75]
    ds_read_b128 v[244:247], v44 offset:4096
    buffer_load_dwordx4 v17, s[12:15], s33 offen offset:1024 lds
    v_mfma_f32_16x16x32_bf16 v[76:79], v[172:175], v[224:227], v[76:79]
    ds_read_b64_tr_b16 v[196:197], v9 offset:12288
    v_mfma_f32_16x16x32_bf16 v[80:83], v[172:175], v[228:231], v[80:83]
    ds_read_b64_tr_b16 v[198:199], v9 offset:13824
    v_mfma_f32_16x16x32_bf16 v[84:87], v[172:175], v[232:235], v[84:87]
    ds_read_b128 v[248:251], v44 offset:6144
    buffer_load_dwordx4 v18, s[12:15], s33 offen offset:2048 lds
    v_mfma_f32_16x16x32_bf16 v[88:91], v[176:179], v[216:219], v[88:91]
    v_mfma_f32_16x16x32_bf16 v[92:95], v[176:179], v[220:223], v[92:95]
    ds_read_b128 v[252:255], v44 offset:8192
    v_mfma_f32_16x16x32_bf16 v[96:99], v[176:179], v[224:227], v[96:99]
    ds_read_b64_tr_b16 v[200:201], v10 offset:12288
    buffer_load_dwordx4 v19, s[12:15], s33 offen offset:3072 lds
    v_mfma_f32_16x16x32_bf16 v[100:103], v[176:179], v[228:231], v[100:103]
    ds_read_b64_tr_b16 v[202:203], v10 offset:13824
    v_mfma_f32_16x16x32_bf16 v[104:107], v[176:179], v[232:235], v[104:107]
    ds_read_b64_tr_b16 v[204:205], v11 offset:12288
    v_mfma_f32_16x16x32_bf16 v[108:111], v[180:183], v[216:219], v[108:111]
    ds_read_b64_tr_b16 v[206:207], v11 offset:13824
    s_add_u32 m0, s55, 114688
    v_mfma_f32_16x16x32_bf16 v[112:115], v[180:183], v[220:223], v[112:115]
    v_mfma_f32_16x16x32_bf16 v[116:119], v[180:183], v[224:227], v[116:119]
    ds_read_b64_tr_b16 v[208:209], v12 offset:12288
    v_mfma_f32_16x16x32_bf16 v[120:123], v[180:183], v[228:231], v[120:123]
    ds_read_b64_tr_b16 v[210:211], v12 offset:13824
    buffer_load_dwordx4 v20, s[12:15], s33 offen lds
    v_mfma_f32_16x16x32_bf16 v[124:127], v[180:183], v[232:235], v[124:127]
    ds_read_b64_tr_b16 v[212:213], v13 offset:12288
    v_mfma_f32_16x16x32_bf16 v[128:131], v[184:187], v[216:219], v[128:131]
    ds_read_b64_tr_b16 v[214:215], v13 offset:13824
    v_mfma_f32_16x16x32_bf16 v[132:135], v[184:187], v[220:223], v[132:135]
    buffer_load_dwordx4 v21, s[12:15], s33 offen offset:1024 lds
    v_mfma_f32_16x16x32_bf16 v[136:139], v[184:187], v[224:227], v[136:139]
    v_mfma_f32_16x16x32_bf16 v[140:143], v[184:187], v[228:231], v[140:143]
    v_mfma_f32_16x16x32_bf16 v[144:147], v[184:187], v[232:235], v[144:147]
    s_add_u32 s32, s32, 1
    s_cmp_eq_u32 s32, 20
    s_cselect_b32 s32, 0, s32
    s_mul_i32 s33, s32, 393216
    v_mfma_f32_16x16x32_bf16 v[148:151], v[188:191], v[216:219], v[148:151]
    v_mfma_f32_16x16x32_bf16 v[152:155], v[188:191], v[220:223], v[152:155]
    v_mfma_f32_16x16x32_bf16 v[156:159], v[188:191], v[224:227], v[156:159]
    v_mfma_f32_16x16x32_bf16 v[160:163], v[188:191], v[228:231], v[160:163]
    v_mfma_f32_16x16x32_bf16 v[164:167], v[188:191], v[232:235], v[164:167]
    s_waitcnt vmcnt(12) lgkmcnt(0)
    s_barrier
    v_mfma_f32_16x16x32_bf16 v[48:51], v[192:195], v[236:239], v[48:51]
    v_add_u32 v44, s37, v14
    v_mfma_f32_16x16x32_bf16 v[52:55], v[192:195], v[240:243], v[52:55]
    ds_read_b128 v[216:219], v44
    s_add_u32 m0, s55, 122880
    v_mfma_f32_16x16x32_bf16 v[56:59], v[192:195], v[244:247], v[56:59]
    ds_read_b64_tr_b16 v[168:169], v8 offset:24576
    v_mfma_f32_16x16x32_bf16 v[60:63], v[192:195], v[248:251], v[60:63]
    ds_read_b64_tr_b16 v[170:171], v8 offset:26112
    buffer_load_dwordx4 v16, s[12:15], s33 offen lds
    v_mfma_f32_16x16x32_bf16 v[64:67], v[192:195], v[252:255], v[64:67]
    ds_read_b128 v[220:223], v44 offset:2048
    v_mfma_f32_16x16x32_bf16 v[68:71], v[196:199], v[236:239], v[68:71]
    v_mfma_f32_16x16x32_bf16 v[72:75], v[196:199], v[240:243], v[72:75]
    ds_read_b128 v[224:227], v44 offset:4096
    buffer_load_dwordx4 v17, s[12:15], s33 offen offset:1024 lds
    v_mfma_f32_16x16x32_bf16 v[76:79], v[196:199], v[244:247], v[76:79]
    ds_read_b64_tr_b16 v[172:173], v9 offset:24576
    v_mfma_f32_16x16x32_bf16 v[80:83], v[196:199], v[248:251], v[80:83]
    ds_read_b64_tr_b16 v[174:175], v9 offset:26112
    v_mfma_f32_16x16x32_bf16 v[84:87], v[196:199], v[252:255], v[84:87]
    ds_read_b128 v[228:231], v44 offset:6144
    buffer_load_dwordx4 v18, s[12:15], s33 offen offset:2048 lds
    v_mfma_f32_16x16x32_bf16 v[88:91], v[200:203], v[236:239], v[88:91]
    v_mfma_f32_16x16x32_bf16 v[92:95], v[200:203], v[240:243], v[92:95]
    ds_read_b128 v[232:235], v44 offset:8192
    v_mfma_f32_16x16x32_bf16 v[96:99], v[200:203], v[244:247], v[96:99]
    ds_read_b64_tr_b16 v[176:177], v10 offset:24576
    buffer_load_dwordx4 v19, s[12:15], s33 offen offset:3072 lds
    v_mfma_f32_16x16x32_bf16 v[100:103], v[200:203], v[248:251], v[100:103]
    ds_read_b64_tr_b16 v[178:179], v10 offset:26112
    v_mfma_f32_16x16x32_bf16 v[104:107], v[200:203], v[252:255], v[104:107]
    ds_read_b64_tr_b16 v[180:181], v11 offset:24576
    v_mfma_f32_16x16x32_bf16 v[108:111], v[204:207], v[236:239], v[108:111]
    ds_read_b64_tr_b16 v[182:183], v11 offset:26112
    s_add_u32 m0, s55, 126976
    v_mfma_f32_16x16x32_bf16 v[112:115], v[204:207], v[240:243], v[112:115]
    v_mfma_f32_16x16x32_bf16 v[116:119], v[204:207], v[244:247], v[116:119]
    ds_read_b64_tr_b16 v[184:185], v12 offset:24576
    v_mfma_f32_16x16x32_bf16 v[120:123], v[204:207], v[248:251], v[120:123]
    ds_read_b64_tr_b16 v[186:187], v12 offset:26112
    buffer_load_dwordx4 v20, s[12:15], s33 offen lds
    v_mfma_f32_16x16x32_bf16 v[124:127], v[204:207], v[252:255], v[124:127]
    ds_read_b64_tr_b16 v[188:189], v13 offset:24576
    v_mfma_f32_16x16x32_bf16 v[128:131], v[208:211], v[236:239], v[128:131]
    ds_read_b64_tr_b16 v[190:191], v13 offset:26112
    v_mfma_f32_16x16x32_bf16 v[132:135], v[208:211], v[240:243], v[132:135]
    buffer_load_dwordx4 v21, s[12:15], s33 offen offset:1024 lds
    v_mfma_f32_16x16x32_bf16 v[136:139], v[208:211], v[244:247], v[136:139]
    v_mfma_f32_16x16x32_bf16 v[140:143], v[208:211], v[248:251], v[140:143]
    v_mfma_f32_16x16x32_bf16 v[144:147], v[208:211], v[252:255], v[144:147]
    s_add_u32 s32, s32, 1
    s_cmp_eq_u32 s32, 20
    s_cselect_b32 s32, 0, s32
    s_mul_i32 s33, s32, 393216
    v_mfma_f32_16x16x32_bf16 v[148:151], v[212:215], v[236:239], v[148:151]
    v_mfma_f32_16x16x32_bf16 v[152:155], v[212:215], v[240:243], v[152:155]
    v_mfma_f32_16x16x32_bf16 v[156:159], v[212:215], v[244:247], v[156:159]
    v_mfma_f32_16x16x32_bf16 v[160:163], v[212:215], v[248:251], v[160:163]
    v_mfma_f32_16x16x32_bf16 v[164:167], v[212:215], v[252:255], v[164:167]
    s_waitcnt vmcnt(12) lgkmcnt(0)
    s_barrier
    v_mfma_f32_16x16x32_bf16 v[48:51], v[168:171], v[216:219], v[48:51]
    v_add_u32 v44, s37, v15
    v_mfma_f32_16x16x32_bf16 v[52:55], v[168:171], v[220:223], v[52:55]
    ds_read_b128 v[236:239], v44
    s_add_u32 m0, s55, 135168
    v_mfma_f32_16x16x32_bf16 v[56:59], v[168:171], v[224:227], v[56:59]
    ds_read_b64_tr_b16 v[192:193], v8 offset:36864
    v_mfma_f32_16x16x32_bf16 v[60:63], v[168:171], v[228:231], v[60:63]
    ds_read_b64_tr_b16 v[194:195], v8 offset:38400
    buffer_load_dwordx4 v16, s[12:15], s33 offen lds
    v_mfma_f32_16x16x32_bf16 v[64:67], v[168:171], v[232:235], v[64:67]
    ds_read_b128 v[240:243], v44 offset:2048
    v_mfma_f32_16x16x32_bf16 v[68:71], v[172:175], v[216:219], v[68:71]
    v_mfma_f32_16x16x32_bf16 v[72:75], v[172:175], v[220:223], v[72:75]
    ds_read_b128 v[244:247], v44 offset:4096
    buffer_load_dwordx4 v17, s[12:15], s33 offen offset:1024 lds
    v_mfma_f32_16x16x32_bf16 v[76:79], v[172:175], v[224:227], v[76:79]
    ds_read_b64_tr_b16 v[196:197], v9 offset:36864
    v_mfma_f32_16x16x32_bf16 v[80:83], v[172:175], v[228:231], v[80:83]
    ds_read_b64_tr_b16 v[198:199], v9 offset:38400
    v_mfma_f32_16x16x32_bf16 v[84:87], v[172:175], v[232:235], v[84:87]
    ds_read_b128 v[248:251], v44 offset:6144
    buffer_load_dwordx4 v18, s[12:15], s33 offen offset:2048 lds
    v_mfma_f32_16x16x32_bf16 v[88:91], v[176:179], v[216:219], v[88:91]
    v_mfma_f32_16x16x32_bf16 v[92:95], v[176:179], v[220:223], v[92:95]
    ds_read_b128 v[252:255], v44 offset:8192
    v_mfma_f32_16x16x32_bf16 v[96:99], v[176:179], v[224:227], v[96:99]
    ds_read_b64_tr_b16 v[200:201], v10 offset:36864
    buffer_load_dwordx4 v19, s[12:15], s33 offen offset:3072 lds
    v_mfma_f32_16x16x32_bf16 v[100:103], v[176:179], v[228:231], v[100:103]
    ds_read_b64_tr_b16 v[202:203], v10 offset:38400
    v_mfma_f32_16x16x32_bf16 v[104:107], v[176:179], v[232:235], v[104:107]
    ds_read_b64_tr_b16 v[204:205], v11 offset:36864
    v_mfma_f32_16x16x32_bf16 v[108:111], v[180:183], v[216:219], v[108:111]
    ds_read_b64_tr_b16 v[206:207], v11 offset:38400
    s_add_u32 m0, s55, 139264
    v_mfma_f32_16x16x32_bf16 v[112:115], v[180:183], v[220:223], v[112:115]
    v_mfma_f32_16x16x32_bf16 v[116:119], v[180:183], v[224:227], v[116:119]
    ds_read_b64_tr_b16 v[208:209], v12 offset:36864
    v_mfma_f32_16x16x32_bf16 v[120:123], v[180:183], v[228:231], v[120:123]
    ds_read_b64_tr_b16 v[210:211], v12 offset:38400
    buffer_load_dwordx4 v20, s[12:15], s33 offen lds
    v_mfma_f32_16x16x32_bf16 v[124:127], v[180:183], v[232:235], v[124:127]
    ds_read_b64_tr_b16 v[212:213], v13 offset:36864
    v_mfma_f32_16x16x32_bf16 v[128:131], v[184:187], v[216:219], v[128:131]
    ds_read_b64_tr_b16 v[214:215], v13 offset:38400
    v_mfma_f32_16x16x32_bf16 v[132:135], v[184:187], v[220:223], v[132:135]
    buffer_load_dwordx4 v21, s[12:15], s33 offen offset:1024 lds
    v_mfma_f32_16x16x32_bf16 v[136:139], v[184:187], v[224:227], v[136:139]
    v_mfma_f32_16x16x32_bf16 v[140:143], v[184:187], v[228:231], v[140:143]
    v_mfma_f32_16x16x32_bf16 v[144:147], v[184:187], v[232:235], v[144:147]
    s_add_u32 s32, s32, 1
    s_cmp_eq_u32 s32, 20
    s_cselect_b32 s32, 0, s32
    s_mul_i32 s33, s32, 393216
    v_mfma_f32_16x16x32_bf16 v[148:151], v[188:191], v[216:219], v[148:151]
    v_mfma_f32_16x16x32_bf16 v[152:155], v[188:191], v[220:223], v[152:155]
    v_mfma_f32_16x16x32_bf16 v[156:159], v[188:191], v[224:227], v[156:159]
    v_mfma_f32_16x16x32_bf16 v[160:163], v[188:191], v[228:231], v[160:163]
    v_mfma_f32_16x16x32_bf16 v[164:167], v[188:191], v[232:235], v[164:167]
    s_waitcnt vmcnt(12) lgkmcnt(0)
    s_barrier
    v_mfma_f32_16x16x32_bf16 v[48:51], v[192:195], v[236:239], v[48:51]
    v_add_u32 v44, s38, v14
    v_mfma_f32_16x16x32_bf16 v[52:55], v[192:195], v[240:243], v[52:55]
    ds_read_b128 v[216:219], v44
    s_add_u32 m0, s55, 147456
    v_mfma_f32_16x16x32_bf16 v[56:59], v[192:195], v[244:247], v[56:59]
    ds_read_b64_tr_b16 v[168:169], v8
    v_mfma_f32_16x16x32_bf16 v[60:63], v[192:195], v[248:251], v[60:63]
    ds_read_b64_tr_b16 v[170:171], v8 offset:1536
    buffer_load_dwordx4 v16, s[12:15], s33 offen lds
    v_mfma_f32_16x16x32_bf16 v[64:67], v[192:195], v[252:255], v[64:67]
    ds_read_b128 v[220:223], v44 offset:2048
    v_mfma_f32_16x16x32_bf16 v[68:71], v[196:199], v[236:239], v[68:71]
    v_mfma_f32_16x16x32_bf16 v[72:75], v[196:199], v[240:243], v[72:75]
    ds_read_b128 v[224:227], v44 offset:4096
    buffer_load_dwordx4 v17, s[12:15], s33 offen offset:1024 lds
    v_mfma_f32_16x16x32_bf16 v[76:79], v[196:199], v[244:247], v[76:79]
    ds_read_b64_tr_b16 v[172:173], v9
    v_mfma_f32_16x16x32_bf16 v[80:83], v[196:199], v[248:251], v[80:83]
    ds_read_b64_tr_b16 v[174:175], v9 offset:1536
    v_mfma_f32_16x16x32_bf16 v[84:87], v[196:199], v[252:255], v[84:87]
    ds_read_b128 v[228:231], v44 offset:6144
    buffer_load_dwordx4 v18, s[12:15], s33 offen offset:2048 lds
    v_mfma_f32_16x16x32_bf16 v[88:91], v[200:203], v[236:239], v[88:91]
    v_mfma_f32_16x16x32_bf16 v[92:95], v[200:203], v[240:243], v[92:95]
    ds_read_b128 v[232:235], v44 offset:8192
    v_mfma_f32_16x16x32_bf16 v[96:99], v[200:203], v[244:247], v[96:99]
    ds_read_b64_tr_b16 v[176:177], v10
    buffer_load_dwordx4 v19, s[12:15], s33 offen offset:3072 lds
    v_mfma_f32_16x16x32_bf16 v[100:103], v[200:203], v[248:251], v[100:103]
    ds_read_b64_tr_b16 v[178:179], v10 offset:1536
    v_mfma_f32_16x16x32_bf16 v[104:107], v[200:203], v[252:255], v[104:107]
    ds_read_b64_tr_b16 v[180:181], v11
    v_mfma_f32_16x16x32_bf16 v[108:111], v[204:207], v[236:239], v[108:111]
    ds_read_b64_tr_b16 v[182:183], v11 offset:1536
    s_add_u32 m0, s55, 151552
    v_mfma_f32_16x16x32_bf16 v[112:115], v[204:207], v[240:243], v[112:115]
    v_mfma_f32_16x16x32_bf16 v[116:119], v[204:207], v[244:247], v[116:119]
    ds_read_b64_tr_b16 v[184:185], v12
    v_mfma_f32_16x16x32_bf16 v[120:123], v[204:207], v[248:251], v[120:123]
    ds_read_b64_tr_b16 v[186:187], v12 offset:1536
    buffer_load_dwordx4 v20, s[12:15], s33 offen lds
    v_mfma_f32_16x16x32_bf16 v[124:127], v[204:207], v[252:255], v[124:127]
    ds_read_b64_tr_b16 v[188:189], v13
    v_mfma_f32_16x16x32_bf16 v[128:131], v[208:211], v[236:239], v[128:131]
    ds_read_b64_tr_b16 v[190:191], v13 offset:1536
    v_mfma_f32_16x16x32_bf16 v[132:135], v[208:211], v[240:243], v[132:135]
    buffer_load_dwordx4 v21, s[12:15], s33 offen offset:1024 lds
    v_mfma_f32_16x16x32_bf16 v[136:139], v[208:211], v[244:247], v[136:139]
    v_mfma_f32_16x16x32_bf16 v[140:143], v[208:211], v[248:251], v[140:143]
    v_mfma_f32_16x16x32_bf16 v[144:147], v[208:211], v[252:255], v[144:147]
    s_add_u32 s32, s32, 1
    s_cmp_eq_u32 s32, 20
    s_cselect_b32 s32, 0, s32
    s_mul_i32 s33, s32, 393216
    v_mfma_f32_16x16x32_bf16 v[148:151], v[212:215], v[236:239], v[148:151]
    v_mfma_f32_16x16x32_bf16 v[152:155], v[212:215], v[240:243], v[152:155]
    v_mfma_f32_16x16x32_bf16 v[156:159], v[212:215], v[244:247], v[156:159]
    v_mfma_f32_16x16x32_bf16 v[160:163], v[212:215], v[248:251], v[160:163]
    v_mfma_f32_16x16x32_bf16 v[164:167], v[212:215], v[252:255], v[164:167]
    s_waitcnt vmcnt(12) lgkmcnt(0)
    s_barrier
    s_mov_b32 s31, s36
    s_mov_b32 s36, s38
    s_mov_b32 s38, s37
    s_mov_b32 s37, s31
    s_sub_u32 s56, s56, 1
    s_cmp_lg_u32 s56, 0
    s_cbranch_scc1 L_LOOP_WQ
    s_branch L_QTAIL
L_LOOP_X:
    v_mfma_f32_16x16x32_bf16 v[48:51], v[168:171], v[216:219], v[48:51]
    v_add_u32 v44, s36, v15
    s_add_u32 m0, s38, 49152
    v_mfma_f32_16x16x32_bf16 v[52:55], v[168:171], v[220:223], v[52:55]
    ds_read_b128 v[236:239], v44
    v_mfma_f32_16x16x32_bf16 v[56:59], v[168:171], v[224:227], v[56:59]
    ds_read_b64_tr_b16 v[192:193], v8 offset:12288
    buffer_load_dwordx4 v16, s[8:11], s35 offen lds
    v_mfma_f32_16x16x32_bf16 v[60:63], v[168:171], v[228:231], v[60:63]
    ds_read_b64_tr_b16 v[194:195], v8 offset:13824
    v_mfma_f32_16x16x32_bf16 v[64:67], v[168:171], v[232:235], v[64:67]
    ds_read_b128 v[240:243], v44 offset:2048
    buffer_load_dwordx4 v17, s[8:11], s35 offen offset:1024 lds
    v_mfma_f32_16x16x32_bf16 v[68:71], v[172:175], v[216:219], v[68:71]
    v_mfma_f32_16x16x32_bf16 v[72:75], v[172:175], v[220:223], v[72:75]
    ds_read_b128 v[244:247], v44 offset:4096
    buffer_load_dwordx4 v18, s[8:11], s35 offen offset:2048 lds
    v_mfma_f32_16x16x32_bf16 v[76:79], v[172:175], v[224:227], v[76:79]
    ds_read_b64_tr_b16 v[196:197], v9 offset:12288
    v_mfma_f32_16x16x32_bf16 v[80:83], v[172:175], v[228:231], v[80:83]
    ds_read_b64_tr_b16 v[198:199], v9 offset:13824
    buffer_load_dwordx4 v19, s[8:11], s35 offen offset:3072 lds
    v_mfma_f32_16x16x32_bf16 v[84:87], v[172:175], v[232:235], v[84:87]
    ds_read_b128 v[248:251], v44 offset:6144
    v_mfma_f32_16x16x32_bf16 v[88:91], v[176:179], v[216:219], v[88:91]
    s_add_u32 m0, s38, 53248
    v_mfma_f32_16x16x32_bf16 v[92:95], v[176:179], v[220:223], v[92:95]
    ds_read_b128 v[252:255], v44 offset:8192
    v_mfma_f32_16x16x32_bf16 v[96:99], v[176:179], v[224:227], v[96:99]
    ds_read_b64_tr_b16 v[200:201], v10 offset:12288
    buffer_load_dwordx4 v20, s[8:11], s35 offen lds
    v_mfma_f32_16x16x32_bf16 v[100:103], v[176:179], v[228:231], v[100:103]
    ds_read_b64_tr_b16 v[202:203], v10 offset:13824
    v_mfma_f32_16x16x32_bf16 v[104:107], v[176:179], v[232:235], v[104:107]
    ds_read_b64_tr_b16 v[204:205], v11 offset:12288
    v_mfma_f32_16x16x32_bf16 v[108:111], v[180:183], v[216:219], v[108:111]
    ds_read_b64_tr_b16 v[206:207], v11 offset:13824
    buffer_load_dwordx4 v21, s[8:11], s35 offen offset:1024 lds
    v_mfma_f32_16x16x32_bf16 v[112:115], v[180:183], v[220:223], v[112:115]
    v_mfma_f32_16x16x32_bf16 v[116:119], v[180:183], v[224:227], v[116:119]
    ds_read_b64_tr_b16 v[208:209], v12 offset:12288
    buffer_load_dwordx4 v24, s[8:11], s35 offen offset:2048 lds
    v_mfma_f32_16x16x32_bf16 v[120:123], v[180:183], v[228:231], v[120:123]
    ds_read_b64_tr_b16 v[210:211], v12 offset:13824
    v_mfma_f32_16x16x32_bf16 v[124:127], v[180:183], v[232:235], v[124:127]
    ds_read_b64_tr_b16 v[212:213], v13 offset:12288
    buffer_load_dwordx4 v25, s[8:11], s35 offen offset:3072 lds
    v_mfma_f32_16x16x32_bf16 v[128:131], v[184:187], v[216:219], v[128:131]
    ds_read_b64_tr_b16 v[214:215], v13 offset:13824
    v_mfma_f32_16x16x32_bf16 v[132:135], v[184:187], v[220:223], v[132:135]
    s_add_u32 m0, s38, 57344
    v_mfma_f32_16x16x32_bf16 v[136:139], v[184:187], v[224:227], v[136:139]
    v_mfma_f32_16x16x32_bf16 v[140:143], v[184:187], v[228:231], v[140:143]
    buffer_load_dwordx4 v26, s[8:11], s35 offen lds
    v_mfma_f32_16x16x32_bf16 v[144:147], v[184:187], v[232:235], v[144:147]
    v_mfma_f32_16x16x32_bf16 v[148:151], v[188:191], v[216:219], v[148:151]
    buffer_load_dwordx4 v27, s[8:11], s35 offen offset:1024 lds
    v_mfma_f32_16x16x32_bf16 v[152:155], v[188:191], v[220:223], v[152:155]
    v_mfma_f32_16x16x32_bf16 v[156:159], v[188:191], v[224:227], v[156:159]
    v_mfma_f32_16x16x32_bf16 v[160:163], v[188:191], v[228:231], v[160:163]
    v_mfma_f32_16x16x32_bf16 v[164:167], v[188:191], v[232:235], v[164:167]
    s_waitcnt vmcnt(10) lgkmcnt(0)
    s_barrier
    v_mfma_f32_16x16x32_bf16 v[48:51], v[192:195], v[236:239], v[48:51]
    v_add_u32 v44, s37, v14
    s_add_u32 s48, s35, 102400
    v_mfma_f32_16x16x32_bf16 v[52:55], v[192:195], v[240:243], v[52:55]
    ds_read_b128 v[216:219], v44
    s_add_u32 m0, s38, 59392
    v_mfma_f32_16x16x32_bf16 v[56:59], v[192:195], v[244:247], v[56:59]
    ds_read_b64_tr_b16 v[168:169], v8 offset:24576
    v_mfma_f32_16x16x32_bf16 v[60:63], v[192:195], v[248:251], v[60:63]
    ds_read_b64_tr_b16 v[170:171], v8 offset:26112
    buffer_load_dwordx4 v16, s[8:11], s48 offen lds
    v_mfma_f32_16x16x32_bf16 v[64:67], v[192:195], v[252:255], v[64:67]
    ds_read_b128 v[220:223], v44 offset:2048
    v_mfma_f32_16x16x32_bf16 v[68:71], v[196:199], v[236:239], v[68:71]
    buffer_load_dwordx4 v17, s[8:11], s48 offen offset:1024 lds
    v_mfma_f32_16x16x32_bf16 v[72:75], v[196:199], v[240:243], v[72:75]
    ds_read_b128 v[224:227], v44 offset:4096
    v_mfma_f32_16x16x32_bf16 v[76:79], v[196:199], v[244:247], v[76:79]
    ds_read_b64_tr_b16 v[172:173], v9 offset:24576
    buffer_load_dwordx4 v18, s[8:11], s48 offen offset:2048 lds
    v_mfma_f32_16x16x32_bf16 v[80:83], v[196:199], v[248:251], v[80:83]
    ds_read_b64_tr_b16 v[174:175], v9 offset:26112
    v_mfma_f32_16x16x32_bf16 v[84:87], v[196:199], v[252:255], v[84:87]
    ds_read_b128 v[228:231], v44 offset:6144
    buffer_load_dwordx4 v19, s[8:11], s48 offen offset:3072 lds
    v_mfma_f32_16x16x32_bf16 v[88:91], v[200:203], v[236:239], v[88:91]
    v_mfma_f32_16x16x32_bf16 v[92:95], v[200:203], v[240:243], v[92:95]
    ds_read_b128 v[232:235], v44 offset:8192
    s_add_u32 m0, s38, 63488
    v_mfma_f32_16x16x32_bf16 v[96:99], v[200:203], v[244:247], v[96:99]
    ds_read_b64_tr_b16 v[176:177], v10 offset:24576
    v_mfma_f32_16x16x32_bf16 v[100:103], v[200:203], v[248:251], v[100:103]
    ds_read_b64_tr_b16 v[178:179], v10 offset:26112
    buffer_load_dwordx4 v20, s[8:11], s48 offen lds
    v_mfma_f32_16x16x32_bf16 v[104:107], v[200:203], v[252:255], v[104:107]
    ds_read_b64_tr_b16 v[180:181], v11 offset:24576
    buffer_load_dwordx4 v21, s[8:11], s48 offen offset:1024 lds
    v_mfma_f32_16x16x32_bf16 v[108:111], v[204:207], v[236:239], v[108:111]
    ds_read_b64_tr_b16 v[182:183], v11 offset:26112
    v_mfma_f32_16x16x32_bf16 v[112:115], v[204:207], v[240:243], v[112:115]
    buffer_load_dwordx4 v24, s[8:11], s48 offen offset:2048 lds
    v_mfma_f32_16x16x32_bf16 v[116:119], v[204:207], v[244:247], v[116:119]
    ds_read_b64_tr_b16 v[184:185], v12 offset:24576
    v_mfma_f32_16x16x32_bf16 v[120:123], v[204:207], v[248:251], v[120:123]
    ds_read_b64_tr_b16 v[186:187], v12 offset:26112
    buffer_load_dwordx4 v25, s[8:11], s48 offen offset:3072 lds
    v_mfma_f32_16x16x32_bf16 v[124:127], v[204:207], v[252:255], v[124:127]
    ds_read_b64_tr_b16 v[188:189], v13 offset:24576
    v_mfma_f32_16x16x32_bf16 v[128:131], v[208:211], v[236:239], v[128:131]
    ds_read_b64_tr_b16 v[190:191], v13 offset:26112
    s_add_u32 m0, s38, 67584
    v_mfma_f32_16x16x32_bf16 v[132:135], v[208:211], v[240:243], v[132:135]
    v_mfma_f32_16x16x32_bf16 v[136:139], v[208:211], v[244:247], v[136:139]
    buffer_load_dwordx4 v26, s[8:11], s48 offen lds
    v_mfma_f32_16x16x32_bf16 v[140:143], v[208:211], v[248:251], v[140:143]
    v_mfma_f32_16x16x32_bf16 v[144:147], v[208:211], v[252:255], v[144:147]
    buffer_load_dwordx4 v27, s[8:11], s48 offen offset:1024 lds
    v_mfma_f32_16x16x32_bf16 v[148:151], v[212:215], v[236:239], v[148:151]
    v_mfma_f32_16x16x32_bf16 v[152:155], v[212:215], v[240:243], v[152:155]
    s_add_u32 s34, s34, 1
    s_cmp_eq_u32 s34, 10
    s_cselect_b32 s34, 0, s34
    s_lshl_b32 s35, s34, 7
    v_mfma_f32_16x16x32_bf16 v[156:159], v[212:215], v[244:247], v[156:159]
    v_mfma_f32_16x16x32_bf16 v[160:163], v[212:215], v[248:251], v[160:163]
    v_mfma_f32_16x16x32_bf16 v[164:167], v[212:215], v[252:255], v[164:167]
    s_waitcnt lgkmcnt(0)
    s_barrier
    v_mfma_f32_16x16x32_bf16 v[48:51], v[168:171], v[216:219], v[48:51]
    v_add_u32 v44, s37, v15
    s_add_u32 m0, s36, 49152
    v_mfma_f32_16x16x32_bf16 v[52:55], v[168:171], v[220:223], v[52:55]
    ds_read_b128 v[236:239], v44
    v_mfma_f32_16x16x32_bf16 v[56:59], v[168:171], v[224:227], v[56:59]
    ds_read_b64_tr_b16 v[192:193], v8 offset:36864
    buffer_load_dwordx4 v16, s[8:11], s35 offen lds
    v_mfma_f32_16x16x32_bf16 v[60:63], v[168:171], v[228:231], v[60:63]
    ds_read_b64_tr_b16 v[194:195], v8 offset:38400
    v_mfma_f32_16x16x32_bf16 v[64:67], v[168:171], v[232:235], v[64:67]
    ds_read_b128 v[240:243], v44 offset:2048
    buffer_load_dwordx4 v17, s[8:11], s35 offen offset:1024 lds
    v_mfma_f32_16x16x32_bf16 v[68:71], v[172:175], v[216:219], v[68:71]
    v_mfma_f32_16x16x32_bf16 v[72:75], v[172:175], v[220:223], v[72:75]
    ds_read_b128 v[244:247], v44 offset:4096
    buffer_load_dwordx4 v18, s[8:11], s35 offen offset:2048 lds
    v_mfma_f32_16x16x32_bf16 v[76:79], v[172:175], v[224:227], v[76:79]
    ds_read_b64_tr_b16 v[196:197], v9 offset:36864
    v_mfma_f32_16x16x32_bf16 v[80:83], v[172:175], v[228:231], v[80:83]
    ds_read_b64_tr_b16 v[198:199], v9 offset:38400
    buffer_load_dwordx4 v19, s[8:11], s35 offen offset:3072 lds
    v_mfma_f32_16x16x32_bf16 v[84:87], v[172:175], v[232:235], v[84:87]
    ds_read_b128 v[248:251], v44 offset:6144
    v_mfma_f32_16x16x32_bf16 v[88:91], v[176:179], v[216:219], v[88:91]
    s_add_u32 m0, s36, 53248
    v_mfma_f32_16x16x32_bf16 v[92:95], v[176:179], v[220:223], v[92:95]
    ds_read_b128 v[252:255], v44 offset:8192
    v_mfma_f32_16x16x32_bf16 v[96:99], v[176:179], v[224:227], v[96:99]
    ds_read_b64_tr_b16 v[200:201], v10 offset:36864
    buffer_load_dwordx4 v20, s[8:11], s35 offen lds
    v_mfma_f32_16x16x32_bf16 v[100:103], v[176:179], v[228:231], v[100:103]
    ds_read_b64_tr_b16 v[202:203], v10 offset:38400
    v_mfma_f32_16x16x32_bf16 v[104:107], v[176:179], v[232:235], v[104:107]
    ds_read_b64_tr_b16 v[204:205], v11 offset:36864
    v_mfma_f32_16x16x32_bf16 v[108:111], v[180:183], v[216:219], v[108:111]
    ds_read_b64_tr_b16 v[206:207], v11 offset:38400
    buffer_load_dwordx4 v21, s[8:11], s35 offen offset:1024 lds
    v_mfma_f32_16x16x32_bf16 v[112:115], v[180:183], v[220:223], v[112:115]
    v_mfma_f32_16x16x32_bf16 v[116:119], v[180:183], v[224:227], v[116:119]
    ds_read_b64_tr_b16 v[208:209], v12 offset:36864
    buffer_load_dwordx4 v24, s[8:11], s35 offen offset:2048 lds
    v_mfma_f32_16x16x32_bf16 v[120:123], v[180:183], v[228:231], v[120:123]
    ds_read_b64_tr_b16 v[210:211], v12 offset:38400
    v_mfma_f32_16x16x32_bf16 v[124:127], v[180:183], v[232:235], v[124:127]
    ds_read_b64_tr_b16 v[212:213], v13 offset:36864
    buffer_load_dwordx4 v25, s[8:11], s35 offen offset:3072 lds
    v_mfma_f32_16x16x32_bf16 v[128:131], v[184:187], v[216:219], v[128:131]
    ds_read_b64_tr_b16 v[214:215], v13 offset:38400
    v_mfma_f32_16x16x32_bf16 v[132:135], v[184:187], v[220:223], v[132:135]
    s_add_u32 m0, s36, 57344
    v_mfma_f32_16x16x32_bf16 v[136:139], v[184:187], v[224:227], v[136:139]
    v_mfma_f32_16x16x32_bf16 v[140:143], v[184:187], v[228:231], v[140:143]
    buffer_load_dwordx4 v26, s[8:11], s35 offen lds
    v_mfma_f32_16x16x32_bf16 v[144:147], v[184:187], v[232:235], v[144:147]
    v_mfma_f32_16x16x32_bf16 v[148:151], v[188:191], v[216:219], v[148:151]
    buffer_load_dwordx4 v27, s[8:11], s35 offen offset:1024 lds
    v_mfma_f32_16x16x32_bf16 v[152:155], v[188:191], v[220:223], v[152:155]
    v_mfma_f32_16x16x32_bf16 v[156:159], v[188:191], v[224:227], v[156:159]
    v_mfma_f32_16x16x32_bf16 v[160:163], v[188:191], v[228:231], v[160:163]
    v_mfma_f32_16x16x32_bf16 v[164:167], v[188:191], v[232:235], v[164:167]
    s_waitcnt vmcnt(10) lgkmcnt(0)
    s_barrier
    v_mfma_f32_16x16x32_bf16 v[48:51], v[192:195], v[236:239], v[48:51]
    v_add_u32 v44, s38, v14
    s_add_u32 s48, s35, 102400
    v_mfma_f32_16x16x32_bf16 v[52:55], v[192:195], v[240:243], v[52:55]
    ds_read_b128 v[216:219], v44
    s_add_u32 m0, s36, 59392
    v_mfma_f32_16x16x32_bf16 v[56:59], v[192:195], v[244:247], v[56:59]
    ds_read_b64_tr_b16 v[168:169], v8
    v_mfma_f32_16x16x32_bf16 v[60:63], v[192:195], v[248:251], v[60:63]
    ds_read_b64_tr_b16 v[170:171], v8 offset:1536
    buffer_load_dwordx4 v16, s[8:11], s48 offen lds
    v_mfma_f32_16x16x32_bf16 v[64:67], v[192:195], v[252:255], v[64:67]
    ds_read_b128 v[220:223], v44 offset:2048
    v_mfma_f32_16x16x32_bf16 v[68:71], v[196:199], v[236:239], v[68:71]
    buffer_load_dwordx4 v17, s[8:11], s48 offen offset:1024 lds
    v_mfma_f32_16x16x32_bf16 v[72:75], v[196:199], v[240:243], v[72:75]
    ds_read_b128 v[224:227], v44 offset:4096
    v_mfma_f32_16x16x32_bf16 v[76:79], v[196:199], v[244:247], v[76:79]
    ds_read_b64_tr_b16 v[172:173], v9
    buffer_load_dwordx4 v18, s[8:11], s48 offen offset:2048 lds
    v_mfma_f32_16x16x32_bf16 v[80:83], v[196:199], v[248:251], v[80:83]
    ds_read_b64_tr_b16 v[174:175], v9 offset:1536
    v_mfma_f32_16x16x32_bf16 v[84:87], v[196:199], v[252:255], v[84:87]
    ds_read_b128 v[228:231], v44 offset:6144
    buffer_load_dwordx4 v19, s[8:11], s48 offen offset:3072 lds
    v_mfma_f32_16x16x32_bf16 v[88:91], v[200:203], v[236:239], v[88:91]
    v_mfma_f32_16x16x32_bf16 v[92:95], v[200:203], v[240:243], v[92:95]
    ds_read_b128 v[232:235], v44 offset:8192
    s_add_u32 m0, s36, 63488
    v_mfma_f32_16x16x32_bf16 v[96:99], v[200:203], v[244:247], v[96:99]
    ds_read_b64_tr_b16 v[176:177], v10
    v_mfma_f32_16x16x32_bf16 v[100:103], v[200:203], v[248:251], v[100:103]
    ds_read_b64_tr_b16 v[178:179], v10 offset:1536
    buffer_load_dwordx4 v20, s[8:11], s48 offen lds
    v_mfma_f32_16x16x32_bf16 v[104:107], v[200:203], v[252:255], v[104:107]
    ds_read_b64_tr_b16 v[180:181], v11
    buffer_load_dwordx4 v21, s[8:11], s48 offen offset:1024 lds
    v_mfma_f32_16x16x32_bf16 v[108:111], v[204:207], v[236:239], v[108:111]
    ds_read_b64_tr_b16 v[182:183], v11 offset:1536
    v_mfma_f32_16x16x32_bf16 v[112:115], v[204:207], v[240:243], v[112:115]
    buffer_load_dwordx4 v24, s[8:11], s48 offen offset:2048 lds
    v_mfma_f32_16x16x32_bf16 v[116:119], v[204:207], v[244:247], v[116:119]
    ds_read_b64_tr_b16 v[184:185], v12
    v_mfma_f32_16x16x32_bf16 v[120:123], v[204:207], v[248:251], v[120:123]
    ds_read_b64_tr_b16 v[186:187], v12 offset:1536
    buffer_load_dwordx4 v25, s[8:11], s48 offen offset:3072 lds
    v_mfma_f32_16x16x32_bf16 v[124:127], v[204:207], v[252:255], v[124:127]
    ds_read_b64_tr_b16 v[188:189], v13
    v_mfma_f32_16x16x32_bf16 v[128:131], v[208:211], v[236:239], v[128:131]
    ds_read_b64_tr_b16 v[190:191], v13 offset:1536
    s_add_u32 m0, s36, 67584
    v_mfma_f32_16x16x32_bf16 v[132:135], v[208:211], v[240:243], v[132:135]
    v_mfma_f32_16x16x32_bf16 v[136:139], v[208:211], v[244:247], v[136:139]
    buffer_load_dwordx4 v26, s[8:11], s48 offen lds
    v_mfma_f32_16x16x32_bf16 v[140:143], v[208:211], v[248:251], v[140:143]
    v_mfma_f32_16x16x32_bf16 v[144:147], v[208:211], v[252:255], v[144:147]
    buffer_load_dwordx4 v27, s[8:11], s48 offen offset:1024 lds
    v_mfma_f32_16x16x32_bf16 v[148:151], v[212:215], v[236:239], v[148:151]
    v_mfma_f32_16x16x32_bf16 v[152:155], v[212:215], v[240:243], v[152:155]
    s_add_u32 s34, s34, 1
    s_cmp_eq_u32 s34, 10
    s_cselect_b32 s34, 0, s34
    s_lshl_b32 s35, s34, 7
    v_mfma_f32_16x16x32_bf16 v[156:159], v[212:215], v[244:247], v[156:159]
    v_mfma_f32_16x16x32_bf16 v[160:163], v[212:215], v[248:251], v[160:163]
    v_mfma_f32_16x16x32_bf16 v[164:167], v[212:215], v[252:255], v[164:167]
    s_waitcnt lgkmcnt(0)
    s_barrier
    s_mov_b32 s31, s36
    s_mov_b32 s36, s38
    s_mov_b32 s38, s37
    s_mov_b32 s37, s31
    s_sub_u32 s56, s56, 1
    s_cmp_lg_u32 s56, 0
    s_cbranch_scc1 L_LOOP_X
    s_branch L_QTAIL
L_LOOP_K:
    v_mfma_f32_16x16x32_bf16 v[48:51], v[168:171], v[216:219], v[48:51]
    v_add_u32 v44, s36, v15
    v_mfma_f32_16x16x32_bf16 v[52:55], v[168:171], v[220:223], v[52:55]
    ds_read_b128 v[236:239], v44
    v_mfma_f32_16x16x32_bf16 v[56:59], v[168:171], v[224:227], v[56:59]
    ds_read_b64_tr_b16 v[192:193], v8 offset:12288
    s_add_u32 m0, s58, 0
    s_add_u32 s48, s57, 0
    v_mfma_f32_16x16x32_bf16 v[60:63], v[168:171], v[228:231], v[60:63]
    ds_read_b64_tr_b16 v[194:195], v8 offset:13824
    v_mfma_f32_16x16x32_bf16 v[64:67], v[168:171], v[232:235], v[64:67]
    ds_read_b128 v[240:243], v44 offset:2048
    v_mfma_f32_16x16x32_bf16 v[68:71], v[172:175], v[216:219], v[68:71]
    v_mfma_f32_16x16x32_bf16 v[72:75], v[172:175], v[220:223], v[72:75]
    ds_read_b128 v[244:247], v44 offset:4096
    v_mfma_f32_16x16x32_bf16 v[76:79], v[172:175], v[224:227], v[76:79]
    ds_read_b64_tr_b16 v[196:197], v9 offset:12288
    buffer_load_dwordx4 v16, s[16:19], s48 offen nt lds
    v_mfma_f32_16x16x32_bf16 v[80:83], v[172:175], v[228:231], v[80:83]
    ds_read_b64_tr_b16 v[198:199], v9 offset:13824
    v_mfma_f32_16x16x32_bf16 v[84:87], v[172:175], v[232:235], v[84:87]
    ds_read_b128 v[248:251], v44 offset:6144
    v_mfma_f32_16x16x32_bf16 v[88:91], v[176:179], v[216:219], v[88:91]
    v_mfma_f32_16x16x32_bf16 v[92:95], v[176:179], v[220:223], v[92:95]
    ds_read_b128 v[252:255], v44 offset:8192
    v_mfma_f32_16x16x32_bf16 v[96:99], v[176:179], v[224:227], v[96:99]
    ds_read_b64_tr_b16 v[200:201], v10 offset:12288
    v_mfma_f32_16x16x32_bf16 v[100:103], v[176:179], v[228:231], v[100:103]
    ds_read_b64_tr_b16 v[202:203], v10 offset:13824
    buffer_load_dwordx4 v17, s[16:19], s48 offen offset:1024 nt lds
    v_mfma_f32_16x16x32_bf16 v[104:107], v[176:179], v[232:235], v[104:107]
    ds_read_b64_tr_b16 v[204:205], v11 offset:12288
    v_mfma_f32_16x16x32_bf16 v[108:111], v[180:183], v[216:219], v[108:111]
    ds_read_b64_tr_b16 v[206:207], v11 offset:13824
    v_mfma_f32_16x16x32_bf16 v[112:115], v[180:183], v[220:223], v[112:115]
    v_mfma_f32_16x16x32_bf16 v[116:119], v[180:183], v[224:227], v[116:119]
    ds_read_b64_tr_b16 v[208:209], v12 offset:12288
    v_mfma_f32_16x16x32_bf16 v[120:123], v[180:183], v[228:231], v[120:123]
    ds_read_b64_tr_b16 v[210:211], v12 offset:13824
    v_mfma_f32_16x16x32_bf16 v[124:127], v[180:183], v[232:235], v[124:127]
    ds_read_b64_tr_b16 v[212:213], v13 offset:12288
    buffer_load_dwordx4 v18, s[16:19], s48 offen offset:2048 nt lds
    v_mfma_f32_16x16x32_bf16 v[128:131], v[184:187], v[216:219], v[128:131]
    ds_read_b64_tr_b16 v[214:215], v13 offset:13824
    v_mfma_f32_16x16x32_bf16 v[132:135], v[184:187], v[220:223], v[132:135]
    v_mfma_f32_16x16x32_bf16 v[136:139], v[184:187], v[224:227], v[136:139]
    v_mfma_f32_16x16x32_bf16 v[140:143], v[184:187], v[228:231], v[140:143]
    v_mfma_f32_16x16x32_bf16 v[144:147], v[184:187], v[232:235], v[144:147]
    v_mfma_f32_16x16x32_bf16 v[148:151], v[188:191], v[216:219], v[148:151]
    v_mfma_f32_16x16x32_bf16 v[152:155], v[188:191], v[220:223], v[152:155]
    v_mfma_f32_16x16x32_bf16 v[156:159], v[188:191], v[224:227], v[156:159]
    v_mfma_f32_16x16x32_bf16 v[160:163], v[188:191], v[228:231], v[160:163]
    v_mfma_f32_16x16x32_bf16 v[164:167], v[188:191], v[232:235], v[164:167]
    s_waitcnt lgkmcnt(0)
    s_barrier
    v_mfma_f32_16x16x32_bf16 v[48:51], v[192:195], v[236:239], v[48:51]
    v_add_u32 v44, s37, v14
    v_mfma_f32_16x16x32_bf16 v[52:55], v[192:195], v[240:243], v[52:55]
    ds_read_b128 v[216:219], v44
    v_mfma_f32_16x16x32_bf16 v[56:59], v[192:195], v[244:247], v[56:59]
    ds_read_b64_tr_b16 v[168:169], v8 offset:24576
    s_add_u32 m0, s58, 0
    s_add_u32 s48, s57, 0
    v_mfma_f32_16x16x32_bf16 v[60:63], v[192:195], v[248:251], v[60:63]
    ds_read_b64_tr_b16 v[170:171], v8 offset:26112
    v_mfma_f32_16x16x32_bf16 v[64:67], v[192:195], v[252:255], v[64:67]
    ds_read_b128 v[220:223], v44 offset:2048
    v_mfma_f32_16x16x32_bf16 v[68:71], v[196:199], v[236:239], v[68:71]
    v_mfma_f32_16x16x32_bf16 v[72:75], v[196:199], v[240:243], v[72:75]
    ds_read_b128 v[224:227], v44 offset:4096
    buffer_load_dwordx4 v19, s[16:19], s48 offen offset:3072 nt lds
    v_mfma_f32_16x16x32_bf16 v[76:79], v[196:199], v[244:247], v[76:79]
    ds_read_b64_tr_b16 v[172:173], v9 offset:24576
    v_mfma_f32_16x16x32_bf16 v[80:83], v[196:199], v[248:251], v[80:83]
    ds_read_b64_tr_b16 v[174:175], v9 offset:26112
    v_mfma_f32_16x16x32_bf16 v[84:87], v[196:199], v[252:255], v[84:87]
    ds_read_b128 v[228:231], v44 offset:6144
    v_mfma_f32_16x16x32_bf16 v[88:91], v[200:203], v[236:239], v[88:91]
    v_mfma_f32_16x16x32_bf16 v[92:95], v[200:203], v[240:243], v[92:95]
    ds_read_b128 v[232:235], v44 offset:8192
    s_add_u32 m0, s58, 4096
    s_add_u32 s48, s57, 4096
    v_mfma_f32_16x16x32_bf16 v[96:99], v[200:203], v[244:247], v[96:99]
    ds_read_b64_tr_b16 v[176:177], v10 offset:24576
    v_mfma_f32_16x16x32_bf16 v[100:103], v[200:203], v[248:251], v[100:103]
    ds_read_b64_tr_b16 v[178:179], v10 offset:26112
    v_mfma_f32_16x16x32_bf16 v[104:107], v[200:203], v[252:255], v[104:107]
    ds_read_b64_tr_b16 v[180:181], v11 offset:24576
    v_mfma_f32_16x16x32_bf16 v[108:111], v[204:207], v[236:239], v[108:111]
    ds_read_b64_tr_b16 v[182:183], v11 offset:26112
    buffer_load_dwordx4 v20, s[16:19], s48 offen nt lds
    v_mfma_f32_16x16x32_bf16 v[112:115], v[204:207], v[240:243], v[112:115]
    v_mfma_f32_16x16x32_bf16 v[116:119], v[204:207], v[244:247], v[116:119]
    ds_read_b64_tr_b16 v[184:185], v12 offset:24576
    v_mfma_f32_16x16x32_bf16 v[120:123], v[204:207], v[248:251], v[120:123]
    ds_read_b64_tr_b16 v[186:187], v12 offset:26112
    v_mfma_f32_16x16x32_bf16 v[124:127], v[204:207], v[252:255], v[124:127]
    ds_read_b64_tr_b16 v[188:189], v13 offset:24576
    v_mfma_f32_16x16x32_bf16 v[128:131], v[208:211], v[236:239], v[128:131]
    ds_read_b64_tr_b16 v[190:191], v13 offset:26112
    buffer_load_dwordx4 v21, s[16:19], s48 offen offset:1024 nt lds
    v_mfma_f32_16x16x32_bf16 v[132:135], v[208:211], v[240:243], v[132:135]
    v_mfma_f32_16x16x32_bf16 v[136:139], v[208:211], v[244:247], v[136:139]
    v_mfma_f32_16x16x32_bf16 v[140:143], v[208:211], v[248:251], v[140:143]
    v_mfma_f32_16x16x32_bf16 v[144:147], v[208:211], v[252:255], v[144:147]
    v_mfma_f32_16x16x32_bf16 v[148:151], v[212:215], v[236:239], v[148:151]
    v_mfma_f32_16x16x32_bf16 v[152:155], v[212:215], v[240:243], v[152:155]
    v_mfma_f32_16x16x32_bf16 v[156:159], v[212:215], v[244:247], v[156:159]
    v_mfma_f32_16x16x32_bf16 v[160:163], v[212:215], v[248:251], v[160:163]
    v_mfma_f32_16x16x32_bf16 v[164:167], v[212:215], v[252:255], v[164:167]
    s_waitcnt lgkmcnt(0)
    s_barrier
    v_mfma_f32_16x16x32_bf16 v[48:51], v[168:171], v[216:219], v[48:51]
    v_add_u32 v44, s37, v15
    v_mfma_f32_16x16x32_bf16 v[52:55], v[168:171], v[220:223], v[52:55]
    ds_read_b128 v[236:239], v44
    v_mfma_f32_16x16x32_bf16 v[56:59], v[168:171], v[224:227], v[56:59]
    ds_read_b64_tr_b16 v[192:193], v8 offset:36864
    s_add_u32 m0, s58, 4096
    s_add_u32 s48, s57, 4096
    v_mfma_f32_16x16x32_bf16 v[60:63], v[168:171], v[228:231], v[60:63]
    ds_read_b64_tr_b16 v[194:195], v8 offset:38400
    v_mfma_f32_16x16x32_bf16 v[64:67], v[168:171], v[232:235], v[64:67]
    ds_read_b128 v[240:243], v44 offset:2048
    v_mfma_f32_16x16x32_bf16 v[68:71], v[172:175], v[216:219], v[68:71]
    v_mfma_f32_16x16x32_bf16 v[72:75], v[172:175], v[220:223], v[72:75]
    ds_read_b128 v[244:247], v44 offset:4096
    buffer_load_dwordx4 v16, s[16:19], s48 offen offset:2048 nt lds
    v_mfma_f32_16x16x32_bf16 v[76:79], v[172:175], v[224:227], v[76:79]
    ds_read_b64_tr_b16 v[196:197], v9 offset:36864
    v_mfma_f32_16x16x32_bf16 v[80:83], v[172:175], v[228:231], v[80:83]
    ds_read_b64_tr_b16 v[198:199], v9 offset:38400
    v_mfma_f32_16x16x32_bf16 v[84:87], v[172:175], v[232:235], v[84:87]
    ds_read_b128 v[248:251], v44 offset:6144
    v_mfma_f32_16x16x32_bf16 v[88:91], v[176:179], v[216:219], v[88:91]
    v_mfma_f32_16x16x32_bf16 v[92:95], v[176:179], v[220:223], v[92:95]
    ds_read_b128 v[252:255], v44 offset:8192
    buffer_load_dwordx4 v17, s[16:19], s48 offen offset:3072 nt lds
    v_mfma_f32_16x16x32_bf16 v[96:99], v[176:179], v[224:227], v[96:99]
    ds_read_b64_tr_b16 v[200:201], v10 offset:36864
    v_mfma_f32_16x16x32_bf16 v[100:103], v[176:179], v[228:231], v[100:103]
    ds_read_b64_tr_b16 v[202:203], v10 offset:38400
    v_mfma_f32_16x16x32_bf16 v[104:107], v[176:179], v[232:235], v[104:107]
    ds_read_b64_tr_b16 v[204:205], v11 offset:36864
    v_mfma_f32_16x16x32_bf16 v[108:111], v[180:183], v[216:219], v[108:111]
    ds_read_b64_tr_b16 v[206:207], v11 offset:38400
    s_add_u32 m0, s58, 8192
    s_add_u32 s48, s57, 8192
    v_mfma_f32_16x16x32_bf16 v[112:115], v[180:183], v[220:223], v[112:115]
    v_mfma_f32_16x16x32_bf16 v[116:119], v[180:183], v[224:227], v[116:119]
    ds_read_b64_tr_b16 v[208:209], v12 offset:36864
    v_mfma_f32_16x16x32_bf16 v[120:123], v[180:183], v[228:231], v[120:123]
    ds_read_b64_tr_b16 v[210:211], v12 offset:38400
    v_mfma_f32_16x16x32_bf16 v[124:127], v[180:183], v[232:235], v[124:127]
    ds_read_b64_tr_b16 v[212:213], v13 offset:36864
    v_mfma_f32_16x16x32_bf16 v[128:131], v[184:187], v[216:219], v[128:131]
    ds_read_b64_tr_b16 v[214:215], v13 offset:38400
    buffer_load_dwordx4 v18, s[16:19], s48 offen nt lds
    v_mfma_f32_16x16x32_bf16 v[132:135], v[184:187], v[220:223], v[132:135]
    v_mfma_f32_16x16x32_bf16 v[136:139], v[184:187], v[224:227], v[136:139]
    v_mfma_f32_16x16x32_bf16 v[140:143], v[184:187], v[228:231], v[140:143]
    v_mfma_f32_16x16x32_bf16 v[144:147], v[184:187], v[232:235], v[144:147]
    v_mfma_f32_16x16x32_bf16 v[148:151], v[188:191], v[216:219], v[148:151]
    v_mfma_f32_16x16x32_bf16 v[152:155], v[188:191], v[220:223], v[152:155]
    v_mfma_f32_16x16x32_bf16 v[156:159], v[188:191], v[224:227], v[156:159]
    v_mfma_f32_16x16x32_bf16 v[160:163], v[188:191], v[228:231], v[160:163]
    v_mfma_f32_16x16x32_bf16 v[164:167], v[188:191], v[232:235], v[164:167]
    s_waitcnt lgkmcnt(0)
    s_barrier
    v_mfma_f32_16x16x32_bf16 v[48:51], v[192:195], v[236:239], v[48:51]
    v_add_u32 v44, s38, v14
    v_mfma_f32_16x16x32_bf16 v[52:55], v[192:195], v[240:243], v[52:55]
    ds_read_b128 v[216:219], v44
    v_mfma_f32_16x16x32_bf16 v[56:59], v[192:195], v[244:247], v[56:59]
    ds_read_b64_tr_b16 v[168:169], v8
    s_add_u32 m0, s58, 8192
    s_add_u32 s48, s57, 8192
    v_mfma_f32_16x16x32_bf16 v[60:63], v[192:195], v[248:251], v[60:63]
    ds_read_b64_tr_b16 v[170:171], v8 offset:1536
    v_mfma_f32_16x16x32_bf16 v[64:67], v[192:195], v[252:255], v[64:67]
    ds_read_b128 v[220:223], v44 offset:2048
    v_mfma_f32_16x16x32_bf16 v[68:71], v[196:199], v[236:239], v[68:71]
    v_mfma_f32_16x16x32_bf16 v[72:75], v[196:199], v[240:243], v[72:75]
    ds_read_b128 v[224:227], v44 offset:4096
    v_mfma_f32_16x16x32_bf16 v[76:79], v[196:199], v[244:247], v[76:79]
    ds_read_b64_tr_b16 v[172:173], v9
    buffer_load_dwordx4 v19, s[16:19], s48 offen offset:1024 nt lds
    v_mfma_f32_16x16x32_bf16 v[80:83], v[196:199], v[248:251], v[80:83]
    ds_read_b64_tr_b16 v[174:175], v9 offset:1536
    v_mfma_f32_16x16x32_bf16 v[84:87], v[196:199], v[252:255], v[84:87]
    ds_read_b128 v[228:231], v44 offset:6144
    v_mfma_f32_16x16x32_bf16 v[88:91], v[200:203], v[236:239], v[88:91]
    v_mfma_f32_16x16x32_bf16 v[92:95], v[200:203], v[240:243], v[92:95]
    ds_read_b128 v[232:235], v44 offset:8192
    v_mfma_f32_16x16x32_bf16 v[96:99], v[200:203], v[244:247], v[96:99]
    ds_read_b64_tr_b16 v[176:177], v10
    v_mfma_f32_16x16x32_bf16 v[100:103], v[200:203], v[248:251], v[100:103]
    ds_read_b64_tr_b16 v[178:179], v10 offset:1536
    buffer_load_dwordx4 v20, s[16:19], s48 offen offset:2048 nt lds
    v_mfma_f32_16x16x32_bf16 v[104:107], v[200:203], v[252:255], v[104:107]
    ds_read_b64_tr_b16 v[180:181], v11
    v_mfma_f32_16x16x32_bf16 v[108:111], v[204:207], v[236:239], v[108:111]
    ds_read_b64_tr_b16 v[182:183], v11 offset:1536
    v_mfma_f32_16x16x32_bf16 v[112:115], v[204:207], v[240:243], v[112:115]
    v_mfma_f32_16x16x32_bf16 v[116:119], v[204:207], v[244:247], v[116:119]
    ds_read_b64_tr_b16 v[184:185], v12
    v_mfma_f32_16x16x32_bf16 v[120:123], v[204:207], v[248:251], v[120:123]
    ds_read_b64_tr_b16 v[186:187], v12 offset:1536
    v_mfma_f32_16x16x32_bf16 v[124:127], v[204:207], v[252:255], v[124:127]
    ds_read_b64_tr_b16 v[188:189], v13
    buffer_load_dwordx4 v21, s[16:19], s48 offen offset:3072 nt lds
    v_mfma_f32_16x16x32_bf16 v[128:131], v[208:211], v[236:239], v[128:131]
    ds_read_b64_tr_b16 v[190:191], v13 offset:1536
    v_mfma_f32_16x16x32_bf16 v[132:135], v[208:211], v[240:243], v[132:135]
    v_mfma_f32_16x16x32_bf16 v[136:139], v[208:211], v[244:247], v[136:139]
    v_mfma_f32_16x16x32_bf16 v[140:143], v[208:211], v[248:251], v[140:143]
    v_mfma_f32_16x16x32_bf16 v[144:147], v[208:211], v[252:255], v[144:147]
    v_mfma_f32_16x16x32_bf16 v[148:151], v[212:215], v[236:239], v[148:151]
    v_mfma_f32_16x16x32_bf16 v[152:155], v[212:215], v[240:243], v[152:155]
    v_mfma_f32_16x16x32_bf16 v[156:159], v[212:215], v[244:247], v[156:159]
    v_mfma_f32_16x16x32_bf16 v[160:163], v[212:215], v[248:251], v[160:163]
    v_mfma_f32_16x16x32_bf16 v[164:167], v[212:215], v[252:255], v[164:167]
    s_waitcnt lgkmcnt(0)
    s_barrier
    s_sub_u32 s31, 5, s56
    s_and_b32 s48, s31, 1
    s_mul_i32 s48, s48, 98304
    s_lshr_b32 s31, s31, 1
    s_mul_i32 s31, s31, 12288
    s_add_u32 s57, s31, s48
    s_add_u32 s58, s58, 12288
    s_mov_b32 s31, s36
    s_mov_b32 s36, s38
    s_mov_b32 s38, s37
    s_mov_b32 s37, s31
    s_sub_u32 s56, s56, 1
    s_cmp_lg_u32 s56, 0
    s_cbranch_scc1 L_LOOP_K
L_QTAIL:
    v_mfma_f32_16x16x32_bf16 v[48:51], v[168:171], v[216:219], v[48:51]
    v_add_u32 v44, s36, v15
    s_lshl_b32 s98, s96, 2
    v_add_u32 v1, 0, v0
    v_mfma_f32_16x16x32_bf16 v[52:55], v[168:171], v[220:223], v[52:55]
    ds_read_b128 v[236:239], v44
    v_mul_u32_u24 v4, 0xaab, v1
    v_mfma_f32_16x16x32_bf16 v[56:59], v[168:171], v[224:227], v[56:59]
    ds_read_b64_tr_b16 v[192:193], v8 offset:12288
    v_lshrrev_b32 v4, 16, v4
    v_mfma_f32_16x16x32_bf16 v[60:63], v[168:171], v[228:231], v[60:63]
    ds_read_b64_tr_b16 v[194:195], v8 offset:13824
    v_mul_u32_u24 v6, 24, v4
    v_sub_u32 v5, v1, v6
    v_mfma_f32_16x16x32_bf16 v[64:67], v[168:171], v[232:235], v[64:67]
    ds_read_b128 v[240:243], v44 offset:2048
    v_lshrrev_b32 v7, 1, v4
    v_mfma_f32_16x16x32_bf16 v[68:71], v[172:175], v[216:219], v[68:71]
    v_add_u32 v7, s98, v7
    v_mfma_f32_16x16x32_bf16 v[72:75], v[172:175], v[220:223], v[72:75]
    ds_read_b128 v[244:247], v44 offset:4096
    v_xor_b32 v5, v5, v7
    v_mfma_f32_16x16x32_bf16 v[76:79], v[172:175], v[224:227], v[76:79]
    ds_read_b64_tr_b16 v[196:197], v9 offset:12288
    v_lshlrev_b32 v5, 4, v5
    v_mul_u32_u24 v4, 0x180, v4
    v_mfma_f32_16x16x32_bf16 v[80:83], v[172:175], v[228:231], v[80:83]
    ds_read_b64_tr_b16 v[198:199], v9 offset:13824
    v_add_u32 v30, v4, v5
    v_mfma_f32_16x16x32_bf16 v[84:87], v[172:175], v[232:235], v[84:87]
    ds_read_b128 v[248:251], v44 offset:6144
    v_add_u32 v1, 64, v0
    v_mfma_f32_16x16x32_bf16 v[88:91], v[176:179], v[216:219], v[88:91]
    v_mul_u32_u24 v4, 0xaab, v1
    v_lshrrev_b32 v4, 16, v4
    v_mfma_f32_16x16x32_bf16 v[92:95], v[176:179], v[220:223], v[92:95]
    ds_read_b128 v[252:255], v44 offset:8192
    v_mul_u32_u24 v6, 24, v4
    v_mfma_f32_16x16x32_bf16 v[96:99], v[176:179], v[224:227], v[96:99]
    ds_read_b64_tr_b16 v[200:201], v10 offset:12288
    v_sub_u32 v5, v1, v6
    v_mfma_f32_16x16x32_bf16 v[100:103], v[176:179], v[228:231], v[100:103]
    ds_read_b64_tr_b16 v[202:203], v10 offset:13824
    v_lshrrev_b32 v7, 1, v4
    v_mfma_f32_16x16x32_bf16 v[104:107], v[176:179], v[232:235], v[104:107]
    ds_read_b64_tr_b16 v[204:205], v11 offset:12288
    v_add_u32 v7, s98, v7
    v_xor_b32 v5, v5, v7
    v_mfma_f32_16x16x32_bf16 v[108:111], v[180:183], v[216:219], v[108:111]
    ds_read_b64_tr_b16 v[206:207], v11 offset:13824
    v_lshlrev_b32 v5, 4, v5
    v_mfma_f32_16x16x32_bf16 v[112:115], v[180:183], v[220:223], v[112:115]
    v_mul_u32_u24 v4, 0x180, v4
    v_mfma_f32_16x16x32_bf16 v[116:119], v[180:183], v[224:227], v[116:119]
    ds_read_b64_tr_b16 v[208:209], v12 offset:12288
    v_add_u32 v31, v4, v5
    v_mfma_f32_16x16x32_bf16 v[120:123], v[180:183], v[228:231], v[120:123]
    ds_read_b64_tr_b16 v[210:211], v12 offset:13824
    v_subrev_u32 v31, 0x400, v31
    v_add_u32 v1, 0x80, v0
    v_mfma_f32_16x16x32_bf16 v[124:127], v[180:183], v[232:235], v[124:127]
    ds_read_b64_tr_b16 v[212:213], v13 offset:12288
    v_mul_u32_u24 v4, 0xaab, v1
    v_mfma_f32_16x16x32_bf16 v[128:131], v[184:187], v[216:219], v[128:131]
    ds_read_b64_tr_b16 v[214:215], v13 offset:13824
    v_lshrrev_b32 v4, 16, v4
    v_mfma_f32_16x16x32_bf16 v[132:135], v[184:187], v[220:223], v[132:135]
    v_mul_u32_u24 v6, 24, v4
    v_sub_u32 v5, v1, v6
    v_mfma_f32_16x16x32_bf16 v[136:139], v[184:187], v[224:227], v[136:139]
    v_lshrrev_b32 v7, 1, v4
    v_mfma_f32_16x16x32_bf16 v[140:143], v[184:187], v[228:231], v[140:143]
    v_add_u32 v7, s98, v7
    v_mfma_f32_16x16x32_bf16 v[144:147], v[184:187], v[232:235], v[144:147]
    v_xor_b32 v5, v5, v7
    v_mfma_f32_16x16x32_bf16 v[148:151], v[188:191], v[216:219], v[148:151]
    v_lshlrev_b32 v5, 4, v5
    v_mul_u32_u24 v4, 0x180, v4
    v_mfma_f32_16x16x32_bf16 v[152:155], v[188:191], v[220:223], v[152:155]
    v_add_u32 v32, v4, v5
    v_mfma_f32_16x16x32_bf16 v[156:159], v[188:191], v[224:227], v[156:159]
    v_subrev_u32 v32, 0x800, v32
    v_mfma_f32_16x16x32_bf16 v[160:163], v[188:191], v[228:231], v[160:163]
    s_mul_i32 s52, s28, 3072
    v_mfma_f32_16x16x32_bf16 v[164:167], v[188:191], v[232:235], v[164:167]
    s_cmp_eq_u32 s28, 3
    s_cbranch_scc1 L_QT_K
    s_waitcnt vmcnt(0)
    s_branch L_QT_J
L_QT_K:
    s_waitcnt vmcnt(48)
    s_lshl_b32 s48, s29, 5
    s_add_u32 s48, s48, s30
    v_mov_b32 v1, 1
    v_mov_b32 v4, 0
    buffer_store_byte v1, v4, s[60:63], s48 offen sc1
L_QT_J:
    s_waitcnt lgkmcnt(0)
    s_barrier
    v_mfma_f32_16x16x32_bf16 v[48:51], v[192:195], v[236:239], v[48:51]
    v_add_u32 v44, s37, v14
    s_add_u32 m0, s52, 110592
    s_add_u32 s48, s52, 24576
    v_mfma_f32_16x16x32_bf16 v[52:55], v[192:195], v[240:243], v[52:55]
    ds_read_b128 v[216:219], v44
    v_mfma_f32_16x16x32_bf16 v[56:59], v[192:195], v[244:247], v[56:59]
    ds_read_b64_tr_b16 v[168:169], v8 offset:24576
    v_mfma_f32_16x16x32_bf16 v[60:63], v[192:195], v[248:251], v[60:63]
    ds_read_b64_tr_b16 v[170:171], v8 offset:26112
    buffer_load_dwordx4 v30, s[16:19], s48 offen nt lds
    v_mfma_f32_16x16x32_bf16 v[64:67], v[192:195], v[252:255], v[64:67]
    ds_read_b128 v[220:223], v44 offset:2048
    v_mfma_f32_16x16x32_bf16 v[68:71], v[196:199], v[236:239], v[68:71]
    v_mfma_f32_16x16x32_bf16 v[72:75], v[196:199], v[240:243], v[72:75]
    ds_read_b128 v[224:227], v44 offset:4096
    v_mfma_f32_16x16x32_bf16 v[76:79], v[196:199], v[244:247], v[76:79]
    ds_read_b64_tr_b16 v[172:173], v9 offset:24576
    buffer_load_dwordx4 v31, s[16:19], s48 offen offset:1024 nt lds
    v_mfma_f32_16x16x32_bf16 v[80:83], v[196:199], v[248:251], v[80:83]
    ds_read_b64_tr_b16 v[174:175], v9 offset:26112
    v_mfma_f32_16x16x32_bf16 v[84:87], v[196:199], v[252:255], v[84:87]
    ds_read_b128 v[228:231], v44 offset:6144
    v_mfma_f32_16x16x32_bf16 v[88:91], v[200:203], v[236:239], v[88:91]
    buffer_load_dwordx4 v32, s[16:19], s48 offen offset:2048 nt lds
    v_mfma_f32_16x16x32_bf16 v[92:95], v[200:203], v[240:243], v[92:95]
    ds_read_b128 v[232:235], v44 offset:8192
    v_mfma_f32_16x16x32_bf16 v[96:99], v[200:203], v[244:247], v[96:99]
    ds_read_b64_tr_b16 v[176:177], v10 offset:24576
    v_mfma_f32_16x16x32_bf16 v[100:103], v[200:203], v[248:251], v[100:103]
    ds_read_b64_tr_b16 v[178:179], v10 offset:26112
    v_mfma_f32_16x16x32_bf16 v[104:107], v[200:203], v[252:255], v[104:107]
    ds_read_b64_tr_b16 v[180:181], v11 offset:24576
    s_add_u32 m0, s52, 122880
    s_add_u32 s48, s52, 122880
    v_mfma_f32_16x16x32_bf16 v[108:111], v[204:207], v[236:239], v[108:111]
    ds_read_b64_tr_b16 v[182:183], v11 offset:26112
    v_mfma_f32_16x16x32_bf16 v[112:115], v[204:207], v[240:243], v[112:115]
    v_mfma_f32_16x16x32_bf16 v[116:119], v[204:207], v[244:247], v[116:119]
    ds_read_b64_tr_b16 v[184:185], v12 offset:24576
    v_mfma_f32_16x16x32_bf16 v[120:123], v[204:207], v[248:251], v[120:123]
    ds_read_b64_tr_b16 v[186:187], v12 offset:26112
    buffer_load_dwordx4 v30, s[16:19], s48 offen nt lds
    v_mfma_f32_16x16x32_bf16 v[124:127], v[204:207], v[252:255], v[124:127]
    ds_read_b64_tr_b16 v[188:189], v13 offset:24576
    v_mfma_f32_16x16x32_bf16 v[128:131], v[208:211], v[236:239], v[128:131]
    ds_read_b64_tr_b16 v[190:191], v13 offset:26112
    v_mfma_f32_16x16x32_bf16 v[132:135], v[208:211], v[240:243], v[132:135]
    buffer_load_dwordx4 v31, s[16:19], s48 offen offset:1024 nt lds
    v_mfma_f32_16x16x32_bf16 v[136:139], v[208:211], v[244:247], v[136:139]
    v_mfma_f32_16x16x32_bf16 v[140:143], v[208:211], v[248:251], v[140:143]
    v_mfma_f32_16x16x32_bf16 v[144:147], v[208:211], v[252:255], v[144:147]
    v_mfma_f32_16x16x32_bf16 v[148:151], v[212:215], v[236:239], v[148:151]
    buffer_load_dwordx4 v32, s[16:19], s48 offen offset:2048 nt lds
    v_mfma_f32_16x16x32_bf16 v[152:155], v[212:215], v[240:243], v[152:155]
    v_mfma_f32_16x16x32_bf16 v[156:159], v[212:215], v[244:247], v[156:159]
    v_mfma_f32_16x16x32_bf16 v[160:163], v[212:215], v[248:251], v[160:163]
    v_mfma_f32_16x16x32_bf16 v[164:167], v[212:215], v[252:255], v[164:167]
    s_waitcnt lgkmcnt(0)
    s_barrier
    v_mfma_f32_16x16x32_bf16 v[48:51], v[168:171], v[216:219], v[48:51]
    v_add_u32 v44, s37, v15
    s_mul_i32 s98, s97, 12288
    v_mfma_f32_16x16x32_bf16 v[52:55], v[168:171], v[220:223], v[52:55]
    ds_read_b128 v[236:239], v44
    v_mul_u32_u24 v1, 0x180, v2
    v_mfma_f32_16x16x32_bf16 v[56:59], v[168:171], v[224:227], v[56:59]
    ds_read_b64_tr_b16 v[192:193], v8 offset:36864
    v_add_u32 v1, s98, v1
    v_mfma_f32_16x16x32_bf16 v[60:63], v[168:171], v[228:231], v[60:63]
    ds_read_b64_tr_b16 v[194:195], v8 offset:38400
    v_mfma_f32_16x16x32_bf16 v[64:67], v[168:171], v[232:235], v[64:67]
    ds_read_b128 v[240:243], v44 offset:2048
    v_bfe_u32 v7, v2, 1, 3
    v_mfma_f32_16x16x32_bf16 v[68:71], v[172:175], v[216:219], v[68:71]
    v_xor_b32 v4, v3, v7
    v_mfma_f32_16x16x32_bf16 v[72:75], v[172:175], v[220:223], v[72:75]
    ds_read_b128 v[244:247], v44 offset:4096
    v_lshl_add_u32 v24, v4, 4, v1
    v_mfma_f32_16x16x32_bf16 v[76:79], v[172:175], v[224:227], v[76:79]
    ds_read_b64_tr_b16 v[196:197], v9 offset:36864
    v_mfma_f32_16x16x32_bf16 v[80:83], v[172:175], v[228:231], v[80:83]
    ds_read_b64_tr_b16 v[198:199], v9 offset:38400
    v_xor_b32 v4, 4, v4
    v_mfma_f32_16x16x32_bf16 v[84:87], v[172:175], v[232:235], v[84:87]
    ds_read_b128 v[248:251], v44 offset:6144
    v_lshl_add_u32 v25, v4, 4, v1
    v_mfma_f32_16x16x32_bf16 v[88:91], v[176:179], v[216:219], v[88:91]
    v_mfma_f32_16x16x32_bf16 v[92:95], v[176:179], v[220:223], v[92:95]
    ds_read_b128 v[252:255], v44 offset:8192
    s_mul_i32 s98, s97, 30720
    v_mfma_f32_16x16x32_bf16 v[96:99], v[176:179], v[224:227], v[96:99]
    ds_read_b64_tr_b16 v[200:201], v10 offset:36864
    s_mul_i32 s99, s96, 5120
    v_mfma_f32_16x16x32_bf16 v[100:103], v[176:179], v[228:231], v[100:103]
    ds_read_b64_tr_b16 v[202:203], v10 offset:38400
    s_add_u32 s98, s98, s99
    v_mfma_f32_16x16x32_bf16 v[104:107], v[176:179], v[232:235], v[104:107]
    ds_read_b64_tr_b16 v[204:205], v11 offset:36864
    v_mfma_f32_16x16x32_bf16 v[108:111], v[180:183], v[216:219], v[108:111]
    ds_read_b64_tr_b16 v[206:207], v11 offset:38400
    s_add_u32 s98, s98, 49152
    v_mfma_f32_16x16x32_bf16 v[112:115], v[180:183], v[220:223], v[112:115]
    v_lshrrev_b32 v1, 1, v3
    v_mfma_f32_16x16x32_bf16 v[116:119], v[180:183], v[224:227], v[116:119]
    ds_read_b64_tr_b16 v[208:209], v12 offset:36864
    v_lshl_add_u32 v1, v1, 4, v2
    v_mfma_f32_16x16x32_bf16 v[120:123], v[180:183], v[228:231], v[120:123]
    ds_read_b64_tr_b16 v[210:211], v12 offset:38400
    v_mfma_f32_16x16x32_bf16 v[124:127], v[180:183], v[232:235], v[124:127]
    ds_read_b64_tr_b16 v[212:213], v13 offset:36864
    v_lshlrev_b32 v1, 4, v1
    v_mfma_f32_16x16x32_bf16 v[128:131], v[184:187], v[216:219], v[128:131]
    ds_read_b64_tr_b16 v[214:215], v13 offset:38400
    v_and_b32 v4, 1, v3
    v_mfma_f32_16x16x32_bf16 v[132:135], v[184:187], v[220:223], v[132:135]
    v_mfma_f32_16x16x32_bf16 v[136:139], v[184:187], v[224:227], v[136:139]
    v_lshl_add_u32 v1, v4, 3, v1
    v_mfma_f32_16x16x32_bf16 v[140:143], v[184:187], v[228:231], v[140:143]
    v_add_u32 v22, s98, v1
    v_mfma_f32_16x16x32_bf16 v[144:147], v[184:187], v[232:235], v[144:147]
    s_add_u32 s99, s99, 49152
    v_mfma_f32_16x16x32_bf16 v[148:151], v[188:191], v[216:219], v[148:151]
    v_mfma_f32_16x16x32_bf16 v[152:155], v[188:191], v[220:223], v[152:155]
    v_lshlrev_b32 v1, 4, v0
    v_mfma_f32_16x16x32_bf16 v[156:159], v[188:191], v[224:227], v[156:159]
    v_add_u32 v23, s99, v1
    v_mfma_f32_16x16x32_bf16 v[160:163], v[188:191], v[228:231], v[160:163]
    v_mfma_f32_16x16x32_bf16 v[164:167], v[188:191], v[232:235], v[164:167]
    s_waitcnt lgkmcnt(0)
    s_barrier
    v_mfma_f32_16x16x32_bf16 v[48:51], v[192:195], v[236:239], v[48:51]
    v_mfma_f32_16x16x32_bf16 v[52:55], v[192:195], v[240:243], v[52:55]
    s_add_u32 m0, s52, 135168
    s_add_u32 s48, s52, 36864
    v_lshrrev_b32 v1, 3, v0
    v_mfma_f32_16x16x32_bf16 v[56:59], v[192:195], v[244:247], v[56:59]
    buffer_load_dwordx4 v30, s[16:19], s48 offen nt lds
    v_mul_u32_u24 v1, 0x180, v1
    v_mfma_f32_16x16x32_bf16 v[60:63], v[192:195], v[248:251], v[60:63]
    v_bfe_u32 v4, v0, 1, 2
    v_mfma_f32_16x16x32_bf16 v[64:67], v[192:195], v[252:255], v[64:67]
    buffer_load_dwordx4 v31, s[16:19], s48 offen offset:1024 nt lds
    v_bfe_u32 v7, v0, 4, 2
    v_mfma_f32_16x16x32_bf16 v[68:71], v[196:199], v[236:239], v[68:71]
    buffer_load_dwordx4 v32, s[16:19], s48 offen offset:2048 nt lds
    v_xor_b32 v4, v4, v7
    v_mfma_f32_16x16x32_bf16 v[72:75], v[196:199], v[240:243], v[72:75]
    v_lshl_add_u32 v1, v4, 5, v1
    v_mfma_f32_16x16x32_bf16 v[76:79], v[196:199], v[244:247], v[76:79]
    s_add_u32 m0, s52, 147456
    s_add_u32 s48, s52, 135168
    v_mfma_f32_16x16x32_bf16 v[80:83], v[196:199], v[248:251], v[80:83]
    buffer_load_dwordx4 v30, s[16:19], s48 offen nt lds
    v_and_b32 v4, 1, v0
    v_mfma_f32_16x16x32_bf16 v[84:87], v[196:199], v[252:255], v[84:87]
    v_lshl_add_u32 v33, v4, 4, v1
    v_mfma_f32_16x16x32_bf16 v[88:91], v[200:203], v[236:239], v[88:91]
    buffer_load_dwordx4 v31, s[16:19], s48 offen offset:1024 nt lds
    s_lshl_b32 s53, s28, 12
    v_mfma_f32_16x16x32_bf16 v[92:95], v[200:203], v[240:243], v[92:95]
    buffer_load_dwordx4 v32, s[16:19], s48 offen offset:2048 nt lds
    s_lshl_b32 s98, s97, 8
    v_mfma_f32_16x16x32_bf16 v[96:99], v[200:203], v[244:247], v[96:99]
    s_lshl_b32 s99, s96, 5
    v_mfma_f32_16x16x32_bf16 v[100:103], v[200:203], v[248:251], v[100:103]
    s_add_u32 s98, s98, s99
    v_mfma_f32_16x16x32_bf16 v[104:107], v[200:203], v[252:255], v[104:107]
    v_mfma_f32_16x16x32_bf16 v[108:111], v[204:207], v[236:239], v[108:111]
    s_mul_i32 s54, s98, 384
    v_mfma_f32_16x16x32_bf16 v[112:115], v[204:207], v[240:243], v[112:115]
    v_lshrrev_b32 v1, 2, v2
    v_mfma_f32_16x16x32_bf16 v[116:119], v[204:207], v[244:247], v[116:119]
    v_lshl_add_u32 v4, v3, 2, v1
    v_mfma_f32_16x16x32_bf16 v[120:123], v[204:207], v[248:251], v[120:123]
    v_bfe_u32 v7, v4, 1, 2
    v_mfma_f32_16x16x32_bf16 v[124:127], v[204:207], v[252:255], v[124:127]
    s_lshl_b32 s98, s97, 1
    v_mfma_f32_16x16x32_bf16 v[128:131], v[208:211], v[236:239], v[128:131]
    v_xor_b32 v7, s98, v7
    v_mfma_f32_16x16x32_bf16 v[132:135], v[208:211], v[240:243], v[132:135]
    v_mfma_f32_16x16x32_bf16 v[136:139], v[208:211], v[244:247], v[136:139]
    v_lshlrev_b32 v4, 7, v4
    v_mfma_f32_16x16x32_bf16 v[140:143], v[208:211], v[248:251], v[140:143]
    v_lshl_add_u32 v4, v7, 5, v4
    v_mfma_f32_16x16x32_bf16 v[144:147], v[208:211], v[252:255], v[144:147]
    v_and_b32 v1, 3, v2
    v_mfma_f32_16x16x32_bf16 v[148:151], v[212:215], v[236:239], v[148:151]
    v_lshl_add_u32 v4, v1, 3, v4
    v_mfma_f32_16x16x32_bf16 v[152:155], v[212:215], v[240:243], v[152:155]
    s_lshl_b32 s98, s97, 13
    v_mfma_f32_16x16x32_bf16 v[156:159], v[212:215], v[244:247], v[156:159]
    v_add_u32 v34, s98, v4
    v_mfma_f32_16x16x32_bf16 v[160:163], v[212:215], v[248:251], v[160:163]
    v_mfma_f32_16x16x32_bf16 v[164:167], v[212:215], v[252:255], v[164:167]
    v_cvt_pk_bf16_f32 v168, v48, v49
    v_cvt_pk_bf16_f32 v169, v50, v51
    ds_write_b64 v22, v[168:169]
    v_cvt_pk_bf16_f32 v170, v52, v53
    v_cvt_pk_bf16_f32 v171, v54, v55
    ds_write_b64 v22, v[170:171] offset:1024
    v_cvt_pk_bf16_f32 v172, v56, v57
    v_cvt_pk_bf16_f32 v173, v58, v59
    ds_write_b64 v22, v[172:173] offset:2048
    v_cvt_pk_bf16_f32 v174, v60, v61
    v_cvt_pk_bf16_f32 v175, v62, v63
    ds_write_b64 v22, v[174:175] offset:3072
    v_cvt_pk_bf16_f32 v176, v64, v65
    v_cvt_pk_bf16_f32 v177, v66, v67
    ds_write_b64 v22, v[176:177] offset:4096
    v_cvt_pk_bf16_f32 v178, v68, v69
    v_cvt_pk_bf16_f32 v179, v70, v71
    ds_write_b64 v22, v[178:179] offset:512
    v_cvt_pk_bf16_f32 v180, v72, v73
    v_cvt_pk_bf16_f32 v181, v74, v75
    ds_write_b64 v22, v[180:181] offset:1536
    v_cvt_pk_bf16_f32 v182, v76, v77
    v_cvt_pk_bf16_f32 v183, v78, v79
    ds_write_b64 v22, v[182:183] offset:2560
    v_cvt_pk_bf16_f32 v184, v80, v81
    v_cvt_pk_bf16_f32 v185, v82, v83
    ds_write_b64 v22, v[184:185] offset:3584
    v_cvt_pk_bf16_f32 v186, v84, v85
    v_cvt_pk_bf16_f32 v187, v86, v87
    ds_write_b64 v22, v[186:187] offset:4608
    v_cvt_pk_bf16_f32 v188, v88, v89
    v_cvt_pk_bf16_f32 v189, v90, v91
    ds_write_b64 v22, v[188:189] offset:10240
    v_cvt_pk_bf16_f32 v190, v92, v93
    v_cvt_pk_bf16_f32 v191, v94, v95
    ds_write_b64 v22, v[190:191] offset:11264
    v_cvt_pk_bf16_f32 v168, v96, v97
    v_cvt_pk_bf16_f32 v169, v98, v99
    ds_write_b64 v22, v[168:169] offset:12288
    v_cvt_pk_bf16_f32 v170, v100, v101
    v_cvt_pk_bf16_f32 v171, v102, v103
    ds_write_b64 v22, v[170:171] offset:13312
    v_cvt_pk_bf16_f32 v172, v104, v105
    v_cvt_pk_bf16_f32 v173, v106, v107
    ds_write_b64 v22, v[172:173] offset:14336
    v_cvt_pk_bf16_f32 v174, v108, v109
    v_cvt_pk_bf16_f32 v175, v110, v111
    ds_write_b64 v22, v[174:175] offset:10752
    v_cvt_pk_bf16_f32 v176, v112, v113
    v_cvt_pk_bf16_f32 v177, v114, v115
    ds_write_b64 v22, v[176:177] offset:11776
    v_cvt_pk_bf16_f32 v178, v116, v117
    v_cvt_pk_bf16_f32 v179, v118, v119
    ds_write_b64 v22, v[178:179] offset:12800
    v_cvt_pk_bf16_f32 v180, v120, v121
    v_cvt_pk_bf16_f32 v181, v122, v123
    ds_write_b64 v22, v[180:181] offset:13824
    v_cvt_pk_bf16_f32 v182, v124, v125
    v_cvt_pk_bf16_f32 v183, v126, v127
    ds_write_b64 v22, v[182:183] offset:14848
    v_cvt_pk_bf16_f32 v184, v128, v129
    v_cvt_pk_bf16_f32 v185, v130, v131
    ds_write_b64 v22, v[184:185] offset:20480
    v_cvt_pk_bf16_f32 v186, v132, v133
    v_cvt_pk_bf16_f32 v187, v134, v135
    ds_write_b64 v22, v[186:187] offset:21504
    v_cvt_pk_bf16_f32 v188, v136, v137
    v_cvt_pk_bf16_f32 v189, v138, v139
    ds_write_b64 v22, v[188:189] offset:22528
    v_cvt_pk_bf16_f32 v190, v140, v141
    v_cvt_pk_bf16_f32 v191, v142, v143
    ds_write_b64 v22, v[190:191] offset:23552
    v_cvt_pk_bf16_f32 v168, v144, v145
    v_cvt_pk_bf16_f32 v169, v146, v147
    ds_write_b64 v22, v[168:169] offset:24576
    v_cvt_pk_bf16_f32 v170, v148, v149
    v_cvt_pk_bf16_f32 v171, v150, v151
    ds_write_b64 v22, v[170:171] offset:20992
    v_cvt_pk_bf16_f32 v172, v152, v153
    v_cvt_pk_bf16_f32 v173, v154, v155
    ds_write_b64 v22, v[172:173] offset:22016
    v_cvt_pk_bf16_f32 v174, v156, v157
    v_cvt_pk_bf16_f32 v175, v158, v159
    ds_write_b64 v22, v[174:175] offset:23040
    v_cvt_pk_bf16_f32 v176, v160, v161
    v_cvt_pk_bf16_f32 v177, v162, v163
    ds_write_b64 v22, v[176:177] offset:24064
    v_cvt_pk_bf16_f32 v178, v164, v165
    v_cvt_pk_bf16_f32 v179, v166, v167
    ds_write_b64 v22, v[178:179] offset:25088
    s_waitcnt lgkmcnt(0)
    s_barrier
    ds_read_b128 a[0:3], v23
    ds_read_b128 a[4:7], v23 offset:1024
    ds_read_b128 a[8:11], v23 offset:2048
    ds_read_b128 a[12:15], v23 offset:3072
    ds_read_b128 a[16:19], v23 offset:4096
    ds_read_b128 a[20:23], v23 offset:10240
    ds_read_b128 a[24:27], v23 offset:11264
    ds_read_b128 a[28:31], v23 offset:12288
    ds_read_b128 a[32:35], v23 offset:13312
    ds_read_b128 a[36:39], v23 offset:14336
    ds_read_b128 a[40:43], v23 offset:20480
    ds_read_b128 a[44:47], v23 offset:21504
    ds_read_b128 a[48:51], v23 offset:22528
    ds_read_b128 a[52:55], v23 offset:23552
    ds_read_b128 a[56:59], v23 offset:24576
    ds_read_b128 a[60:63], v23 offset:30720
    ds_read_b128 a[64:67], v23 offset:31744
    ds_read_b128 a[68:71], v23 offset:32768
    ds_read_b128 a[72:75], v23 offset:33792
    ds_read_b128 a[76:79], v23 offset:34816
    ds_read_b128 a[80:83], v23 offset:40960
    ds_read_b128 a[84:87], v23 offset:41984
    ds_read_b128 a[88:91], v23 offset:43008
    ds_read_b128 a[92:95], v23 offset:44032
    ds_read_b128 a[96:99], v23 offset:45056
    ds_read_b128 a[100:103], v23 offset:51200
    ds_read_b128 a[104:107], v23 offset:52224
    ds_read_b128 a[108:111], v23 offset:53248
    ds_read_b128 a[112:115], v23 offset:54272
    ds_read_b128 a[116:119], v23 offset:55296
    s_waitcnt vmcnt(12) lgkmcnt(0)
    s_barrier
    v_add_u32 v26, 0, v24
    v_add_u32 v27, 0, v25
    ds_read_b128 a[120:123], v26
    ds_read_b128 a[124:127], v27
    ds_read_b128 a[128:131], v26 offset:128
    s_waitcnt lgkmcnt(2)
    v_mfma_f32_16x16x32_bf16 v[48:51], a[120:123], a[0:3], 0
    v_mfma_f32_16x16x32_bf16 v[56:59], a[120:123], a[4:7], 0
    ds_read_b128 a[132:135], v27 offset:128
    s_add_u32 m0, s52, 49152
    s_add_u32 s48, s52, 49152
    v_mfma_f32_16x16x32_bf16 v[64:67], a[120:123], a[8:11], 0
    v_mfma_f32_16x16x32_bf16 v[72:75], a[120:123], a[12:15], 0
    v_mfma_f32_16x16x32_bf16 v[80:83], a[120:123], a[16:19], 0
    s_waitcnt lgkmcnt(2)
    v_mfma_f32_16x16x32_bf16 v[48:51], a[124:127], a[20:23], v[48:51]
    v_mfma_f32_16x16x32_bf16 v[56:59], a[124:127], a[24:27], v[56:59]
    ds_read_b128 a[120:123], v26 offset:256
    v_mfma_f32_16x16x32_bf16 v[64:67], a[124:127], a[28:31], v[64:67]
    v_mfma_f32_16x16x32_bf16 v[72:75], a[124:127], a[32:35], v[72:75]
    buffer_load_dwordx4 v30, s[16:19], s48 offen nt lds
    v_mfma_f32_16x16x32_bf16 v[80:83], a[124:127], a[36:39], v[80:83]
    s_waitcnt lgkmcnt(2)
    v_mfma_f32_16x16x32_bf16 v[48:51], a[128:131], a[40:43], v[48:51]
    v_mfma_f32_16x16x32_bf16 v[56:59], a[128:131], a[44:47], v[56:59]
    ds_read_b128 a[124:127], v27 offset:256
    v_mfma_f32_16x16x32_bf16 v[64:67], a[128:131], a[48:51], v[64:67]
    v_mfma_f32_16x16x32_bf16 v[72:75], a[128:131], a[52:55], v[72:75]
    v_mfma_f32_16x16x32_bf16 v[80:83], a[128:131], a[56:59], v[80:83]
    s_waitcnt lgkmcnt(2)
    v_mfma_f32_16x16x32_bf16 v[48:51], a[132:135], a[60:63], v[48:51]
    buffer_load_dwordx4 v31, s[16:19], s48 offen offset:1024 nt lds
    v_mfma_f32_16x16x32_bf16 v[56:59], a[132:135], a[64:67], v[56:59]
    ds_read_b128 a[128:131], v26 offset:6144
    v_mfma_f32_16x16x32_bf16 v[64:67], a[132:135], a[68:71], v[64:67]
    v_mfma_f32_16x16x32_bf16 v[72:75], a[132:135], a[72:75], v[72:75]
    v_mfma_f32_16x16x32_bf16 v[80:83], a[132:135], a[76:79], v[80:83]
    s_waitcnt lgkmcnt(2)
    v_mfma_f32_16x16x32_bf16 v[48:51], a[120:123], a[80:83], v[48:51]
    v_mfma_f32_16x16x32_bf16 v[56:59], a[120:123], a[84:87], v[56:59]
    ds_read_b128 a[132:135], v27 offset:6144
    v_mfma_f32_16x16x32_bf16 v[64:67], a[120:123], a[88:91], v[64:67]
    buffer_load_dwordx4 v32, s[16:19], s48 offen offset:2048 nt lds
    v_mfma_f32_16x16x32_bf16 v[72:75], a[120:123], a[92:95], v[72:75]
    v_mfma_f32_16x16x32_bf16 v[80:83], a[120:123], a[96:99], v[80:83]
    s_waitcnt lgkmcnt(2)
    v_mfma_f32_16x16x32_bf16 v[48:51], a[124:127], a[100:103], v[48:51]
    v_mfma_f32_16x16x32_bf16 v[56:59], a[124:127], a[104:107], v[56:59]
    ds_read_b128 a[120:123], v26 offset:6272
    v_mfma_f32_16x16x32_bf16 v[64:67], a[124:127], a[108:111], v[64:67]
    v_mfma_f32_16x16x32_bf16 v[72:75], a[124:127], a[112:115], v[72:75]
    v_mfma_f32_16x16x32_bf16 v[80:83], a[124:127], a[116:119], v[80:83]
    s_waitcnt lgkmcnt(2)
    v_mfma_f32_16x16x32_bf16 v[52:55], a[128:131], a[0:3], 0
    v_mfma_f32_16x16x32_bf16 v[60:63], a[128:131], a[4:7], 0
    ds_read_b128 a[124:127], v27 offset:6272
    s_add_u32 m0, s52, 61440
    s_add_u32 s48, s52, 147456
    v_mfma_f32_16x16x32_bf16 v[68:71], a[128:131], a[8:11], 0
    v_max3_f32 v248, v48, v49, v50
    v_mfma_f32_16x16x32_bf16 v[76:79], a[128:131], a[12:15], 0
    v_mfma_f32_16x16x32_bf16 v[84:87], a[128:131], a[16:19], 0
    v_max_f32 v248, v248, v51
    s_waitcnt lgkmcnt(2)
    v_mfma_f32_16x16x32_bf16 v[52:55], a[132:135], a[20:23], v[52:55]
    v_mfma_f32_16x16x32_bf16 v[60:63], a[132:135], a[24:27], v[60:63]
    ds_read_b128 a[128:131], v26 offset:6400
    v_mfma_f32_16x16x32_bf16 v[68:71], a[132:135], a[28:31], v[68:71]
    v_max3_f32 v249, v56, v57, v58
    v_mfma_f32_16x16x32_bf16 v[76:79], a[132:135], a[32:35], v[76:79]
    buffer_load_dwordx4 v30, s[16:19], s48 offen nt lds
    v_mfma_f32_16x16x32_bf16 v[84:87], a[132:135], a[36:39], v[84:87]
    s_waitcnt lgkmcnt(2)
    v_mfma_f32_16x16x32_bf16 v[52:55], a[120:123], a[40:43], v[52:55]
    v_max_f32 v249, v249, v59
    v_mfma_f32_16x16x32_bf16 v[60:63], a[120:123], a[44:47], v[60:63]
    ds_read_b128 a[132:135], v27 offset:6400
    v_mfma_f32_16x16x32_bf16 v[68:71], a[120:123], a[48:51], v[68:71]
    v_mfma_f32_16x16x32_bf16 v[76:79], a[120:123], a[52:55], v[76:79]
    v_max3_f32 v250, v64, v65, v66
    v_mfma_f32_16x16x32_bf16 v[84:87], a[120:123], a[56:59], v[84:87]
    s_waitcnt lgkmcnt(2)
    v_mfma_f32_16x16x32_bf16 v[52:55], a[124:127], a[60:63], v[52:55]
    v_add_u32 v28, 0x6000, v24
    v_add_u32 v29, 0x6000, v25
    buffer_load_dwordx4 v31, s[16:19], s48 offen offset:1024 nt lds
    v_mfma_f32_16x16x32_bf16 v[60:63], a[124:127], a[64:67], v[60:63]
    ds_read_b128 a[120:123], v28
    v_max_f32 v250, v250, v67
    v_mfma_f32_16x16x32_bf16 v[68:71], a[124:127], a[68:71], v[68:71]
    v_mfma_f32_16x16x32_bf16 v[76:79], a[124:127], a[72:75], v[76:79]
    v_max3_f32 v251, v72, v73, v74
    v_mfma_f32_16x16x32_bf16 v[84:87], a[124:127], a[76:79], v[84:87]
    s_waitcnt lgkmcnt(2)
    v_mfma_f32_16x16x32_bf16 v[52:55], a[128:131], a[80:83], v[52:55]
    v_mfma_f32_16x16x32_bf16 v[60:63], a[128:131], a[84:87], v[60:63]
    ds_read_b128 a[124:127], v29
    v_max_f32 v251, v251, v75
    v_mfma_f32_16x16x32_bf16 v[68:71], a[128:131], a[88:91], v[68:71]
    buffer_load_dwordx4 v32, s[16:19], s48 offen offset:2048 nt lds
    v_mfma_f32_16x16x32_bf16 v[76:79], a[128:131], a[92:95], v[76:79]
    v_mfma_f32_16x16x32_bf16 v[84:87], a[128:131], a[96:99], v[84:87]
    v_max3_f32 v252, v80, v81, v82
    s_waitcnt lgkmcnt(2)
    v_mfma_f32_16x16x32_bf16 v[52:55], a[132:135], a[100:103], v[52:55]
    v_mfma_f32_16x16x32_bf16 v[60:63], a[132:135], a[104:107], v[60:63]
    ds_read_b128 a[128:131], v28 offset:128
    v_mfma_f32_16x16x32_bf16 v[68:71], a[132:135], a[108:111], v[68:71]
    v_max_f32 v252, v252, v83
    v_mfma_f32_16x16x32_bf16 v[76:79], a[132:135], a[112:115], v[76:79]
    v_mfma_f32_16x16x32_bf16 v[84:87], a[132:135], a[116:119], v[84:87]
    s_waitcnt vmcnt(12)
    s_barrier
    s_waitcnt lgkmcnt(2)
    v_mfma_f32_16x16x32_bf16 v[88:91], a[120:123], a[0:3], 0
    v_mfma_f32_16x16x32_bf16 v[96:99], a[120:123], a[4:7], 0
    ds_read_b128 a[132:135], v29 offset:128
    s_add_u32 m0, s52, 0
    s_add_u32 s48, s52, 61440
    v_mfma_f32_16x16x32_bf16 v[104:107], a[120:123], a[8:11], 0
    v_max3_f32 v248, v248, v52, v53
    v_mfma_f32_16x16x32_bf16 v[112:115], a[120:123], a[12:15], 0
    v_mfma_f32_16x16x32_bf16 v[120:123], a[120:123], a[16:19], 0
    v_max3_f32 v248, v248, v54, v55
    s_waitcnt lgkmcnt(2)
    v_mfma_f32_16x16x32_bf16 v[88:91], a[124:127], a[20:23], v[88:91]
    v_mfma_f32_16x16x32_bf16 v[96:99], a[124:127], a[24:27], v[96:99]
    ds_read_b128 a[120:123], v28 offset:256
    v_mfma_f32_16x16x32_bf16 v[104:107], a[124:127], a[28:31], v[104:107]
    v_max3_f32 v249, v249, v60, v61
    v_mfma_f32_16x16x32_bf16 v[112:115], a[124:127], a[32:35], v[112:115]
    buffer_load_dwordx4 v30, s[16:19], s48 offen nt lds
    v_mfma_f32_16x16x32_bf16 v[120:123], a[124:127], a[36:39], v[120:123]
    s_waitcnt lgkmcnt(2)
    v_mfma_f32_16x16x32_bf16 v[88:91], a[128:131], a[40:43], v[88:91]
    v_max3_f32 v249, v249, v62, v63
    v_mfma_f32_16x16x32_bf16 v[96:99], a[128:131], a[44:47], v[96:99]
    ds_read_b128 a[124:127], v29 offset:256
    v_mfma_f32_16x16x32_bf16 v[104:107], a[128:131], a[48:51], v[104:107]
    v_mfma_f32_16x16x32_bf16 v[112:115], a[128:131], a[52:55], v[112:115]
    v_max3_f32 v250, v250, v68, v69
    v_mfma_f32_16x16x32_bf16 v[120:123], a[128:131], a[56:59], v[120:123]
    s_waitcnt lgkmcnt(2)
    v_mfma_f32_16x16x32_bf16 v[88:91], a[132:135], a[60:63], v[88:91]
    buffer_load_dwordx4 v31, s[16:19], s48 offen offset:1024 nt lds
    v_mfma_f32_16x16x32_bf16 v[96:99], a[132:135], a[64:67], v[96:99]
    ds_read_b128 a[128:131], v28 offset:6144
    v_max3_f32 v250, v250, v70, v71
    v_mfma_f32_16x16x32_bf16 v[104:107], a[132:135], a[68:71], v[104:107]
    v_mfma_f32_16x16x32_bf16 v[112:115], a[132:135], a[72:75], v[112:115]
    v_max3_f32 v251, v251, v76, v77
    v_mfma_f32_16x16x32_bf16 v[120:123], a[132:135], a[76:79], v[120:123]
    s_waitcnt lgkmcnt(2)
    v_mfma_f32_16x16x32_bf16 v[88:91], a[120:123], a[80:83], v[88:91]
    v_mfma_f32_16x16x32_bf16 v[96:99], a[120:123], a[84:87], v[96:99]
    ds_read_b128 a[132:135], v29 offset:6144
    v_max3_f32 v251, v251, v78, v79
    v_mfma_f32_16x16x32_bf16 v[104:107], a[120:123], a[88:91], v[104:107]
    buffer_load_dwordx4 v32, s[16:19], s48 offen offset:2048 nt lds
    v_mfma_f32_16x16x32_bf16 v[112:115], a[120:123], a[92:95], v[112:115]
    v_mfma_f32_16x16x32_bf16 v[120:123], a[120:123], a[96:99], v[120:123]
    v_max3_f32 v252, v252, v84, v85
    s_waitcnt lgkmcnt(2)
    v_mfma_f32_16x16x32_bf16 v[88:91], a[124:127], a[100:103], v[88:91]
    v_mfma_f32_16x16x32_bf16 v[96:99], a[124:127], a[104:107], v[96:99]
    ds_read_b128 a[120:123], v28 offset:6272
    v_mfma_f32_16x16x32_bf16 v[104:107], a[124:127], a[108:111], v[104:107]
    v_max3_f32 v252, v252, v86, v87
    v_mfma_f32_16x16x32_bf16 v[112:115], a[124:127], a[112:115], v[112:115]
    v_mfma_f32_16x16x32_bf16 v[120:123], a[124:127], a[116:119], v[120:123]
    s_waitcnt lgkmcnt(2)
    v_mfma_f32_16x16x32_bf16 v[92:95], a[128:131], a[0:3], 0
    v_mfma_f32_16x16x32_bf16 v[100:103], a[128:131], a[4:7], 0
    ds_read_b128 a[124:127], v29 offset:6272
    s_add_u32 m0, s52, 12288
    s_add_u32 s48, s52, 159744
    v_mfma_f32_16x16x32_bf16 v[108:111], a[128:131], a[8:11], 0
    v_max3_f32 v248, v248, v88, v89
    v_mfma_f32_16x16x32_bf16 v[116:119], a[128:131], a[12:15], 0
    v_mfma_f32_16x16x32_bf16 v[124:127], a[128:131], a[16:19], 0
    v_max3_f32 v248, v248, v90, v91
    s_waitcnt lgkmcnt(2)
    v_mfma_f32_16x16x32_bf16 v[92:95], a[132:135], a[20:23], v[92:95]
    v_mfma_f32_16x16x32_bf16 v[100:103], a[132:135], a[24:27], v[100:103]
    ds_read_b128 a[128:131], v28 offset:6400
    v_mfma_f32_16x16x32_bf16 v[108:111], a[132:135], a[28:31], v[108:111]
    v_max3_f32 v249, v249, v96, v97
    v_mfma_f32_16x16x32_bf16 v[116:119], a[132:135], a[32:35], v[116:119]
    buffer_load_dwordx4 v30, s[16:19], s48 offen nt lds
    v_mfma_f32_16x16x32_bf16 v[124:127], a[132:135], a[36:39], v[124:127]
    s_waitcnt lgkmcnt(2)
    v_mfma_f32_16x16x32_bf16 v[92:95], a[120:123], a[40:43], v[92:95]
    v_max3_f32 v249, v249, v98, v99
    v_mfma_f32_16x16x32_bf16 v[100:103], a[120:123], a[44:47], v[100:103]
    ds_read_b128 a[132:135], v29 offset:6400
    v_mfma_f32_16x16x32_bf16 v[108:111], a[120:123], a[48:51], v[108:111]
    v_mfma_f32_16x16x32_bf16 v[116:119], a[120:123], a[52:55], v[116:119]
    v_max3_f32 v250, v250, v104, v105
    v_mfma_f32_16x16x32_bf16 v[124:127], a[120:123], a[56:59], v[124:127]
    s_waitcnt lgkmcnt(2)
    v_mfma_f32_16x16x32_bf16 v[92:95], a[124:127], a[60:63], v[92:95]
    v_add_u32 v26, 0x1b000, v24
    v_add_u32 v27, 0x1b000, v25
    buffer_load_dwordx4 v31, s[16:19], s48 offen offset:1024 nt lds
    v_mfma_f32_16x16x32_bf16 v[100:103], a[124:127], a[64:67], v[100:103]
    ds_read_b128 a[120:123], v26
    v_max3_f32 v250, v250, v106, v107
    v_mfma_f32_16x16x32_bf16 v[108:111], a[124:127], a[68:71], v[108:111]
    v_mfma_f32_16x16x32_bf16 v[116:119], a[124:127], a[72:75], v[116:119]
    v_max3_f32 v251, v251, v112, v113
    v_mfma_f32_16x16x32_bf16 v[124:127], a[124:127], a[76:79], v[124:127]
    s_waitcnt lgkmcnt(2)
    v_mfma_f32_16x16x32_bf16 v[92:95], a[128:131], a[80:83], v[92:95]
    v_mfma_f32_16x16x32_bf16 v[100:103], a[128:131], a[84:87], v[100:103]
    ds_read_b128 a[124:127], v27
    v_max3_f32 v251, v251, v114, v115
    v_mfma_f32_16x16x32_bf16 v[108:111], a[128:131], a[88:91], v[108:111]
    buffer_load_dwordx4 v32, s[16:19], s48 offen offset:2048 nt lds
    v_mfma_f32_16x16x32_bf16 v[116:119], a[128:131], a[92:95], v[116:119]
    v_mfma_f32_16x16x32_bf16 v[124:127], a[128:131], a[96:99], v[124:127]
    v_max3_f32 v252, v252, v120, v121
    s_waitcnt lgkmcnt(2)
    v_mfma_f32_16x16x32_bf16 v[92:95], a[132:135], a[100:103], v[92:95]
    v_mfma_f32_16x16x32_bf16 v[100:103], a[132:135], a[104:107], v[100:103]
    ds_read_b128 a[128:131], v26 offset:128
    v_mfma_f32_16x16x32_bf16 v[108:111], a[132:135], a[108:111], v[108:111]
    v_max3_f32 v252, v252, v122, v123
    v_mfma_f32_16x16x32_bf16 v[116:119], a[132:135], a[112:115], v[116:119]
    v_mfma_f32_16x16x32_bf16 v[124:127], a[132:135], a[116:119], v[124:127]
    s_waitcnt vmcnt(12)
    s_barrier
    s_waitcnt lgkmcnt(2)
    v_mfma_f32_16x16x32_bf16 v[128:131], a[120:123], a[0:3], 0
    v_mfma_f32_16x16x32_bf16 v[136:139], a[120:123], a[4:7], 0
    ds_read_b128 a[132:135], v27 offset:128
    s_add_u32 m0, s52, 24576
    s_add_u32 s48, s52, 73728
    v_mfma_f32_16x16x32_bf16 v[144:147], a[120:123], a[8:11], 0
    v_max3_f32 v248, v248, v92, v93
    v_mfma_f32_16x16x32_bf16 v[152:155], a[120:123], a[12:15], 0
    v_mfma_f32_16x16x32_bf16 v[160:163], a[120:123], a[16:19], 0
    v_max3_f32 v248, v248, v94, v95
    s_waitcnt lgkmcnt(2)
    v_mfma_f32_16x16x32_bf16 v[128:131], a[124:127], a[20:23], v[128:131]
    v_mfma_f32_16x16x32_bf16 v[136:139], a[124:127], a[24:27], v[136:139]
    ds_read_b128 a[120:123], v26 offset:256
    v_mfma_f32_16x16x32_bf16 v[144:147], a[124:127], a[28:31], v[144:147]
    v_max3_f32 v249, v249, v100, v101
    v_mfma_f32_16x16x32_bf16 v[152:155], a[124:127], a[32:35], v[152:155]
    buffer_load_dwordx4 v30, s[16:19], s48 offen nt lds
    v_mfma_f32_16x16x32_bf16 v[160:163], a[124:127], a[36:39], v[160:163]
    s_waitcnt lgkmcnt(2)
    v_mfma_f32_16x16x32_bf16 v[128:131], a[128:131], a[40:43], v[128:131]
    v_max3_f32 v249, v249, v102, v103
    v_mfma_f32_16x16x32_bf16 v[136:139], a[128:131], a[44:47], v[136:139]
    ds_read_b128 a[124:127], v27 offset:256
    v_mfma_f32_16x16x32_bf16 v[144:147], a[128:131], a[48:51], v[144:147]
    v_mfma_f32_16x16x32_bf16 v[152:155], a[128:131], a[52:55], v[152:155]
    v_max3_f32 v250, v250, v108, v109
    v_mfma_f32_16x16x32_bf16 v[160:163], a[128:131], a[56:59], v[160:163]
    s_waitcnt lgkmcnt(2)
    v_mfma_f32_16x16x32_bf16 v[128:131], a[132:135], a[60:63], v[128:131]
    buffer_load_dwordx4 v31, s[16:19], s48 offen offset:1024 nt lds
    v_mfma_f32_16x16x32_bf16 v[136:139], a[132:135], a[64:67], v[136:139]
    ds_read_b128 a[128:131], v26 offset:6144
    v_max3_f32 v250, v250, v110, v111
    v_mfma_f32_16x16x32_bf16 v[144:147], a[132:135], a[68:71], v[144:147]
    v_mfma_f32_16x16x32_bf16 v[152:155], a[132:135], a[72:75], v[152:155]
    v_max3_f32 v251, v251, v116, v117
    v_mfma_f32_16x16x32_bf16 v[160:163], a[132:135], a[76:79], v[160:163]
    s_waitcnt lgkmcnt(2)
    v_mfma_f32_16x16x32_bf16 v[128:131], a[120:123], a[80:83], v[128:131]
    v_mfma_f32_16x16x32_bf16 v[136:139], a[120:123], a[84:87], v[136:139]
    ds_read_b128 a[132:135], v27 offset:6144
    v_max3_f32 v251, v251, v118, v119
    v_mfma_f32_16x16x32_bf16 v[144:147], a[120:123], a[88:91], v[144:147]
    buffer_load_dwordx4 v32, s[16:19], s48 offen offset:2048 nt lds
    v_mfma_f32_16x16x32_bf16 v[152:155], a[120:123], a[92:95], v[152:155]
    v_mfma_f32_16x16x32_bf16 v[160:163], a[120:123], a[96:99], v[160:163]
    v_max3_f32 v252, v252, v124, v125
    s_waitcnt lgkmcnt(2)
    v_mfma_f32_16x16x32_bf16 v[128:131], a[124:127], a[100:103], v[128:131]
    v_mfma_f32_16x16x32_bf16 v[136:139], a[124:127], a[104:107], v[136:139]
    ds_read_b128 a[120:123], v26 offset:6272
    v_mfma_f32_16x16x32_bf16 v[144:147], a[124:127], a[108:111], v[144:147]
    v_max3_f32 v252, v252, v126, v127
    v_mfma_f32_16x16x32_bf16 v[152:155], a[124:127], a[112:115], v[152:155]
    v_mfma_f32_16x16x32_bf16 v[160:163], a[124:127], a[116:119], v[160:163]
    s_waitcnt lgkmcnt(2)
    v_mfma_f32_16x16x32_bf16 v[132:135], a[128:131], a[0:3], 0
    v_mfma_f32_16x16x32_bf16 v[140:143], a[128:131], a[4:7], 0
    ds_read_b128 a[124:127], v27 offset:6272
    s_add_u32 m0, s52, 36864
    s_add_u32 s48, s52, 172032
    v_mfma_f32_16x16x32_bf16 v[148:151], a[128:131], a[8:11], 0
    v_max3_f32 v248, v248, v128, v129
    v_mfma_f32_16x16x32_bf16 v[156:159], a[128:131], a[12:15], 0
    v_mfma_f32_16x16x32_bf16 v[164:167], a[128:131], a[16:19], 0
    v_max3_f32 v248, v248, v130, v131
    s_waitcnt lgkmcnt(2)
    v_mfma_f32_16x16x32_bf16 v[132:135], a[132:135], a[20:23], v[132:135]
    v_mfma_f32_16x16x32_bf16 v[140:143], a[132:135], a[24:27], v[140:143]
    ds_read_b128 a[128:131], v26 offset:6400
    v_mfma_f32_16x16x32_bf16 v[148:151], a[132:135], a[28:31], v[148:151]
    v_max3_f32 v249, v249, v136, v137
    v_mfma_f32_16x16x32_bf16 v[156:159], a[132:135], a[32:35], v[156:159]
    buffer_load_dwordx4 v30, s[16:19], s48 offen nt lds
    v_mfma_f32_16x16x32_bf16 v[164:167], a[132:135], a[36:39], v[164:167]
    s_waitcnt lgkmcnt(2)
    v_mfma_f32_16x16x32_bf16 v[132:135], a[120:123], a[40:43], v[132:135]
    v_max3_f32 v249, v249, v138, v139
    v_mfma_f32_16x16x32_bf16 v[140:143], a[120:123], a[44:47], v[140:143]
    ds_read_b128 a[132:135], v27 offset:6400
    v_mfma_f32_16x16x32_bf16 v[148:151], a[120:123], a[48:51], v[148:151]
    v_mfma_f32_16x16x32_bf16 v[156:159], a[120:123], a[52:55], v[156:159]
    v_max3_f32 v250, v250, v144, v145
    v_mfma_f32_16x16x32_bf16 v[164:167], a[120:123], a[56:59], v[164:167]
    s_waitcnt lgkmcnt(2)
    v_mfma_f32_16x16x32_bf16 v[132:135], a[124:127], a[60:63], v[132:135]
    v_add_u32 v28, 0x21000, v24
    v_add_u32 v29, 0x21000, v25
    buffer_load_dwordx4 v31, s[16:19], s48 offen offset:1024 nt lds
    v_mfma_f32_16x16x32_bf16 v[140:143], a[124:127], a[64:67], v[140:143]
    ds_read_b128 a[120:123], v28
    v_max3_f32 v250, v250, v146, v147
    v_mfma_f32_16x16x32_bf16 v[148:151], a[124:127], a[68:71], v[148:151]
    v_mfma_f32_16x16x32_bf16 v[156:159], a[124:127], a[72:75], v[156:159]
    v_max3_f32 v251, v251, v152, v153
    v_mfma_f32_16x16x32_bf16 v[164:167], a[124:127], a[76:79], v[164:167]
    s_waitcnt lgkmcnt(2)
    v_mfma_f32_16x16x32_bf16 v[132:135], a[128:131], a[80:83], v[132:135]
    v_mfma_f32_16x16x32_bf16 v[140:143], a[128:131], a[84:87], v[140:143]
    ds_read_b128 a[124:127], v29
    v_max3_f32 v251, v251, v154, v155
    v_mfma_f32_16x16x32_bf16 v[148:151], a[128:131], a[88:91], v[148:151]
    buffer_load_dwordx4 v32, s[16:19], s48 offen offset:2048 nt lds
    v_mfma_f32_16x16x32_bf16 v[156:159], a[128:131], a[92:95], v[156:159]
    v_mfma_f32_16x16x32_bf16 v[164:167], a[128:131], a[96:99], v[164:167]
    v_max3_f32 v252, v252, v160, v161
    s_waitcnt lgkmcnt(2)
    v_mfma_f32_16x16x32_bf16 v[132:135], a[132:135], a[100:103], v[132:135]
    v_mfma_f32_16x16x32_bf16 v[140:143], a[132:135], a[104:107], v[140:143]
    ds_read_b128 a[128:131], v28 offset:128
    v_mfma_f32_16x16x32_bf16 v[148:151], a[132:135], a[108:111], v[148:151]
    v_max3_f32 v252, v252, v162, v163
    v_mfma_f32_16x16x32_bf16 v[156:159], a[132:135], a[112:115], v[156:159]
    v_mfma_f32_16x16x32_bf16 v[164:167], a[132:135], a[116:119], v[164:167]
    s_waitcnt vmcnt(12)
    s_barrier
    s_waitcnt lgkmcnt(2)
    v_mfma_f32_16x16x32_bf16 v[168:171], a[120:123], a[0:3], 0
    v_mfma_f32_16x16x32_bf16 v[176:179], a[120:123], a[4:7], 0
    ds_read_b128 a[132:135], v29 offset:128
    s_add_u32 m0, s52, 73728
    s_add_u32 s48, s52, 86016
    v_mfma_f32_16x16x32_bf16 v[184:187], a[120:123], a[8:11], 0
    v_max3_f32 v248, v248, v132, v133
    v_mfma_f32_16x16x32_bf16 v[192:195], a[120:123], a[12:15], 0
    v_mfma_f32_16x16x32_bf16 v[200:203], a[120:123], a[16:19], 0
    v_max3_f32 v248, v248, v134, v135
    s_waitcnt lgkmcnt(2)
    v_mfma_f32_16x16x32_bf16 v[168:171], a[124:127], a[20:23], v[168:171]
    v_mfma_f32_16x16x32_bf16 v[176:179], a[124:127], a[24:27], v[176:179]
    ds_read_b128 a[120:123], v28 offset:256
    v_mfma_f32_16x16x32_bf16 v[184:187], a[124:127], a[28:31], v[184:187]
    v_max3_f32 v249, v249, v140, v141
    v_mfma_f32_16x16x32_bf16 v[192:195], a[124:127], a[32:35], v[192:195]
    buffer_load_dwordx4 v30, s[16:19], s48 offen nt lds
    v_mfma_f32_16x16x32_bf16 v[200:203], a[124:127], a[36:39], v[200:203]
    s_waitcnt lgkmcnt(2)
    v_mfma_f32_16x16x32_bf16 v[168:171], a[128:131], a[40:43], v[168:171]
    v_max3_f32 v249, v249, v142, v143
    v_mfma_f32_16x16x32_bf16 v[176:179], a[128:131], a[44:47], v[176:179]
    ds_read_b128 a[124:127], v29 offset:256
    v_mfma_f32_16x16x32_bf16 v[184:187], a[128:131], a[48:51], v[184:187]
    v_mfma_f32_16x16x32_bf16 v[192:195], a[128:131], a[52:55], v[192:195]
    v_max3_f32 v250, v250, v148, v149
    v_mfma_f32_16x16x32_bf16 v[200:203], a[128:131], a[56:59], v[200:203]
    s_waitcnt lgkmcnt(2)
    v_mfma_f32_16x16x32_bf16 v[168:171], a[132:135], a[60:63], v[168:171]
    buffer_load_dwordx4 v31, s[16:19], s48 offen offset:1024 nt lds
    v_mfma_f32_16x16x32_bf16 v[176:179], a[132:135], a[64:67], v[176:179]
    ds_read_b128 a[128:131], v28 offset:6144
    v_max3_f32 v250, v250, v150, v151
    v_mfma_f32_16x16x32_bf16 v[184:187], a[132:135], a[68:71], v[184:187]
    v_mfma_f32_16x16x32_bf16 v[192:195], a[132:135], a[72:75], v[192:195]
    v_max3_f32 v251, v251, v156, v157
    v_mfma_f32_16x16x32_bf16 v[200:203], a[132:135], a[76:79], v[200:203]
    s_waitcnt lgkmcnt(2)
    v_mfma_f32_16x16x32_bf16 v[168:171], a[120:123], a[80:83], v[168:171]
    v_mfma_f32_16x16x32_bf16 v[176:179], a[120:123], a[84:87], v[176:179]
    ds_read_b128 a[132:135], v29 offset:6144
    v_max3_f32 v251, v251, v158, v159
    v_mfma_f32_16x16x32_bf16 v[184:187], a[120:123], a[88:91], v[184:187]
    buffer_load_dwordx4 v32, s[16:19], s48 offen offset:2048 nt lds
    v_mfma_f32_16x16x32_bf16 v[192:195], a[120:123], a[92:95], v[192:195]
    v_mfma_f32_16x16x32_bf16 v[200:203], a[120:123], a[96:99], v[200:203]
    v_max3_f32 v252, v252, v164, v165
    s_waitcnt lgkmcnt(2)
    v_mfma_f32_16x16x32_bf16 v[168:171], a[124:127], a[100:103], v[168:171]
    v_mfma_f32_16x16x32_bf16 v[176:179], a[124:127], a[104:107], v[176:179]
    ds_read_b128 a[120:123], v28 offset:6272
    v_mfma_f32_16x16x32_bf16 v[184:187], a[124:127], a[108:111], v[184:187]
    v_max3_f32 v252, v252, v166, v167
    v_mfma_f32_16x16x32_bf16 v[192:195], a[124:127], a[112:115], v[192:195]
    v_mfma_f32_16x16x32_bf16 v[200:203], a[124:127], a[116:119], v[200:203]
    s_waitcnt lgkmcnt(2)
    v_mfma_f32_16x16x32_bf16 v[172:175], a[128:131], a[0:3], 0
    v_mfma_f32_16x16x32_bf16 v[180:183], a[128:131], a[4:7], 0
    ds_read_b128 a[124:127], v29 offset:6272
    s_add_u32 m0, s52, 86016
    s_add_u32 s48, s52, 184320
    v_mfma_f32_16x16x32_bf16 v[188:191], a[128:131], a[8:11], 0
    v_max3_f32 v248, v248, v168, v169
    v_mfma_f32_16x16x32_bf16 v[196:199], a[128:131], a[12:15], 0
    v_mfma_f32_16x16x32_bf16 v[204:207], a[128:131], a[16:19], 0
    v_max3_f32 v248, v248, v170, v171
    s_waitcnt lgkmcnt(2)
    v_mfma_f32_16x16x32_bf16 v[172:175], a[132:135], a[20:23], v[172:175]
    v_mfma_f32_16x16x32_bf16 v[180:183], a[132:135], a[24:27], v[180:183]
    ds_read_b128 a[128:131], v28 offset:6400
    v_mfma_f32_16x16x32_bf16 v[188:191], a[132:135], a[28:31], v[188:191]
    v_max3_f32 v249, v249, v176, v177
    v_mfma_f32_16x16x32_bf16 v[196:199], a[132:135], a[32:35], v[196:199]
    buffer_load_dwordx4 v30, s[16:19], s48 offen nt lds
    v_mfma_f32_16x16x32_bf16 v[204:207], a[132:135], a[36:39], v[204:207]
    s_waitcnt lgkmcnt(2)
    v_mfma_f32_16x16x32_bf16 v[172:175], a[120:123], a[40:43], v[172:175]
    v_max3_f32 v249, v249, v178, v179
    v_mfma_f32_16x16x32_bf16 v[180:183], a[120:123], a[44:47], v[180:183]
    ds_read_b128 a[132:135], v29 offset:6400
    v_mfma_f32_16x16x32_bf16 v[188:191], a[120:123], a[48:51], v[188:191]
    v_mfma_f32_16x16x32_bf16 v[196:199], a[120:123], a[52:55], v[196:199]
    v_max3_f32 v250, v250, v184, v185
    v_mfma_f32_16x16x32_bf16 v[204:207], a[120:123], a[56:59], v[204:207]
    s_waitcnt lgkmcnt(2)
    v_mfma_f32_16x16x32_bf16 v[172:175], a[124:127], a[60:63], v[172:175]
    v_add_u32 v26, 0xc000, v24
    v_add_u32 v27, 0xc000, v25
    buffer_load_dwordx4 v31, s[16:19], s48 offen offset:1024 nt lds
    v_mfma_f32_16x16x32_bf16 v[180:183], a[124:127], a[64:67], v[180:183]
    ds_read_b128 a[120:123], v26
    v_max3_f32 v250, v250, v186, v187
    v_mfma_f32_16x16x32_bf16 v[188:191], a[124:127], a[68:71], v[188:191]
    v_mfma_f32_16x16x32_bf16 v[196:199], a[124:127], a[72:75], v[196:199]
    v_max3_f32 v251, v251, v192, v193
    v_mfma_f32_16x16x32_bf16 v[204:207], a[124:127], a[76:79], v[204:207]
    s_waitcnt lgkmcnt(2)
    v_mfma_f32_16x16x32_bf16 v[172:175], a[128:131], a[80:83], v[172:175]
    v_mfma_f32_16x16x32_bf16 v[180:183], a[128:131], a[84:87], v[180:183]
    ds_read_b128 a[124:127], v27
    v_max3_f32 v251, v251, v194, v195
    v_mfma_f32_16x16x32_bf16 v[188:191], a[128:131], a[88:91], v[188:191]
    buffer_load_dwordx4 v32, s[16:19], s48 offen offset:2048 nt lds
    v_mfma_f32_16x16x32_bf16 v[196:199], a[128:131], a[92:95], v[196:199]
    v_mfma_f32_16x16x32_bf16 v[204:207], a[128:131], a[96:99], v[204:207]
    v_max3_f32 v252, v252, v200, v201
    s_waitcnt lgkmcnt(2)
    v_mfma_f32_16x16x32_bf16 v[172:175], a[132:135], a[100:103], v[172:175]
    v_mfma_f32_16x16x32_bf16 v[180:183], a[132:135], a[104:107], v[180:183]
    ds_read_b128 a[128:131], v26 offset:128
    v_mfma_f32_16x16x32_bf16 v[188:191], a[132:135], a[108:111], v[188:191]
    v_max3_f32 v252, v252, v202, v203
    v_mfma_f32_16x16x32_bf16 v[196:199], a[132:135], a[112:115], v[196:199]
    v_mfma_f32_16x16x32_bf16 v[204:207], a[132:135], a[116:119], v[204:207]
    s_waitcnt vmcnt(12)
    s_barrier
    s_waitcnt lgkmcnt(2)
    v_mfma_f32_16x16x32_bf16 v[208:211], a[120:123], a[0:3], 0
    v_mfma_f32_16x16x32_bf16 v[216:219], a[120:123], a[4:7], 0
    ds_read_b128 a[132:135], v27 offset:128
    v_mfma_f32_16x16x32_bf16 v[224:227], a[120:123], a[8:11], 0
    v_max3_f32 v248, v248, v172, v173
    v_mfma_f32_16x16x32_bf16 v[232:235], a[120:123], a[12:15], 0
    v_mfma_f32_16x16x32_bf16 v[240:243], a[120:123], a[16:19], 0
    v_max3_f32 v248, v248, v174, v175
    s_waitcnt lgkmcnt(2)
    v_mfma_f32_16x16x32_bf16 v[208:211], a[124:127], a[20:23], v[208:211]
    v_mfma_f32_16x16x32_bf16 v[216:219], a[124:127], a[24:27], v[216:219]
    ds_read_b128 a[120:123], v26 offset:256
    v_mfma_f32_16x16x32_bf16 v[224:227], a[124:127], a[28:31], v[224:227]
    v_max3_f32 v249, v249, v180, v181
    v_mfma_f32_16x16x32_bf16 v[232:235], a[124:127], a[32:35], v[232:235]
    v_mfma_f32_16x16x32_bf16 v[240:243], a[124:127], a[36:39], v[240:243]
    s_waitcnt lgkmcnt(2)
    v_mfma_f32_16x16x32_bf16 v[208:211], a[128:131], a[40:43], v[208:211]
    v_max3_f32 v249, v249, v182, v183
    v_mfma_f32_16x16x32_bf16 v[216:219], a[128:131], a[44:47], v[216:219]
    ds_read_b128 a[124:127], v27 offset:256
    v_mfma_f32_16x16x32_bf16 v[224:227], a[128:131], a[48:51], v[224:227]
    v_mfma_f32_16x16x32_bf16 v[232:235], a[128:131], a[52:55], v[232:235]
    v_max3_f32 v250, v250, v188, v189
    v_mfma_f32_16x16x32_bf16 v[240:243], a[128:131], a[56:59], v[240:243]
    s_waitcnt lgkmcnt(2)
    v_mfma_f32_16x16x32_bf16 v[208:211], a[132:135], a[60:63], v[208:211]
    v_mfma_f32_16x16x32_bf16 v[216:219], a[132:135], a[64:67], v[216:219]
    ds_read_b128 a[128:131], v26 offset:6144
    v_max3_f32 v250, v250, v190, v191
    v_mfma_f32_16x16x32_bf16 v[224:227], a[132:135], a[68:71], v[224:227]
    v_mfma_f32_16x16x32_bf16 v[232:235], a[132:135], a[72:75], v[232:235]
    v_max3_f32 v251, v251, v196, v197
    v_mfma_f32_16x16x32_bf16 v[240:243], a[132:135], a[76:79], v[240:243]
    s_waitcnt lgkmcnt(2)
    v_mfma_f32_16x16x32_bf16 v[208:211], a[120:123], a[80:83], v[208:211]
    v_mfma_f32_16x16x32_bf16 v[216:219], a[120:123], a[84:87], v[216:219]
    ds_read_b128 a[132:135], v27 offset:6144
    v_max3_f32 v251, v251, v198, v199
    v_mfma_f32_16x16x32_bf16 v[224:227], a[120:123], a[88:91], v[224:227]
    v_mfma_f32_16x16x32_bf16 v[232:235], a[120:123], a[92:95], v[232:235]
    v_mfma_f32_16x16x32_bf16 v[240:243], a[120:123], a[96:99], v[240:243]
    v_max3_f32 v252, v252, v204, v205
    s_waitcnt lgkmcnt(2)
    v_mfma_f32_16x16x32_bf16 v[208:211], a[124:127], a[100:103], v[208:211]
    v_mfma_f32_16x16x32_bf16 v[216:219], a[124:127], a[104:107], v[216:219]
    ds_read_b128 a[120:123], v26 offset:6272
    v_mfma_f32_16x16x32_bf16 v[224:227], a[124:127], a[108:111], v[224:227]
    v_max3_f32 v252, v252, v206, v207
    v_mfma_f32_16x16x32_bf16 v[232:235], a[124:127], a[112:115], v[232:235]
    v_mfma_f32_16x16x32_bf16 v[240:243], a[124:127], a[116:119], v[240:243]
    s_waitcnt lgkmcnt(2)
    v_mfma_f32_16x16x32_bf16 v[212:215], a[128:131], a[0:3], 0
    v_mfma_f32_16x16x32_bf16 v[220:223], a[128:131], a[4:7], 0
    ds_read_b128 a[124:127], v27 offset:6272
    v_mfma_f32_16x16x32_bf16 v[228:231], a[128:131], a[8:11], 0
    v_max3_f32 v248, v248, v208, v209
    v_mfma_f32_16x16x32_bf16 v[236:239], a[128:131], a[12:15], 0
    v_mfma_f32_16x16x32_bf16 v[244:247], a[128:131], a[16:19], 0
    v_max3_f32 v248, v248, v210, v211
    s_waitcnt lgkmcnt(2)
    v_mfma_f32_16x16x32_bf16 v[212:215], a[132:135], a[20:23], v[212:215]
    v_mfma_f32_16x16x32_bf16 v[220:223], a[132:135], a[24:27], v[220:223]
    ds_read_b128 a[128:131], v26 offset:6400
    v_mfma_f32_16x16x32_bf16 v[228:231], a[132:135], a[28:31], v[228:231]
    v_max3_f32 v249, v249, v216, v217
    v_mfma_f32_16x16x32_bf16 v[236:239], a[132:135], a[32:35], v[236:239]
    v_mfma_f32_16x16x32_bf16 v[244:247], a[132:135], a[36:39], v[244:247]
    s_waitcnt lgkmcnt(2)
    v_mfma_f32_16x16x32_bf16 v[212:215], a[120:123], a[40:43], v[212:215]
    v_max3_f32 v249, v249, v218, v219
    v_mfma_f32_16x16x32_bf16 v[220:223], a[120:123], a[44:47], v[220:223]
    ds_read_b128 a[132:135], v27 offset:6400
    v_mfma_f32_16x16x32_bf16 v[228:231], a[120:123], a[48:51], v[228:231]
    v_mfma_f32_16x16x32_bf16 v[236:239], a[120:123], a[52:55], v[236:239]
    v_max3_f32 v250, v250, v224, v225
    v_mfma_f32_16x16x32_bf16 v[244:247], a[120:123], a[56:59], v[244:247]
    s_waitcnt lgkmcnt(2)
    v_mfma_f32_16x16x32_bf16 v[212:215], a[124:127], a[60:63], v[212:215]
    v_add_u32 v28, 0, v24
    v_add_u32 v29, 0, v25
    v_mfma_f32_16x16x32_bf16 v[220:223], a[124:127], a[64:67], v[220:223]
    ds_read_b128 a[120:123], v28
    v_max3_f32 v250, v250, v226, v227
    v_mfma_f32_16x16x32_bf16 v[228:231], a[124:127], a[68:71], v[228:231]
    v_mfma_f32_16x16x32_bf16 v[236:239], a[124:127], a[72:75], v[236:239]
    v_max3_f32 v251, v251, v232, v233
    v_mfma_f32_16x16x32_bf16 v[244:247], a[124:127], a[76:79], v[244:247]
    s_waitcnt lgkmcnt(2)
    v_mfma_f32_16x16x32_bf16 v[212:215], a[128:131], a[80:83], v[212:215]
    v_mfma_f32_16x16x32_bf16 v[220:223], a[128:131], a[84:87], v[220:223]
    ds_read_b128 a[124:127], v29
    v_max3_f32 v251, v251, v234, v235
    v_mfma_f32_16x16x32_bf16 v[228:231], a[128:131], a[88:91], v[228:231]
    v_mfma_f32_16x16x32_bf16 v[236:239], a[128:131], a[92:95], v[236:239]
    v_mfma_f32_16x16x32_bf16 v[244:247], a[128:131], a[96:99], v[244:247]
    v_max3_f32 v252, v252, v240, v241
    s_waitcnt lgkmcnt(2)
    v_mfma_f32_16x16x32_bf16 v[212:215], a[132:135], a[100:103], v[212:215]
    v_mfma_f32_16x16x32_bf16 v[220:223], a[132:135], a[104:107], v[220:223]
    ds_read_b128 a[128:131], v28 offset:128
    v_mfma_f32_16x16x32_bf16 v[228:231], a[132:135], a[108:111], v[228:231]
    v_max3_f32 v252, v252, v242, v243
    v_mfma_f32_16x16x32_bf16 v[236:239], a[132:135], a[112:115], v[236:239]
    v_mfma_f32_16x16x32_bf16 v[244:247], a[132:135], a[116:119], v[244:247]
    s_waitcnt vmcnt(6)
    s_barrier
    s_waitcnt lgkmcnt(2)
    v_mfma_f32_16x16x32_bf16 a[136:139], a[120:123], a[0:3], 0
    v_mfma_f32_16x16x32_bf16 a[144:147], a[120:123], a[4:7], 0
    ds_read_b128 a[132:135], v29 offset:128
    v_add_u32 v30, 0x800, v33
    v_mfma_f32_16x16x32_bf16 a[152:155], a[120:123], a[8:11], 0
    v_max3_f32 v248, v248, v212, v213
    v_mfma_f32_16x16x32_bf16 a[160:163], a[120:123], a[12:15], 0
    v_mfma_f32_16x16x32_bf16 a[168:171], a[120:123], a[16:19], 0
    v_max3_f32 v248, v248, v214, v215
    s_waitcnt lgkmcnt(2)
    v_mfma_f32_16x16x32_bf16 a[136:139], a[124:127], a[20:23], a[136:139]
    v_mfma_f32_16x16x32_bf16 a[144:147], a[124:127], a[24:27], a[144:147]
    ds_read_b128 a[120:123], v28 offset:256
    v_mfma_f32_16x16x32_bf16 a[152:155], a[124:127], a[28:31], a[152:155]
    v_max3_f32 v249, v249, v220, v221
    v_mfma_f32_16x16x32_bf16 a[160:163], a[124:127], a[32:35], a[160:163]
    v_add_u32 v31, 0x1000, v33
    v_mfma_f32_16x16x32_bf16 a[168:171], a[124:127], a[36:39], a[168:171]
    s_waitcnt lgkmcnt(2)
    v_mfma_f32_16x16x32_bf16 a[136:139], a[128:131], a[40:43], a[136:139]
    v_max3_f32 v249, v249, v222, v223
    v_mfma_f32_16x16x32_bf16 a[144:147], a[128:131], a[44:47], a[144:147]
    ds_read_b128 a[124:127], v29 offset:256
    v_mfma_f32_16x16x32_bf16 a[152:155], a[128:131], a[48:51], a[152:155]
    v_mfma_f32_16x16x32_bf16 a[160:163], a[128:131], a[52:55], a[160:163]
    v_max3_f32 v250, v250, v228, v229
    v_mfma_f32_16x16x32_bf16 a[168:171], a[128:131], a[56:59], a[168:171]
    s_waitcnt lgkmcnt(2)
    v_mfma_f32_16x16x32_bf16 a[136:139], a[132:135], a[60:63], a[136:139]
    v_add_u32 v32, 0x1800, v33
    v_mfma_f32_16x16x32_bf16 a[144:147], a[132:135], a[64:67], a[144:147]
    ds_read_b128 a[128:131], v28 offset:6144
    v_max3_f32 v250, v250, v230, v231
    v_mfma_f32_16x16x32_bf16 a[152:155], a[132:135], a[68:71], a[152:155]
    v_mfma_f32_16x16x32_bf16 a[160:163], a[132:135], a[72:75], a[160:163]
    v_max3_f32 v251, v251, v236, v237
    v_mfma_f32_16x16x32_bf16 a[168:171], a[132:135], a[76:79], a[168:171]
    s_waitcnt lgkmcnt(2)
    v_mfma_f32_16x16x32_bf16 a[136:139], a[120:123], a[80:83], a[136:139]
    v_mfma_f32_16x16x32_bf16 a[144:147], a[120:123], a[84:87], a[144:147]
    ds_read_b128 a[132:135], v29 offset:6144
    v_max3_f32 v251, v251, v238, v239
    v_mfma_f32_16x16x32_bf16 a[152:155], a[120:123], a[88:91], a[152:155]
    s_add_u32 m0, s53, 49152
    s_add_u32 s48, s54, 0
    v_mfma_f32_16x16x32_bf16 a[160:163], a[120:123], a[92:95], a[160:163]
    v_mfma_f32_16x16x32_bf16 a[168:171], a[120:123], a[96:99], a[168:171]
    v_max3_f32 v252, v252, v244, v245
    s_waitcnt lgkmcnt(2)
    v_mfma_f32_16x16x32_bf16 a[136:139], a[124:127], a[100:103], a[136:139]
    v_mfma_f32_16x16x32_bf16 a[144:147], a[124:127], a[104:107], a[144:147]
    ds_read_b128 a[120:123], v28 offset:6272
    v_mfma_f32_16x16x32_bf16 a[152:155], a[124:127], a[108:111], a[152:155]
    v_max3_f32 v252, v252, v246, v247
    v_mfma_f32_16x16x32_bf16 a[160:163], a[124:127], a[112:115], a[160:163]
    v_mfma_f32_16x16x32_bf16 a[168:171], a[124:127], a[116:119], a[168:171]
    s_waitcnt lgkmcnt(2)
    v_mfma_f32_16x16x32_bf16 a[140:143], a[128:131], a[0:3], 0
    v_mfma_f32_16x16x32_bf16 a[148:151], a[128:131], a[4:7], 0
    ds_read_b128 a[124:127], v29 offset:6272
    buffer_load_dwordx4 v33, s[20:23], s48 offen nt lds
    v_mfma_f32_16x16x32_bf16 a[156:159], a[128:131], a[8:11], 0
    v_accvgpr_read_b32 v1, a136
    v_accvgpr_read_b32 v2, a137
    v_mfma_f32_16x16x32_bf16 a[164:167], a[128:131], a[12:15], 0
    v_accvgpr_read_b32 v3, a138
    v_mfma_f32_16x16x32_bf16 a[172:175], a[128:131], a[16:19], 0
    v_accvgpr_read_b32 v4, a139
    s_waitcnt lgkmcnt(2)
    v_mfma_f32_16x16x32_bf16 a[140:143], a[132:135], a[20:23], a[140:143]
    v_max3_f32 v248, v248, v1, v2
    v_mfma_f32_16x16x32_bf16 a[148:151], a[132:135], a[24:27], a[148:151]
    ds_read_b128 a[128:131], v28 offset:6400
    v_max3_f32 v248, v248, v3, v4
    v_mfma_f32_16x16x32_bf16 a[156:159], a[132:135], a[28:31], a[156:159]
    v_accvgpr_read_b32 v5, a144
    v_mfma_f32_16x16x32_bf16 a[164:167], a[132:135], a[32:35], a[164:167]
    v_accvgpr_read_b32 v6, a145
    buffer_load_dwordx4 v30, s[20:23], s48 offen offset:1024 nt lds
    v_mfma_f32_16x16x32_bf16 a[172:175], a[132:135], a[36:39], a[172:175]
    v_accvgpr_read_b32 v7, a146
    s_waitcnt lgkmcnt(2)
    v_mfma_f32_16x16x32_bf16 a[140:143], a[120:123], a[40:43], a[140:143]
    v_accvgpr_read_b32 v46, a147
    v_mfma_f32_16x16x32_bf16 a[148:151], a[120:123], a[44:47], a[148:151]
    ds_read_b128 a[132:135], v29 offset:6400
    v_max3_f32 v249, v249, v5, v6
    v_mfma_f32_16x16x32_bf16 a[156:159], a[120:123], a[48:51], a[156:159]
    v_max3_f32 v249, v249, v7, v46
    v_mfma_f32_16x16x32_bf16 a[164:167], a[120:123], a[52:55], a[164:167]
    v_accvgpr_read_b32 v1, a152
    v_mfma_f32_16x16x32_bf16 a[172:175], a[120:123], a[56:59], a[172:175]
    v_accvgpr_read_b32 v2, a153
    s_waitcnt lgkmcnt(2)
    v_mfma_f32_16x16x32_bf16 a[140:143], a[124:127], a[60:63], a[140:143]
    v_add_u32 v26, 0x6000, v24
    v_add_u32 v27, 0x6000, v25
    v_accvgpr_read_b32 v3, a154
    buffer_load_dwordx4 v31, s[20:23], s48 offen offset:2048 nt lds
    v_mfma_f32_16x16x32_bf16 a[148:151], a[124:127], a[64:67], a[148:151]
    ds_read_b128 a[120:123], v26
    v_accvgpr_read_b32 v4, a155
    v_max3_f32 v250, v250, v1, v2
    v_mfma_f32_16x16x32_bf16 a[156:159], a[124:127], a[68:71], a[156:159]
    v_max3_f32 v250, v250, v3, v4
    v_mfma_f32_16x16x32_bf16 a[164:167], a[124:127], a[72:75], a[164:167]
    v_accvgpr_read_b32 v5, a160
    v_mfma_f32_16x16x32_bf16 a[172:175], a[124:127], a[76:79], a[172:175]
    v_accvgpr_read_b32 v6, a161
    s_waitcnt lgkmcnt(2)
    v_mfma_f32_16x16x32_bf16 a[140:143], a[128:131], a[80:83], a[140:143]
    v_accvgpr_read_b32 v7, a162
    v_mfma_f32_16x16x32_bf16 a[148:151], a[128:131], a[84:87], a[148:151]
    ds_read_b128 a[124:127], v27
    v_accvgpr_read_b32 v46, a163
    v_mfma_f32_16x16x32_bf16 a[156:159], a[128:131], a[88:91], a[156:159]
    v_max3_f32 v251, v251, v5, v6
    buffer_load_dwordx4 v32, s[20:23], s48 offen offset:3072 nt lds
    v_mfma_f32_16x16x32_bf16 a[164:167], a[128:131], a[92:95], a[164:167]
    v_max3_f32 v251, v251, v7, v46
    v_mfma_f32_16x16x32_bf16 a[172:175], a[128:131], a[96:99], a[172:175]
    v_accvgpr_read_b32 v1, a168
    s_waitcnt lgkmcnt(2)
    v_mfma_f32_16x16x32_bf16 a[140:143], a[132:135], a[100:103], a[140:143]
    v_accvgpr_read_b32 v2, a169
    v_mfma_f32_16x16x32_bf16 a[148:151], a[132:135], a[104:107], a[148:151]
    ds_read_b128 a[128:131], v26 offset:128
    v_accvgpr_read_b32 v3, a170
    v_mfma_f32_16x16x32_bf16 a[156:159], a[132:135], a[108:111], a[156:159]
    v_accvgpr_read_b32 v4, a171
    v_mfma_f32_16x16x32_bf16 a[164:167], a[132:135], a[112:115], a[164:167]
    v_max3_f32 v252, v252, v1, v2
    v_mfma_f32_16x16x32_bf16 a[172:175], a[132:135], a[116:119], a[172:175]
    v_max3_f32 v252, v252, v3, v4
    s_waitcnt vmcnt(4)
    s_barrier
    s_waitcnt lgkmcnt(2)
    v_mfma_f32_16x16x32_bf16 a[176:179], a[120:123], a[0:3], 0
    v_mfma_f32_16x16x32_bf16 a[184:187], a[120:123], a[4:7], 0
    ds_read_b128 a[132:135], v27 offset:128
    s_add_u32 m0, s53, 0
    s_add_u32 s48, s54, 24576
    v_mfma_f32_16x16x32_bf16 a[192:195], a[120:123], a[8:11], 0
    v_accvgpr_read_b32 v1, a140
    v_accvgpr_read_b32 v2, a141
    v_mfma_f32_16x16x32_bf16 a[200:203], a[120:123], a[12:15], 0
    v_accvgpr_read_b32 v3, a142
    v_mfma_f32_16x16x32_bf16 a[208:211], a[120:123], a[16:19], 0
    v_accvgpr_read_b32 v4, a143
    s_waitcnt lgkmcnt(2)
    v_mfma_f32_16x16x32_bf16 a[176:179], a[124:127], a[20:23], a[176:179]
    v_max3_f32 v248, v248, v1, v2
    buffer_load_dwordx4 v33, s[20:23], s48 offen nt lds
    v_mfma_f32_16x16x32_bf16 a[184:187], a[124:127], a[24:27], a[184:187]
    ds_read_b128 a[120:123], v26 offset:256
    v_max3_f32 v248, v248, v3, v4
    v_mfma_f32_16x16x32_bf16 a[192:195], a[124:127], a[28:31], a[192:195]
    v_accvgpr_read_b32 v5, a148
    v_mfma_f32_16x16x32_bf16 a[200:203], a[124:127], a[32:35], a[200:203]
    v_accvgpr_read_b32 v6, a149
    v_mfma_f32_16x16x32_bf16 a[208:211], a[124:127], a[36:39], a[208:211]
    v_accvgpr_read_b32 v7, a150
    s_waitcnt lgkmcnt(2)
    v_mfma_f32_16x16x32_bf16 a[176:179], a[128:131], a[40:43], a[176:179]
    v_accvgpr_read_b32 v46, a151
    buffer_load_dwordx4 v30, s[20:23], s48 offen offset:1024 nt lds
    v_mfma_f32_16x16x32_bf16 a[184:187], a[128:131], a[44:47], a[184:187]
    ds_read_b128 a[124:127], v27 offset:256
    v_max3_f32 v249, v249, v5, v6
    v_mfma_f32_16x16x32_bf16 a[192:195], a[128:131], a[48:51], a[192:195]
    v_max3_f32 v249, v249, v7, v46
    v_mfma_f32_16x16x32_bf16 a[200:203], a[128:131], a[52:55], a[200:203]
    v_accvgpr_read_b32 v1, a156
    v_mfma_f32_16x16x32_bf16 a[208:211], a[128:131], a[56:59], a[208:211]
    v_accvgpr_read_b32 v2, a157
    s_waitcnt lgkmcnt(2)
    v_mfma_f32_16x16x32_bf16 a[176:179], a[132:135], a[60:63], a[176:179]
    v_accvgpr_read_b32 v3, a158
    buffer_load_dwordx4 v31, s[20:23], s48 offen offset:2048 nt lds
    v_mfma_f32_16x16x32_bf16 a[184:187], a[132:135], a[64:67], a[184:187]
    ds_read_b128 a[128:131], v26 offset:6144
    v_accvgpr_read_b32 v4, a159
    v_max3_f32 v250, v250, v1, v2
    v_mfma_f32_16x16x32_bf16 a[192:195], a[132:135], a[68:71], a[192:195]
    v_max3_f32 v250, v250, v3, v4
    v_mfma_f32_16x16x32_bf16 a[200:203], a[132:135], a[72:75], a[200:203]
    v_accvgpr_read_b32 v5, a164
    v_mfma_f32_16x16x32_bf16 a[208:211], a[132:135], a[76:79], a[208:211]
    v_accvgpr_read_b32 v6, a165
    buffer_load_dwordx4 v32, s[20:23], s48 offen offset:3072 nt lds
    s_waitcnt lgkmcnt(2)
    v_mfma_f32_16x16x32_bf16 a[176:179], a[120:123], a[80:83], a[176:179]
    v_accvgpr_read_b32 v7, a166
    v_mfma_f32_16x16x32_bf16 a[184:187], a[120:123], a[84:87], a[184:187]
    ds_read_b128 a[132:135], v27 offset:6144
    v_accvgpr_read_b32 v46, a167
    v_mfma_f32_16x16x32_bf16 a[192:195], a[120:123], a[88:91], a[192:195]
    v_max3_f32 v251, v251, v5, v6
    v_mfma_f32_16x16x32_bf16 a[200:203], a[120:123], a[92:95], a[200:203]
    v_max3_f32 v251, v251, v7, v46
    v_mfma_f32_16x16x32_bf16 a[208:211], a[120:123], a[96:99], a[208:211]
    v_accvgpr_read_b32 v1, a172
    s_add_u32 m0, s53, 98304
    s_add_u32 s48, s54, 49152
    s_waitcnt lgkmcnt(2)
    v_mfma_f32_16x16x32_bf16 a[176:179], a[124:127], a[100:103], a[176:179]
    v_accvgpr_read_b32 v2, a173
    v_mfma_f32_16x16x32_bf16 a[184:187], a[124:127], a[104:107], a[184:187]
    ds_read_b128 a[120:123], v26 offset:6272
    v_accvgpr_read_b32 v3, a174
    v_mfma_f32_16x16x32_bf16 a[192:195], a[124:127], a[108:111], a[192:195]
    v_accvgpr_read_b32 v4, a175
    v_mfma_f32_16x16x32_bf16 a[200:203], a[124:127], a[112:115], a[200:203]
    v_max3_f32 v252, v252, v1, v2
    v_mfma_f32_16x16x32_bf16 a[208:211], a[124:127], a[116:119], a[208:211]
    v_max3_f32 v252, v252, v3, v4
    s_waitcnt lgkmcnt(2)
    v_mfma_f32_16x16x32_bf16 a[180:183], a[128:131], a[0:3], 0
    v_mfma_f32_16x16x32_bf16 a[188:191], a[128:131], a[4:7], 0
    ds_read_b128 a[124:127], v27 offset:6272
    buffer_load_dwordx4 v33, s[20:23], s48 offen nt lds
    v_mfma_f32_16x16x32_bf16 a[196:199], a[128:131], a[8:11], 0
    v_accvgpr_read_b32 v1, a176
    v_accvgpr_read_b32 v2, a177
    v_mfma_f32_16x16x32_bf16 a[204:207], a[128:131], a[12:15], 0
    v_accvgpr_read_b32 v3, a178
    v_mfma_f32_16x16x32_bf16 a[212:215], a[128:131], a[16:19], 0
    v_accvgpr_read_b32 v4, a179
    s_waitcnt lgkmcnt(2)
    v_mfma_f32_16x16x32_bf16 a[180:183], a[132:135], a[20:23], a[180:183]
    v_max3_f32 v248, v248, v1, v2
    v_mfma_f32_16x16x32_bf16 a[188:191], a[132:135], a[24:27], a[188:191]
    ds_read_b128 a[128:131], v26 offset:6400
    v_max3_f32 v248, v248, v3, v4
    v_mfma_f32_16x16x32_bf16 a[196:199], a[132:135], a[28:31], a[196:199]
    v_accvgpr_read_b32 v5, a184
    v_mfma_f32_16x16x32_bf16 a[204:207], a[132:135], a[32:35], a[204:207]
    v_accvgpr_read_b32 v6, a185
    buffer_load_dwordx4 v30, s[20:23], s48 offen offset:1024 nt lds
    v_mfma_f32_16x16x32_bf16 a[212:215], a[132:135], a[36:39], a[212:215]
    v_accvgpr_read_b32 v7, a186
    s_waitcnt lgkmcnt(2)
    v_mfma_f32_16x16x32_bf16 a[180:183], a[120:123], a[40:43], a[180:183]
    v_accvgpr_read_b32 v46, a187
    v_mfma_f32_16x16x32_bf16 a[188:191], a[120:123], a[44:47], a[188:191]
    ds_read_b128 a[132:135], v27 offset:6400
    v_max3_f32 v249, v249, v5, v6
    v_mfma_f32_16x16x32_bf16 a[196:199], a[120:123], a[48:51], a[196:199]
    v_max3_f32 v249, v249, v7, v46
    v_mfma_f32_16x16x32_bf16 a[204:207], a[120:123], a[52:55], a[204:207]
    v_accvgpr_read_b32 v1, a192
    v_mfma_f32_16x16x32_bf16 a[212:215], a[120:123], a[56:59], a[212:215]
    v_accvgpr_read_b32 v2, a193
    s_waitcnt lgkmcnt(2)
    v_mfma_f32_16x16x32_bf16 a[180:183], a[124:127], a[60:63], a[180:183]
    v_add_u32 v28, 0x12000, v24
    v_add_u32 v29, 0x12000, v25
    v_accvgpr_read_b32 v3, a194
    buffer_load_dwordx4 v31, s[20:23], s48 offen offset:2048 nt lds
    v_mfma_f32_16x16x32_bf16 a[188:191], a[124:127], a[64:67], a[188:191]
    ds_read_b128 a[120:123], v28
    v_accvgpr_read_b32 v4, a195
    v_max3_f32 v250, v250, v1, v2
    v_mfma_f32_16x16x32_bf16 a[196:199], a[124:127], a[68:71], a[196:199]
    v_max3_f32 v250, v250, v3, v4
    v_mfma_f32_16x16x32_bf16 a[204:207], a[124:127], a[72:75], a[204:207]
    v_accvgpr_read_b32 v5, a200
    v_mfma_f32_16x16x32_bf16 a[212:215], a[124:127], a[76:79], a[212:215]
    v_accvgpr_read_b32 v6, a201
    s_waitcnt lgkmcnt(2)
    v_mfma_f32_16x16x32_bf16 a[180:183], a[128:131], a[80:83], a[180:183]
    v_accvgpr_read_b32 v7, a202
    v_mfma_f32_16x16x32_bf16 a[188:191], a[128:131], a[84:87], a[188:191]
    ds_read_b128 a[124:127], v29
    v_accvgpr_read_b32 v46, a203
    v_mfma_f32_16x16x32_bf16 a[196:199], a[128:131], a[88:91], a[196:199]
    v_max3_f32 v251, v251, v5, v6
    buffer_load_dwordx4 v32, s[20:23], s48 offen offset:3072 nt lds
    v_mfma_f32_16x16x32_bf16 a[204:207], a[128:131], a[92:95], a[204:207]
    v_max3_f32 v251, v251, v7, v46
    v_mfma_f32_16x16x32_bf16 a[212:215], a[128:131], a[96:99], a[212:215]
    v_accvgpr_read_b32 v1, a208
    s_waitcnt lgkmcnt(2)
    v_mfma_f32_16x16x32_bf16 a[180:183], a[132:135], a[100:103], a[180:183]
    v_accvgpr_read_b32 v2, a209
    v_mfma_f32_16x16x32_bf16 a[188:191], a[132:135], a[104:107], a[188:191]
    ds_read_b128 a[128:131], v28 offset:128
    v_accvgpr_read_b32 v3, a210
    v_mfma_f32_16x16x32_bf16 a[196:199], a[132:135], a[108:111], a[196:199]
    v_accvgpr_read_b32 v4, a211
    v_mfma_f32_16x16x32_bf16 a[204:207], a[132:135], a[112:115], a[204:207]
    v_max3_f32 v252, v252, v1, v2
    v_mfma_f32_16x16x32_bf16 a[212:215], a[132:135], a[116:119], a[212:215]
    v_max3_f32 v252, v252, v3, v4
    s_barrier
    s_waitcnt lgkmcnt(2)
    v_mfma_f32_16x16x32_bf16 a[216:219], a[120:123], a[0:3], 0
    v_mfma_f32_16x16x32_bf16 a[224:227], a[120:123], a[4:7], 0
    ds_read_b128 a[132:135], v29 offset:128
    v_mfma_f32_16x16x32_bf16 a[232:235], a[120:123], a[8:11], 0
    v_accvgpr_read_b32 v1, a180
    v_accvgpr_read_b32 v2, a181
    v_mfma_f32_16x16x32_bf16 a[240:243], a[120:123], a[12:15], 0
    v_accvgpr_read_b32 v3, a182
    v_mfma_f32_16x16x32_bf16 a[248:251], a[120:123], a[16:19], 0
    v_accvgpr_read_b32 v4, a183
    s_waitcnt lgkmcnt(2)
    v_mfma_f32_16x16x32_bf16 a[216:219], a[124:127], a[20:23], a[216:219]
    v_max3_f32 v248, v248, v1, v2
    v_mfma_f32_16x16x32_bf16 a[224:227], a[124:127], a[24:27], a[224:227]
    ds_read_b128 a[120:123], v28 offset:256
    v_max3_f32 v248, v248, v3, v4
    v_mfma_f32_16x16x32_bf16 a[232:235], a[124:127], a[28:31], a[232:235]
    v_accvgpr_read_b32 v5, a188
    v_mfma_f32_16x16x32_bf16 a[240:243], a[124:127], a[32:35], a[240:243]
    v_accvgpr_read_b32 v6, a189
    v_mfma_f32_16x16x32_bf16 a[248:251], a[124:127], a[36:39], a[248:251]
    v_accvgpr_read_b32 v7, a190
    s_waitcnt lgkmcnt(2)
    v_mfma_f32_16x16x32_bf16 a[216:219], a[128:131], a[40:43], a[216:219]
    v_accvgpr_read_b32 v46, a191
    v_mfma_f32_16x16x32_bf16 a[224:227], a[128:131], a[44:47], a[224:227]
    ds_read_b128 a[124:127], v29 offset:256
    v_max3_f32 v249, v249, v5, v6
    v_mfma_f32_16x16x32_bf16 a[232:235], a[128:131], a[48:51], a[232:235]
    v_max3_f32 v249, v249, v7, v46
    v_mfma_f32_16x16x32_bf16 a[240:243], a[128:131], a[52:55], a[240:243]
    v_accvgpr_read_b32 v1, a196
    v_mfma_f32_16x16x32_bf16 a[248:251], a[128:131], a[56:59], a[248:251]
    v_accvgpr_read_b32 v2, a197
    s_waitcnt lgkmcnt(2)
    v_mfma_f32_16x16x32_bf16 a[216:219], a[132:135], a[60:63], a[216:219]
    v_accvgpr_read_b32 v3, a198
    v_mfma_f32_16x16x32_bf16 a[224:227], a[132:135], a[64:67], a[224:227]
    ds_read_b128 a[128:131], v28 offset:6144
    v_accvgpr_read_b32 v4, a199
    v_max3_f32 v250, v250, v1, v2
    v_mfma_f32_16x16x32_bf16 a[232:235], a[132:135], a[68:71], a[232:235]
    v_max3_f32 v250, v250, v3, v4
    v_mfma_f32_16x16x32_bf16 a[240:243], a[132:135], a[72:75], a[240:243]
    v_accvgpr_read_b32 v5, a204
    v_mfma_f32_16x16x32_bf16 a[248:251], a[132:135], a[76:79], a[248:251]
    v_accvgpr_read_b32 v6, a205
    s_waitcnt lgkmcnt(2)
    v_mfma_f32_16x16x32_bf16 a[216:219], a[120:123], a[80:83], a[216:219]
    v_accvgpr_read_b32 v7, a206
    v_mfma_f32_16x16x32_bf16 a[224:227], a[120:123], a[84:87], a[224:227]
    ds_read_b128 a[132:135], v29 offset:6144
    v_accvgpr_read_b32 v46, a207
    v_mfma_f32_16x16x32_bf16 a[232:235], a[120:123], a[88:91], a[232:235]
    v_max3_f32 v251, v251, v5, v6
    v_mfma_f32_16x16x32_bf16 a[240:243], a[120:123], a[92:95], a[240:243]
    v_max3_f32 v251, v251, v7, v46
    v_mfma_f32_16x16x32_bf16 a[248:251], a[120:123], a[96:99], a[248:251]
    v_accvgpr_read_b32 v1, a212
    s_waitcnt lgkmcnt(2)
    v_mfma_f32_16x16x32_bf16 a[216:219], a[124:127], a[100:103], a[216:219]
    v_accvgpr_read_b32 v2, a213
    v_mfma_f32_16x16x32_bf16 a[224:227], a[124:127], a[104:107], a[224:227]
    ds_read_b128 a[120:123], v28 offset:6272
    v_accvgpr_read_b32 v3, a214
    v_mfma_f32_16x16x32_bf16 a[232:235], a[124:127], a[108:111], a[232:235]
    v_accvgpr_read_b32 v4, a215
    v_mfma_f32_16x16x32_bf16 a[240:243], a[124:127], a[112:115], a[240:243]
    v_max3_f32 v252, v252, v1, v2
    v_mfma_f32_16x16x32_bf16 a[248:251], a[124:127], a[116:119], a[248:251]
    v_max3_f32 v252, v252, v3, v4
    s_waitcnt lgkmcnt(2)
    v_mfma_f32_16x16x32_bf16 a[220:223], a[128:131], a[0:3], 0
    v_mfma_f32_16x16x32_bf16 a[228:231], a[128:131], a[4:7], 0
    ds_read_b128 a[124:127], v29 offset:6272
    v_mfma_f32_16x16x32_bf16 a[236:239], a[128:131], a[8:11], 0
    v_accvgpr_read_b32 v1, a216
    v_accvgpr_read_b32 v2, a217
    v_mfma_f32_16x16x32_bf16 a[244:247], a[128:131], a[12:15], 0
    v_accvgpr_read_b32 v3, a218
    v_mfma_f32_16x16x32_bf16 a[252:255], a[128:131], a[16:19], 0
    v_accvgpr_read_b32 v4, a219
    s_waitcnt lgkmcnt(2)
    v_mfma_f32_16x16x32_bf16 a[220:223], a[132:135], a[20:23], a[220:223]
    v_max3_f32 v248, v248, v1, v2
    v_mfma_f32_16x16x32_bf16 a[228:231], a[132:135], a[24:27], a[228:231]
    ds_read_b128 a[128:131], v28 offset:6400
    v_max3_f32 v248, v248, v3, v4
    v_mfma_f32_16x16x32_bf16 a[236:239], a[132:135], a[28:31], a[236:239]
    v_accvgpr_read_b32 v5, a224
    v_mfma_f32_16x16x32_bf16 a[244:247], a[132:135], a[32:35], a[244:247]
    v_accvgpr_read_b32 v6, a225
    v_mfma_f32_16x16x32_bf16 a[252:255], a[132:135], a[36:39], a[252:255]
    v_accvgpr_read_b32 v7, a226
    s_waitcnt lgkmcnt(2)
    v_mfma_f32_16x16x32_bf16 a[220:223], a[120:123], a[40:43], a[220:223]
    v_accvgpr_read_b32 v46, a227
    v_mfma_f32_16x16x32_bf16 a[228:231], a[120:123], a[44:47], a[228:231]
    ds_read_b128 a[132:135], v29 offset:6400
    v_max3_f32 v249, v249, v5, v6
    v_mfma_f32_16x16x32_bf16 a[236:239], a[120:123], a[48:51], a[236:239]
    v_max3_f32 v249, v249, v7, v46
    v_mfma_f32_16x16x32_bf16 a[244:247], a[120:123], a[52:55], a[244:247]
    v_accvgpr_read_b32 v1, a232
    v_mfma_f32_16x16x32_bf16 a[252:255], a[120:123], a[56:59], a[252:255]
    v_accvgpr_read_b32 v2, a233
    s_waitcnt lgkmcnt(2)
    v_mfma_f32_16x16x32_bf16 a[220:223], a[124:127], a[60:63], a[220:223]
    v_accvgpr_read_b32 v3, a234
    v_mfma_f32_16x16x32_bf16 a[228:231], a[124:127], a[64:67], a[228:231]
    v_accvgpr_read_b32 v4, a235
    v_max3_f32 v250, v250, v1, v2
    v_mfma_f32_16x16x32_bf16 a[236:239], a[124:127], a[68:71], a[236:239]
    v_max3_f32 v250, v250, v3, v4
    v_mfma_f32_16x16x32_bf16 a[244:247], a[124:127], a[72:75], a[244:247]
    v_accvgpr_read_b32 v5, a240
    v_mfma_f32_16x16x32_bf16 a[252:255], a[124:127], a[76:79], a[252:255]
    v_accvgpr_read_b32 v6, a241
    s_waitcnt lgkmcnt(1)
    v_mfma_f32_16x16x32_bf16 a[220:223], a[128:131], a[80:83], a[220:223]
    v_accvgpr_read_b32 v7, a242
    v_mfma_f32_16x16x32_bf16 a[228:231], a[128:131], a[84:87], a[228:231]
    v_accvgpr_read_b32 v46, a243
    v_mfma_f32_16x16x32_bf16 a[236:239], a[128:131], a[88:91], a[236:239]
    v_max3_f32 v251, v251, v5, v6
    v_mfma_f32_16x16x32_bf16 a[244:247], a[128:131], a[92:95], a[244:247]
    v_max3_f32 v251, v251, v7, v46
    v_mfma_f32_16x16x32_bf16 a[252:255], a[128:131], a[96:99], a[252:255]
    v_accvgpr_read_b32 v1, a248
    s_waitcnt lgkmcnt(0)
    v_mfma_f32_16x16x32_bf16 a[220:223], a[132:135], a[100:103], a[220:223]
    v_accvgpr_read_b32 v2, a249
    v_mfma_f32_16x16x32_bf16 a[228:231], a[132:135], a[104:107], a[228:231]
    v_accvgpr_read_b32 v3, a250
    v_mfma_f32_16x16x32_bf16 a[236:239], a[132:135], a[108:111], a[236:239]
    v_accvgpr_read_b32 v4, a251
    v_mfma_f32_16x16x32_bf16 a[244:247], a[132:135], a[112:115], a[244:247]
    v_max3_f32 v252, v252, v1, v2
    v_mfma_f32_16x16x32_bf16 a[252:255], a[132:135], a[116:119], a[252:255]
    v_max3_f32 v252, v252, v3, v4
    s_waitcnt vmcnt(8)
    s_barrier
    v_accvgpr_read_b32 v1, a220
    v_accvgpr_read_b32 v2, a221
    v_accvgpr_read_b32 v3, a222
    v_accvgpr_read_b32 v4, a223
    v_max3_f32 v248, v248, v1, v2
    v_max3_f32 v248, v248, v3, v4
    v_accvgpr_read_b32 v5, a228
    v_accvgpr_read_b32 v6, a229
    v_accvgpr_read_b32 v7, a230
    v_accvgpr_read_b32 v46, a231
    v_max3_f32 v249, v249, v5, v6
    v_max3_f32 v249, v249, v7, v46
    v_accvgpr_read_b32 v1, a236
    v_accvgpr_read_b32 v2, a237
    v_accvgpr_read_b32 v3, a238
    v_accvgpr_read_b32 v4, a239
    v_max3_f32 v250, v250, v1, v2
    v_max3_f32 v250, v250, v3, v4
    v_accvgpr_read_b32 v5, a244
    v_accvgpr_read_b32 v6, a245
    v_accvgpr_read_b32 v7, a246
    v_accvgpr_read_b32 v46, a247
    v_max3_f32 v251, v251, v5, v6
    v_max3_f32 v251, v251, v7, v46
    v_accvgpr_read_b32 v1, a252
    v_accvgpr_read_b32 v2, a253
    v_accvgpr_read_b32 v3, a254
    v_accvgpr_read_b32 v4, a255
    v_max3_f32 v252, v252, v1, v2
    v_max3_f32 v252, v252, v3, v4
    v_mov_b32 v1, v248
    s_nop 1
    v_permlane16_swap_b32 v248, v1
    v_max_f32 v248, v248, v1
    v_mov_b32 v1, v248
    s_nop 1
    v_permlane32_swap_b32 v248, v1
    v_max_f32 v248, v248, v1
    v_mov_b32 v1, v249
    s_nop 1
    v_permlane16_swap_b32 v249, v1
    v_max_f32 v249, v249, v1
    v_mov_b32 v1, v249
    s_nop 1
    v_permlane32_swap_b32 v249, v1
    v_max_f32 v249, v249, v1
    v_mov_b32 v1, v250
    s_nop 1
    v_permlane16_swap_b32 v250, v1
    v_max_f32 v250, v250, v1
    v_mov_b32 v1, v250
    s_nop 1
    v_permlane32_swap_b32 v250, v1
    v_max_f32 v250, v250, v1
    v_mov_b32 v1, v251
    s_nop 1
    v_permlane16_swap_b32 v251, v1
    v_max_f32 v251, v251, v1
    v_mov_b32 v1, v251
    s_nop 1
    v_permlane32_swap_b32 v251, v1
    v_max_f32 v251, v251, v1
    v_mov_b32 v1, v252
    s_nop 1
    v_permlane16_swap_b32 v252, v1
    v_max_f32 v252, v252, v1
    v_mov_b32 v1, v252
    s_nop 1
    v_permlane32_swap_b32 v252, v1
    v_max_f32 v252, v252, v1
    v_and_b32 v1, 15, v0
    v_lshlrev_b32 v1, 2, v1
    s_mul_i32 s48, s28, 320
    s_add_u32 s48, s48, 159744
    v_add_u32 v253, s48, v1
    s_xor_b32 s48, s28, 2
    s_mul_i32 s48, s48, 320
    s_add_u32 s48, s48, 159744
    v_add_u32 v254, s48, v1
    ds_write_b32 v253, v248
    ds_write_b32 v253, v249 offset:64
    ds_write_b32 v253, v250 offset:128
    ds_write_b32 v253, v251 offset:192
    ds_write_b32 v253, v252 offset:256
    s_waitcnt lgkmcnt(0)
    s_barrier
    ds_read_b32 v3, v254
    ds_read_b32 v4, v254 offset:64
    ds_read_b32 v5, v254 offset:128
    ds_read_b32 v6, v254 offset:192
    ds_read_b32 v7, v254 offset:256
    s_add_u32 m0, s53, 16384
    s_add_u32 s48, s54, 73728
    buffer_load_dwordx4 v33, s[20:23], s48 offen nt lds
    buffer_load_dwordx4 v30, s[20:23], s48 offen offset:1024 nt lds
    buffer_load_dwordx4 v31, s[20:23], s48 offen offset:2048 nt lds
    buffer_load_dwordx4 v32, s[20:23], s48 offen offset:3072 nt lds
    v_lshlrev_b32 v1, 4, v0
    s_mul_i32 s48, s28, 10240
    s_add_u32 s48, s48, 118784
    v_add_u32 v13, s48, v1
    s_xor_b32 s48, s28, 2
    s_mul_i32 s48, s48, 10240
    s_add_u32 s48, s48, 118784
    v_add_u32 v14, s48, v1
    s_lshr_b32 s48, s28, 1
    s_mul_i32 s48, s48, 10240
    s_and_b32 s49, s28, 1
    s_mul_i32 s49, s49, 5120
    s_add_u32 s48, s48, s49
    s_add_u32 s49, s48, 0
    v_add_u32 v18, s49, v1
    s_add_u32 s48, s48, s59
    v_add_u32 v15, s48, v1
    v_add_u32 v16, 0x800, v253
    v_add_u32 v17, 0x800, v254
    s_waitcnt lgkmcnt(4)
    v_max_f32 v248, v248, v3
    v_mul_f32 v248, s51, v248
    s_waitcnt lgkmcnt(3)
    v_max_f32 v249, v249, v4
    v_mul_f32 v249, s51, v249
    s_waitcnt lgkmcnt(2)
    v_max_f32 v250, v250, v5
    v_mul_f32 v250, s51, v250
    s_waitcnt lgkmcnt(1)
    v_max_f32 v251, v251, v6
    v_mul_f32 v251, s51, v251
    s_waitcnt lgkmcnt(0)
    v_max_f32 v252, v252, v7
    v_mul_f32 v252, s51, v252
    v_mov_b32 v44, 0x3f803f80
    v_mov_b32 v45, 0x3f803f80
    v_mov_b32 v46, 0x3f803f80
    v_mov_b32 v47, 0x3f803f80
    v_fma_f32 v48, v48, s51, -v248
    v_fma_f32 v49, v49, s51, -v248
    v_fma_f32 v50, v50, s51, -v248
    v_fma_f32 v51, v51, s51, -v248
    v_fma_f32 v52, v52, s51, -v248
    v_fma_f32 v53, v53, s51, -v248
    v_fma_f32 v54, v54, s51, -v248
    v_fma_f32 v55, v55, s51, -v248
    v_exp_f32 v48, v48
    v_exp_f32 v49, v49
    v_exp_f32 v50, v50
    v_exp_f32 v51, v51
    v_exp_f32 v52, v52
    v_exp_f32 v53, v53
    v_exp_f32 v54, v54
    v_exp_f32 v55, v55
    v_cvt_pk_bf16_f32 v48, v48, v49
    v_cvt_pk_bf16_f32 v49, v50, v51
    v_cvt_pk_bf16_f32 v50, v52, v53
    v_cvt_pk_bf16_f32 v51, v54, v55
    v_fma_f32 v56, v56, s51, -v249
    v_fma_f32 v57, v57, s51, -v249
    v_fma_f32 v58, v58, s51, -v249
    v_fma_f32 v59, v59, s51, -v249
    v_fma_f32 v60, v60, s51, -v249
    v_fma_f32 v61, v61, s51, -v249
    v_fma_f32 v62, v62, s51, -v249
    v_fma_f32 v63, v63, s51, -v249
    v_exp_f32 v56, v56
    v_exp_f32 v57, v57
    v_exp_f32 v58, v58
    v_exp_f32 v59, v59
    v_exp_f32 v60, v60
    v_exp_f32 v61, v61
    v_exp_f32 v62, v62
    v_exp_f32 v63, v63
    v_cvt_pk_bf16_f32 v56, v56, v57
    v_cvt_pk_bf16_f32 v57, v58, v59
    v_cvt_pk_bf16_f32 v58, v60, v61
    v_cvt_pk_bf16_f32 v59, v62, v63
    v_fma_f32 v64, v64, s51, -v250
    v_fma_f32 v65, v65, s51, -v250
    v_fma_f32 v66, v66, s51, -v250
    v_fma_f32 v67, v67, s51, -v250
    v_fma_f32 v68, v68, s51, -v250
    v_fma_f32 v69, v69, s51, -v250
    v_fma_f32 v70, v70, s51, -v250
    v_fma_f32 v71, v71, s51, -v250
    v_exp_f32 v64, v64
    v_exp_f32 v65, v65
    v_exp_f32 v66, v66
    v_exp_f32 v67, v67
    v_exp_f32 v68, v68
    v_exp_f32 v69, v69
    v_exp_f32 v70, v70
    v_exp_f32 v71, v71
    v_cvt_pk_bf16_f32 v64, v64, v65
    v_cvt_pk_bf16_f32 v65, v66, v67
    v_cvt_pk_bf16_f32 v66, v68, v69
    v_cvt_pk_bf16_f32 v67, v70, v71
    v_fma_f32 v72, v72, s51, -v251
    v_fma_f32 v73, v73, s51, -v251
    v_fma_f32 v74, v74, s51, -v251
    v_fma_f32 v75, v75, s51, -v251
    v_fma_f32 v76, v76, s51, -v251
    v_fma_f32 v77, v77, s51, -v251
    v_fma_f32 v78, v78, s51, -v251
    v_fma_f32 v79, v79, s51, -v251
    v_exp_f32 v72, v72
    v_exp_f32 v73, v73
    v_exp_f32 v74, v74
    v_exp_f32 v75, v75
    v_exp_f32 v76, v76
    v_exp_f32 v77, v77
    v_exp_f32 v78, v78
    v_exp_f32 v79, v79
    v_cvt_pk_bf16_f32 v72, v72, v73
    v_cvt_pk_bf16_f32 v73, v74, v75
    v_cvt_pk_bf16_f32 v74, v76, v77
    v_cvt_pk_bf16_f32 v75, v78, v79
    v_fma_f32 v80, v80, s51, -v252
    v_fma_f32 v81, v81, s51, -v252
    v_fma_f32 v82, v82, s51, -v252
    v_fma_f32 v83, v83, s51, -v252
    v_fma_f32 v84, v84, s51, -v252
    v_fma_f32 v85, v85, s51, -v252
    v_fma_f32 v86, v86, s51, -v252
    v_fma_f32 v87, v87, s51, -v252
    v_exp_f32 v80, v80
    v_exp_f32 v81, v81
    v_exp_f32 v82, v82
    v_exp_f32 v83, v83
    v_exp_f32 v84, v84
    v_exp_f32 v85, v85
    v_exp_f32 v86, v86
    v_exp_f32 v87, v87
    v_cvt_pk_bf16_f32 v80, v80, v81
    v_cvt_pk_bf16_f32 v81, v82, v83
    v_cvt_pk_bf16_f32 v82, v84, v85
    v_cvt_pk_bf16_f32 v83, v86, v87
    s_waitcnt vmcnt(8)
    s_barrier
    v_add_u32 v36, 0xc000, v34
    v_xor_b32 v37, 32, v36
    v_xor_b32 v38, 64, v36
    v_xor_b32 v39, 0x60, v36
    ds_read_b64_tr_b16 a[100:101], v36
    ds_read_b64_tr_b16 a[102:103], v36 offset:2048
    ds_read_b64_tr_b16 a[104:105], v37
    ds_read_b64_tr_b16 a[106:107], v37 offset:2048
    ds_read_b64_tr_b16 a[108:109], v38
    ds_read_b64_tr_b16 a[110:111], v38 offset:2048
    s_waitcnt lgkmcnt(4)
    v_mfma_f32_16x16x32_bf16 a[0:3], a[100:103], v[48:51], 0
    v_fma_f32 v88, v88, s51, -v248
    v_fma_f32 v89, v89, s51, -v248
    v_fma_f32 v90, v90, s51, -v248
    v_fma_f32 v91, v91, s51, -v248
    v_mfma_f32_16x16x32_bf16 a[4:7], a[100:103], v[56:59], 0
    ds_read_b64_tr_b16 a[112:113], v39
    ds_read_b64_tr_b16 a[114:115], v39 offset:2048
    v_fma_f32 v92, v92, s51, -v248
    v_fma_f32 v93, v93, s51, -v248
    v_fma_f32 v94, v94, s51, -v248
    v_fma_f32 v95, v95, s51, -v248
    s_add_u32 m0, s53, 32768
    s_add_u32 s48, s54, 128
    v_mfma_f32_16x16x32_bf16 a[8:11], a[100:103], v[64:67], 0
    v_exp_f32 v88, v88
    v_exp_f32 v89, v89
    v_exp_f32 v90, v90
    v_exp_f32 v91, v91
    v_mfma_f32_16x16x32_bf16 a[12:15], a[100:103], v[72:75], 0
    v_exp_f32 v92, v92
    v_exp_f32 v93, v93
    v_exp_f32 v94, v94
    v_exp_f32 v95, v95
    v_mfma_f32_16x16x32_bf16 a[16:19], a[100:103], v[80:83], 0
    v_cvt_pk_bf16_f32 v88, v88, v89
    v_cvt_pk_bf16_f32 v89, v90, v91
    v_cvt_pk_bf16_f32 v90, v92, v93
    v_cvt_pk_bf16_f32 v91, v94, v95
    buffer_load_dwordx4 v33, s[20:23], s48 offen nt lds
    s_waitcnt lgkmcnt(4)
    v_mfma_f32_16x16x32_bf16 a[20:23], a[104:107], v[48:51], 0
    v_fma_f32 v96, v96, s51, -v249
    v_fma_f32 v97, v97, s51, -v249
    v_fma_f32 v98, v98, s51, -v249
    v_fma_f32 v99, v99, s51, -v249
    v_mfma_f32_16x16x32_bf16 a[24:27], a[104:107], v[56:59], 0
    ds_read_b64_tr_b16 a[100:101], v36 offset:4096
    ds_read_b64_tr_b16 a[102:103], v36 offset:6144
    v_fma_f32 v100, v100, s51, -v249
    v_fma_f32 v101, v101, s51, -v249
    v_fma_f32 v102, v102, s51, -v249
    v_fma_f32 v103, v103, s51, -v249
    v_mfma_f32_16x16x32_bf16 a[28:31], a[104:107], v[64:67], 0
    v_exp_f32 v96, v96
    v_exp_f32 v97, v97
    v_exp_f32 v98, v98
    v_exp_f32 v99, v99
    buffer_load_dwordx4 v30, s[20:23], s48 offen offset:1024 nt lds
    v_mfma_f32_16x16x32_bf16 a[32:35], a[104:107], v[72:75], 0
    v_exp_f32 v100, v100
    v_exp_f32 v101, v101
    v_exp_f32 v102, v102
    v_exp_f32 v103, v103
    v_mfma_f32_16x16x32_bf16 a[36:39], a[104:107], v[80:83], 0
    v_cvt_pk_bf16_f32 v96, v96, v97
    v_cvt_pk_bf16_f32 v97, v98, v99
    v_cvt_pk_bf16_f32 v98, v100, v101
    v_cvt_pk_bf16_f32 v99, v102, v103
    s_waitcnt lgkmcnt(4)
    v_mfma_f32_16x16x32_bf16 a[40:43], a[108:111], v[48:51], 0
    v_fma_f32 v104, v104, s51, -v250
    v_fma_f32 v105, v105, s51, -v250
    v_fma_f32 v106, v106, s51, -v250
    v_fma_f32 v107, v107, s51, -v250
    buffer_load_dwordx4 v31, s[20:23], s48 offen offset:2048 nt lds
    v_mfma_f32_16x16x32_bf16 a[44:47], a[108:111], v[56:59], 0
    ds_read_b64_tr_b16 a[104:105], v37 offset:4096
    ds_read_b64_tr_b16 a[106:107], v37 offset:6144
    v_fma_f32 v108, v108, s51, -v250
    v_fma_f32 v109, v109, s51, -v250
    v_fma_f32 v110, v110, s51, -v250
    v_fma_f32 v111, v111, s51, -v250
    v_mfma_f32_16x16x32_bf16 a[48:51], a[108:111], v[64:67], 0
    v_exp_f32 v104, v104
    v_exp_f32 v105, v105
    v_exp_f32 v106, v106
    v_exp_f32 v107, v107
    v_mfma_f32_16x16x32_bf16 a[52:55], a[108:111], v[72:75], 0
    v_exp_f32 v108, v108
    v_exp_f32 v109, v109
    v_exp_f32 v110, v110
    v_exp_f32 v111, v111
    buffer_load_dwordx4 v32, s[20:23], s48 offen offset:3072 nt lds
    v_mfma_f32_16x16x32_bf16 a[56:59], a[108:111], v[80:83], 0
    v_cvt_pk_bf16_f32 v104, v104, v105
    v_cvt_pk_bf16_f32 v105, v106, v107
    v_cvt_pk_bf16_f32 v106, v108, v109
    v_cvt_pk_bf16_f32 v107, v110, v111
    s_waitcnt lgkmcnt(4)
    v_mfma_f32_16x16x32_bf16 a[60:63], a[112:115], v[48:51], 0
    v_fma_f32 v112, v112, s51, -v251
    v_fma_f32 v113, v113, s51, -v251
    v_fma_f32 v114, v114, s51, -v251
    v_fma_f32 v115, v115, s51, -v251
    v_mfma_f32_16x16x32_bf16 a[64:67], a[112:115], v[56:59], 0
    ds_read_b64_tr_b16 a[108:109], v38 offset:4096
    ds_read_b64_tr_b16 a[110:111], v38 offset:6144
    v_fma_f32 v116, v116, s51, -v251
    v_fma_f32 v117, v117, s51, -v251
    v_fma_f32 v118, v118, s51, -v251
    v_fma_f32 v119, v119, s51, -v251
    v_mfma_f32_16x16x32_bf16 a[68:71], a[112:115], v[64:67], 0
    v_exp_f32 v112, v112
    v_exp_f32 v113, v113
    v_exp_f32 v114, v114
    v_exp_f32 v115, v115
    s_add_u32 m0, s53, 65536
    s_add_u32 s48, s54, 24704
    v_mfma_f32_16x16x32_bf16 a[72:75], a[112:115], v[72:75], 0
    v_exp_f32 v116, v116
    v_exp_f32 v117, v117
    v_exp_f32 v118, v118
    v_exp_f32 v119, v119
    v_mfma_f32_16x16x32_bf16 a[76:79], a[112:115], v[80:83], 0
    v_cvt_pk_bf16_f32 v112, v112, v113
    v_cvt_pk_bf16_f32 v113, v114, v115
    v_cvt_pk_bf16_f32 v114, v116, v117
    v_cvt_pk_bf16_f32 v115, v118, v119
    v_mfma_f32_16x16x32_bf16 a[80:83], v[44:47], v[48:51], 0
    v_fma_f32 v120, v120, s51, -v252
    v_fma_f32 v121, v121, s51, -v252
    v_fma_f32 v122, v122, s51, -v252
    v_fma_f32 v123, v123, s51, -v252
    buffer_load_dwordx4 v33, s[20:23], s48 offen nt lds
    v_mfma_f32_16x16x32_bf16 a[84:87], v[44:47], v[56:59], 0
    v_fma_f32 v124, v124, s51, -v252
    v_fma_f32 v125, v125, s51, -v252
    v_fma_f32 v126, v126, s51, -v252
    v_fma_f32 v127, v127, s51, -v252
    v_mfma_f32_16x16x32_bf16 a[88:91], v[44:47], v[64:67], 0
    v_exp_f32 v120, v120
    v_exp_f32 v121, v121
    v_exp_f32 v122, v122
    v_exp_f32 v123, v123
    v_mfma_f32_16x16x32_bf16 a[92:95], v[44:47], v[72:75], 0
    v_exp_f32 v124, v124
    v_exp_f32 v125, v125
    v_exp_f32 v126, v126
    v_exp_f32 v127, v127
    buffer_load_dwordx4 v30, s[20:23], s48 offen offset:1024 nt lds
    v_mfma_f32_16x16x32_bf16 a[96:99], v[44:47], v[80:83], 0
    v_cvt_pk_bf16_f32 v120, v120, v121
    v_cvt_pk_bf16_f32 v121, v122, v123
    v_cvt_pk_bf16_f32 v122, v124, v125
    v_cvt_pk_bf16_f32 v123, v126, v127
    s_waitcnt lgkmcnt(4)
    v_mfma_f32_16x16x32_bf16 a[0:3], a[100:103], v[88:91], a[0:3]
    v_fma_f32 v128, v128, s51, -v248
    v_fma_f32 v129, v129, s51, -v248
    v_fma_f32 v130, v130, s51, -v248
    v_fma_f32 v131, v131, s51, -v248
    v_mfma_f32_16x16x32_bf16 a[4:7], a[100:103], v[96:99], a[4:7]
    ds_read_b64_tr_b16 a[112:113], v39 offset:4096
    ds_read_b64_tr_b16 a[114:115], v39 offset:6144
    v_fma_f32 v132, v132, s51, -v248
    v_fma_f32 v133, v133, s51, -v248
    v_fma_f32 v134, v134, s51, -v248
    v_fma_f32 v135, v135, s51, -v248
    buffer_load_dwordx4 v31, s[20:23], s48 offen offset:2048 nt lds
    v_mfma_f32_16x16x32_bf16 a[8:11], a[100:103], v[104:107], a[8:11]
    v_exp_f32 v128, v128
    v_exp_f32 v129, v129
    v_exp_f32 v130, v130
    v_exp_f32 v131, v131
    v_mfma_f32_16x16x32_bf16 a[12:15], a[100:103], v[112:115], a[12:15]
    v_exp_f32 v132, v132
    v_exp_f32 v133, v133
    v_exp_f32 v134, v134
    v_exp_f32 v135, v135
    v_mfma_f32_16x16x32_bf16 a[16:19], a[100:103], v[120:123], a[16:19]
    v_cvt_pk_bf16_f32 v128, v128, v129
    v_cvt_pk_bf16_f32 v129, v130, v131
    v_cvt_pk_bf16_f32 v130, v132, v133
    v_cvt_pk_bf16_f32 v131, v134, v135
    buffer_load_dwordx4 v32, s[20:23], s48 offen offset:3072 nt lds
    s_waitcnt lgkmcnt(4)
    v_mfma_f32_16x16x32_bf16 a[20:23], a[104:107], v[88:91], a[20:23]
    v_add_u32 v40, 0, v34
    v_xor_b32 v41, 32, v40
    v_xor_b32 v42, 64, v40
    v_xor_b32 v43, 0x60, v40
    v_fma_f32 v136, v136, s51, -v249
    v_fma_f32 v137, v137, s51, -v249
    v_fma_f32 v138, v138, s51, -v249
    v_fma_f32 v139, v139, s51, -v249
    v_mfma_f32_16x16x32_bf16 a[24:27], a[104:107], v[96:99], a[24:27]
    ds_read_b64_tr_b16 a[100:101], v40
    ds_read_b64_tr_b16 a[102:103], v40 offset:2048
    v_fma_f32 v140, v140, s51, -v249
    v_fma_f32 v141, v141, s51, -v249
    v_fma_f32 v142, v142, s51, -v249
    v_fma_f32 v143, v143, s51, -v249
    v_mfma_f32_16x16x32_bf16 a[28:31], a[104:107], v[104:107], a[28:31]
    v_exp_f32 v136, v136
    v_exp_f32 v137, v137
    v_exp_f32 v138, v138
    v_exp_f32 v139, v139
    v_mfma_f32_16x16x32_bf16 a[32:35], a[104:107], v[112:115], a[32:35]
    v_exp_f32 v140, v140
    v_exp_f32 v141, v141
    v_exp_f32 v142, v142
    v_exp_f32 v143, v143
    s_add_u32 m0, s53, 81920
    s_add_u32 s48, s54, 49280
    v_mfma_f32_16x16x32_bf16 a[36:39], a[104:107], v[120:123], a[36:39]
    v_cvt_pk_bf16_f32 v136, v136, v137
    v_cvt_pk_bf16_f32 v137, v138, v139
    v_cvt_pk_bf16_f32 v138, v140, v141
    v_cvt_pk_bf16_f32 v139, v142, v143
    s_waitcnt lgkmcnt(4)
    v_mfma_f32_16x16x32_bf16 a[40:43], a[108:111], v[88:91], a[40:43]
    v_fma_f32 v144, v144, s51, -v250
    v_fma_f32 v145, v145, s51, -v250
    v_fma_f32 v146, v146, s51, -v250
    v_fma_f32 v147, v147, s51, -v250
    v_mfma_f32_16x16x32_bf16 a[44:47], a[108:111], v[96:99], a[44:47]
    ds_read_b64_tr_b16 a[104:105], v41
    ds_read_b64_tr_b16 a[106:107], v41 offset:2048
    v_fma_f32 v148, v148, s51, -v250
    v_fma_f32 v149, v149, s51, -v250
    v_fma_f32 v150, v150, s51, -v250
    v_fma_f32 v151, v151, s51, -v250
    buffer_load_dwordx4 v33, s[20:23], s48 offen nt lds
    v_mfma_f32_16x16x32_bf16 a[48:51], a[108:111], v[104:107], a[48:51]
    v_exp_f32 v144, v144
    v_exp_f32 v145, v145
    v_exp_f32 v146, v146
    v_exp_f32 v147, v147
    v_mfma_f32_16x16x32_bf16 a[52:55], a[108:111], v[112:115], a[52:55]
    v_exp_f32 v148, v148
    v_exp_f32 v149, v149
    v_exp_f32 v150, v150
    v_exp_f32 v151, v151
    v_mfma_f32_16x16x32_bf16 a[56:59], a[108:111], v[120:123], a[56:59]
    v_cvt_pk_bf16_f32 v144, v144, v145
    v_cvt_pk_bf16_f32 v145, v146, v147
    v_cvt_pk_bf16_f32 v146, v148, v149
    v_cvt_pk_bf16_f32 v147, v150, v151
    buffer_load_dwordx4 v30, s[20:23], s48 offen offset:1024 nt lds
    s_waitcnt lgkmcnt(4)
    v_mfma_f32_16x16x32_bf16 a[60:63], a[112:115], v[88:91], a[60:63]
    v_fma_f32 v152, v152, s51, -v251
    v_fma_f32 v153, v153, s51, -v251
    v_fma_f32 v154, v154, s51, -v251
    v_fma_f32 v155, v155, s51, -v251
    v_mfma_f32_16x16x32_bf16 a[64:67], a[112:115], v[96:99], a[64:67]
    ds_read_b64_tr_b16 a[108:109], v42
    ds_read_b64_tr_b16 a[110:111], v42 offset:2048
    v_fma_f32 v156, v156, s51, -v251
    v_fma_f32 v157, v157, s51, -v251
    v_fma_f32 v158, v158, s51, -v251
    v_fma_f32 v159, v159, s51, -v251
    v_mfma_f32_16x16x32_bf16 a[68:71], a[112:115], v[104:107], a[68:71]
    v_exp_f32 v152, v152
    v_exp_f32 v153, v153
    v_exp_f32 v154, v154
    v_exp_f32 v155, v155
    buffer_load_dwordx4 v31, s[20:23], s48 offen offset:2048 nt lds
    v_mfma_f32_16x16x32_bf16 a[72:75], a[112:115], v[112:115], a[72:75]
    v_exp_f32 v156, v156
    v_exp_f32 v157, v157
    v_exp_f32 v158, v158
    v_exp_f32 v159, v159
    v_mfma_f32_16x16x32_bf16 a[76:79], a[112:115], v[120:123], a[76:79]
    v_cvt_pk_bf16_f32 v152, v152, v153
    v_cvt_pk_bf16_f32 v153, v154, v155
    v_cvt_pk_bf16_f32 v154, v156, v157
    v_cvt_pk_bf16_f32 v155, v158, v159
    v_mfma_f32_16x16x32_bf16 a[80:83], v[44:47], v[88:91], a[80:83]
    v_fma_f32 v160, v160, s51, -v252
    v_fma_f32 v161, v161, s51, -v252
    v_fma_f32 v162, v162, s51, -v252
    v_fma_f32 v163, v163, s51, -v252
    buffer_load_dwordx4 v32, s[20:23], s48 offen offset:3072 nt lds
    v_mfma_f32_16x16x32_bf16 a[84:87], v[44:47], v[96:99], a[84:87]
    v_fma_f32 v164, v164, s51, -v252
    v_fma_f32 v165, v165, s51, -v252
    v_fma_f32 v166, v166, s51, -v252
    v_fma_f32 v167, v167, s51, -v252
    v_mfma_f32_16x16x32_bf16 a[88:91], v[44:47], v[104:107], a[88:91]
    v_exp_f32 v160, v160
    v_exp_f32 v161, v161
    v_exp_f32 v162, v162
    v_exp_f32 v163, v163
    v_mfma_f32_16x16x32_bf16 a[92:95], v[44:47], v[112:115], a[92:95]
    v_exp_f32 v164, v164
    v_exp_f32 v165, v165
    v_exp_f32 v166, v166
    v_exp_f32 v167, v167
    v_mfma_f32_16x16x32_bf16 a[96:99], v[44:47], v[120:123], a[96:99]
    v_cvt_pk_bf16_f32 v160, v160, v161
    v_cvt_pk_bf16_f32 v161, v162, v163
    v_cvt_pk_bf16_f32 v162, v164, v165
    v_cvt_pk_bf16_f32 v163, v166, v167
    s_waitcnt vmcnt(16)
    s_barrier
    s_waitcnt lgkmcnt(4)
    v_mfma_f32_16x16x32_bf16 a[0:3], a[100:103], v[128:131], a[0:3]
    v_fma_f32 v168, v168, s51, -v248
    v_fma_f32 v169, v169, s51, -v248
    v_fma_f32 v170, v170, s51, -v248
    v_fma_f32 v171, v171, s51, -v248
    v_mfma_f32_16x16x32_bf16 a[4:7], a[100:103], v[136:139], a[4:7]
    ds_read_b64_tr_b16 a[112:113], v43
    ds_read_b64_tr_b16 a[114:115], v43 offset:2048
    v_fma_f32 v172, v172, s51, -v248
    v_fma_f32 v173, v173, s51, -v248
    v_fma_f32 v174, v174, s51, -v248
    v_fma_f32 v175, v175, s51, -v248
    s_add_u32 m0, s53, 49152
    s_add_u32 s48, s54, 73856
    v_mfma_f32_16x16x32_bf16 a[8:11], a[100:103], v[144:147], a[8:11]
    v_exp_f32 v168, v168
    v_exp_f32 v169, v169
    v_exp_f32 v170, v170
    v_exp_f32 v171, v171
    v_mfma_f32_16x16x32_bf16 a[12:15], a[100:103], v[152:155], a[12:15]
    v_exp_f32 v172, v172
    v_exp_f32 v173, v173
    v_exp_f32 v174, v174
    v_exp_f32 v175, v175
    v_mfma_f32_16x16x32_bf16 a[16:19], a[100:103], v[160:163], a[16:19]
    v_cvt_pk_bf16_f32 v168, v168, v169
    v_cvt_pk_bf16_f32 v169, v170, v171
    v_cvt_pk_bf16_f32 v170, v172, v173
    v_cvt_pk_bf16_f32 v171, v174, v175
    s_waitcnt lgkmcnt(4)
    v_mfma_f32_16x16x32_bf16 a[20:23], a[104:107], v[128:131], a[20:23]
    v_fma_f32 v176, v176, s51, -v249
    v_fma_f32 v177, v177, s51, -v249
    v_fma_f32 v178, v178, s51, -v249
    v_fma_f32 v179, v179, s51, -v249
    v_mfma_f32_16x16x32_bf16 a[24:27], a[104:107], v[136:139], a[24:27]
    ds_read_b64_tr_b16 a[100:101], v40 offset:4096
    ds_read_b64_tr_b16 a[102:103], v40 offset:6144
    v_fma_f32 v180, v180, s51, -v249
    v_fma_f32 v181, v181, s51, -v249
    v_fma_f32 v182, v182, s51, -v249
    v_fma_f32 v183, v183, s51, -v249
    v_mfma_f32_16x16x32_bf16 a[28:31], a[104:107], v[144:147], a[28:31]
    v_exp_f32 v176, v176
    v_exp_f32 v177, v177
    v_exp_f32 v178, v178
    v_exp_f32 v179, v179
    v_mfma_f32_16x16x32_bf16 a[32:35], a[104:107], v[152:155], a[32:35]
    v_exp_f32 v180, v180
    v_exp_f32 v181, v181
    v_exp_f32 v182, v182
    v_exp_f32 v183, v183
    v_mfma_f32_16x16x32_bf16 a[36:39], a[104:107], v[160:163], a[36:39]
    v_cvt_pk_bf16_f32 v176, v176, v177
    v_cvt_pk_bf16_f32 v177, v178, v179
    v_cvt_pk_bf16_f32 v178, v180, v181
    v_cvt_pk_bf16_f32 v179, v182, v183
    s_waitcnt lgkmcnt(4)
    v_mfma_f32_16x16x32_bf16 a[40:43], a[108:111], v[128:131], a[40:43]
    v_fma_f32 v184, v184, s51, -v250
    v_fma_f32 v185, v185, s51, -v250
    v_fma_f32 v186, v186, s51, -v250
    v_fma_f32 v187, v187, s51, -v250
    buffer_load_dwordx4 v33, s[20:23], s48 offen nt lds
    v_mfma_f32_16x16x32_bf16 a[44:47], a[108:111], v[136:139], a[44:47]
    ds_read_b64_tr_b16 a[104:105], v41 offset:4096
    ds_read_b64_tr_b16 a[106:107], v41 offset:6144
    v_fma_f32 v188, v188, s51, -v250
    v_fma_f32 v189, v189, s51, -v250
    v_fma_f32 v190, v190, s51, -v250
    v_fma_f32 v191, v191, s51, -v250
    v_mfma_f32_16x16x32_bf16 a[48:51], a[108:111], v[144:147], a[48:51]
    v_exp_f32 v184, v184
    v_exp_f32 v185, v185
    v_exp_f32 v186, v186
    v_exp_f32 v187, v187
    v_mfma_f32_16x16x32_bf16 a[52:55], a[108:111], v[152:155], a[52:55]
    v_exp_f32 v188, v188
    v_exp_f32 v189, v189
    v_exp_f32 v190, v190
    v_exp_f32 v191, v191
    v_mfma_f32_16x16x32_bf16 a[56:59], a[108:111], v[160:163], a[56:59]
    v_cvt_pk_bf16_f32 v184, v184, v185
    v_cvt_pk_bf16_f32 v185, v186, v187
    v_cvt_pk_bf16_f32 v186, v188, v189
    v_cvt_pk_bf16_f32 v187, v190, v191
    s_waitcnt lgkmcnt(4)
    v_mfma_f32_16x16x32_bf16 a[60:63], a[112:115], v[128:131], a[60:63]
    v_fma_f32 v192, v192, s51, -v251
    v_fma_f32 v193, v193, s51, -v251
    v_fma_f32 v194, v194, s51, -v251
    v_fma_f32 v195, v195, s51, -v251
    v_mfma_f32_16x16x32_bf16 a[64:67], a[112:115], v[136:139], a[64:67]
    ds_read_b64_tr_b16 a[108:109], v42 offset:4096
    ds_read_b64_tr_b16 a[110:111], v42 offset:6144
    v_fma_f32 v196, v196, s51, -v251
    v_fma_f32 v197, v197, s51, -v251
    v_fma_f32 v198, v198, s51, -v251
    v_fma_f32 v199, v199, s51, -v251
    v_mfma_f32_16x16x32_bf16 a[68:71], a[112:115], v[144:147], a[68:71]
    v_exp_f32 v192, v192
    v_exp_f32 v193, v193
    v_exp_f32 v194, v194
    v_exp_f32 v195, v195
    v_mfma_f32_16x16x32_bf16 a[72:75], a[112:115], v[152:155], a[72:75]
    v_exp_f32 v196, v196
    v_exp_f32 v197, v197
    v_exp_f32 v198, v198
    v_exp_f32 v199, v199
    v_mfma_f32_16x16x32_bf16 a[76:79], a[112:115], v[160:163], a[76:79]
    v_cvt_pk_bf16_f32 v192, v192, v193
    v_cvt_pk_bf16_f32 v193, v194, v195
    v_cvt_pk_bf16_f32 v194, v196, v197
    v_cvt_pk_bf16_f32 v195, v198, v199
    v_mfma_f32_16x16x32_bf16 a[80:83], v[44:47], v[128:131], a[80:83]
    v_fma_f32 v200, v200, s51, -v252
    v_fma_f32 v201, v201, s51, -v252
    v_fma_f32 v202, v202, s51, -v252
    v_fma_f32 v203, v203, s51, -v252
    buffer_load_dwordx4 v30, s[20:23], s48 offen offset:1024 nt lds
    v_mfma_f32_16x16x32_bf16 a[84:87], v[44:47], v[136:139], a[84:87]
    v_fma_f32 v204, v204, s51, -v252
    v_fma_f32 v205, v205, s51, -v252
    v_fma_f32 v206, v206, s51, -v252
    v_fma_f32 v207, v207, s51, -v252
    v_mfma_f32_16x16x32_bf16 a[88:91], v[44:47], v[144:147], a[88:91]
    v_exp_f32 v200, v200
    v_exp_f32 v201, v201
    v_exp_f32 v202, v202
    v_exp_f32 v203, v203
    v_mfma_f32_16x16x32_bf16 a[92:95], v[44:47], v[152:155], a[92:95]
    v_exp_f32 v204, v204
    v_exp_f32 v205, v205
    v_exp_f32 v206, v206
    v_exp_f32 v207, v207
    v_mfma_f32_16x16x32_bf16 a[96:99], v[44:47], v[160:163], a[96:99]
    v_cvt_pk_bf16_f32 v200, v200, v201
    v_cvt_pk_bf16_f32 v201, v202, v203
    v_cvt_pk_bf16_f32 v202, v204, v205
    v_cvt_pk_bf16_f32 v203, v206, v207
    s_waitcnt lgkmcnt(4)
    v_mfma_f32_16x16x32_bf16 a[0:3], a[100:103], v[168:171], a[0:3]
    v_fma_f32 v208, v208, s51, -v248
    v_fma_f32 v209, v209, s51, -v248
    v_fma_f32 v210, v210, s51, -v248
    v_fma_f32 v211, v211, s51, -v248
    v_mfma_f32_16x16x32_bf16 a[4:7], a[100:103], v[176:179], a[4:7]
    ds_read_b64_tr_b16 a[112:113], v43 offset:4096
    ds_read_b64_tr_b16 a[114:115], v43 offset:6144
    v_fma_f32 v212, v212, s51, -v248
    v_fma_f32 v213, v213, s51, -v248
    v_fma_f32 v214, v214, s51, -v248
    v_fma_f32 v215, v215, s51, -v248
    v_mfma_f32_16x16x32_bf16 a[8:11], a[100:103], v[184:187], a[8:11]
    v_exp_f32 v208, v208
    v_exp_f32 v209, v209
    v_exp_f32 v210, v210
    v_exp_f32 v211, v211
    v_mfma_f32_16x16x32_bf16 a[12:15], a[100:103], v[192:195], a[12:15]
    v_exp_f32 v212, v212
    v_exp_f32 v213, v213
    v_exp_f32 v214, v214
    v_exp_f32 v215, v215
    v_mfma_f32_16x16x32_bf16 a[16:19], a[100:103], v[200:203], a[16:19]
    v_cvt_pk_bf16_f32 v208, v208, v209
    v_cvt_pk_bf16_f32 v209, v210, v211
    v_cvt_pk_bf16_f32 v210, v212, v213
    v_cvt_pk_bf16_f32 v211, v214, v215
    buffer_load_dwordx4 v31, s[20:23], s48 offen offset:2048 nt lds
    s_waitcnt lgkmcnt(4)
    v_mfma_f32_16x16x32_bf16 a[20:23], a[104:107], v[168:171], a[20:23]
    v_add_u32 v36, 0x18000, v34
    v_xor_b32 v37, 32, v36
    v_xor_b32 v38, 64, v36
    v_xor_b32 v39, 0x60, v36
    v_fma_f32 v216, v216, s51, -v249
    v_fma_f32 v217, v217, s51, -v249
    v_fma_f32 v218, v218, s51, -v249
    v_fma_f32 v219, v219, s51, -v249
    v_mfma_f32_16x16x32_bf16 a[24:27], a[104:107], v[176:179], a[24:27]
    ds_read_b64_tr_b16 a[100:101], v36
    ds_read_b64_tr_b16 a[102:103], v36 offset:2048
    v_fma_f32 v220, v220, s51, -v249
    v_fma_f32 v221, v221, s51, -v249
    v_fma_f32 v222, v222, s51, -v249
    v_fma_f32 v223, v223, s51, -v249
    v_mfma_f32_16x16x32_bf16 a[28:31], a[104:107], v[184:187], a[28:31]
    v_exp_f32 v216, v216
    v_exp_f32 v217, v217
    v_exp_f32 v218, v218
    v_exp_f32 v219, v219
    v_mfma_f32_16x16x32_bf16 a[32:35], a[104:107], v[192:195], a[32:35]
    v_exp_f32 v220, v220
    v_exp_f32 v221, v221
    v_exp_f32 v222, v222
    v_exp_f32 v223, v223
    v_mfma_f32_16x16x32_bf16 a[36:39], a[104:107], v[200:203], a[36:39]
    v_cvt_pk_bf16_f32 v216, v216, v217
    v_cvt_pk_bf16_f32 v217, v218, v219
    v_cvt_pk_bf16_f32 v218, v220, v221
    v_cvt_pk_bf16_f32 v219, v222, v223
    s_waitcnt lgkmcnt(4)
    v_mfma_f32_16x16x32_bf16 a[40:43], a[108:111], v[168:171], a[40:43]
    v_fma_f32 v224, v224, s51, -v250
    v_fma_f32 v225, v225, s51, -v250
    v_fma_f32 v226, v226, s51, -v250
    v_fma_f32 v227, v227, s51, -v250
    v_mfma_f32_16x16x32_bf16 a[44:47], a[108:111], v[176:179], a[44:47]
    ds_read_b64_tr_b16 a[104:105], v37
    ds_read_b64_tr_b16 a[106:107], v37 offset:2048
    v_fma_f32 v228, v228, s51, -v250
    v_fma_f32 v229, v229, s51, -v250
    v_fma_f32 v230, v230, s51, -v250
    v_fma_f32 v231, v231, s51, -v250
    v_mfma_f32_16x16x32_bf16 a[48:51], a[108:111], v[184:187], a[48:51]
    v_exp_f32 v224, v224
    v_exp_f32 v225, v225
    v_exp_f32 v226, v226
    v_exp_f32 v227, v227
    v_mfma_f32_16x16x32_bf16 a[52:55], a[108:111], v[192:195], a[52:55]
    v_exp_f32 v228, v228
    v_exp_f32 v229, v229
    v_exp_f32 v230, v230
    v_exp_f32 v231, v231
    v_mfma_f32_16x16x32_bf16 a[56:59], a[108:111], v[200:203], a[56:59]
    v_cvt_pk_bf16_f32 v224, v224, v225
    v_cvt_pk_bf16_f32 v225, v226, v227
    v_cvt_pk_bf16_f32 v226, v228, v229
    v_cvt_pk_bf16_f32 v227, v230, v231
    buffer_load_dwordx4 v32, s[20:23], s48 offen offset:3072 nt lds
    s_waitcnt lgkmcnt(4)
    v_mfma_f32_16x16x32_bf16 a[60:63], a[112:115], v[168:171], a[60:63]
    v_fma_f32 v232, v232, s51, -v251
    v_fma_f32 v233, v233, s51, -v251
    v_fma_f32 v234, v234, s51, -v251
    v_fma_f32 v235, v235, s51, -v251
    v_mfma_f32_16x16x32_bf16 a[64:67], a[112:115], v[176:179], a[64:67]
    ds_read_b64_tr_b16 a[108:109], v38
    ds_read_b64_tr_b16 a[110:111], v38 offset:2048
    v_fma_f32 v236, v236, s51, -v251
    v_fma_f32 v237, v237, s51, -v251
    v_fma_f32 v238, v238, s51, -v251
    v_fma_f32 v239, v239, s51, -v251
    v_mfma_f32_16x16x32_bf16 a[68:71], a[112:115], v[184:187], a[68:71]
    v_exp_f32 v232, v232
    v_exp_f32 v233, v233
    v_exp_f32 v234, v234
    v_exp_f32 v235, v235
    v_mfma_f32_16x16x32_bf16 a[72:75], a[112:115], v[192:195], a[72:75]
    v_exp_f32 v236, v236
    v_exp_f32 v237, v237
    v_exp_f32 v238, v238
    v_exp_f32 v239, v239
    v_mfma_f32_16x16x32_bf16 a[76:79], a[112:115], v[200:203], a[76:79]
    v_cvt_pk_bf16_f32 v232, v232, v233
    v_cvt_pk_bf16_f32 v233, v234, v235
    v_cvt_pk_bf16_f32 v234, v236, v237
    v_cvt_pk_bf16_f32 v235, v238, v239
    v_mfma_f32_16x16x32_bf16 a[80:83], v[44:47], v[168:171], a[80:83]
    v_fma_f32 v240, v240, s51, -v252
    v_fma_f32 v241, v241, s51, -v252
    v_fma_f32 v242, v242, s51, -v252
    v_fma_f32 v243, v243, s51, -v252
    v_mfma_f32_16x16x32_bf16 a[84:87], v[44:47], v[176:179], a[84:87]
    v_fma_f32 v244, v244, s51, -v252
    v_fma_f32 v245, v245, s51, -v252
    v_fma_f32 v246, v246, s51, -v252
    v_fma_f32 v247, v247, s51, -v252
    v_mfma_f32_16x16x32_bf16 a[88:91], v[44:47], v[184:187], a[88:91]
    v_exp_f32 v240, v240
    v_exp_f32 v241, v241
    v_exp_f32 v242, v242
    v_exp_f32 v243, v243
    v_mfma_f32_16x16x32_bf16 a[92:95], v[44:47], v[192:195], a[92:95]
    v_exp_f32 v244, v244
    v_exp_f32 v245, v245
    v_exp_f32 v246, v246
    v_exp_f32 v247, v247
    v_mfma_f32_16x16x32_bf16 a[96:99], v[44:47], v[200:203], a[96:99]
    v_cvt_pk_bf16_f32 v240, v240, v241
    v_cvt_pk_bf16_f32 v241, v242, v243
    v_cvt_pk_bf16_f32 v242, v244, v245
    v_cvt_pk_bf16_f32 v243, v246, v247
    s_waitcnt vmcnt(16)
    s_barrier
    s_waitcnt lgkmcnt(4)
    v_mfma_f32_16x16x32_bf16 a[0:3], a[100:103], v[208:211], a[0:3]
    v_accvgpr_read_b32 v172, a136
    v_accvgpr_read_b32 v173, a137
    v_accvgpr_read_b32 v174, a138
    v_accvgpr_read_b32 v175, a139
    v_accvgpr_read_b32 v180, a140
    v_accvgpr_read_b32 v181, a141
    v_mfma_f32_16x16x32_bf16 a[4:7], a[100:103], v[216:219], a[4:7]
    ds_read_b64_tr_b16 a[112:113], v39
    ds_read_b64_tr_b16 a[114:115], v39 offset:2048
    v_accvgpr_read_b32 v182, a142
    v_accvgpr_read_b32 v183, a143
    v_fma_f32 v172, v172, s51, -v248
    v_fma_f32 v173, v173, s51, -v248
    v_fma_f32 v174, v174, s51, -v248
    v_fma_f32 v175, v175, s51, -v248
    s_add_u32 m0, s53, 0
    s_add_u32 s48, s54, 256
    v_mfma_f32_16x16x32_bf16 a[8:11], a[100:103], v[224:227], a[8:11]
    v_fma_f32 v180, v180, s51, -v248
    v_fma_f32 v181, v181, s51, -v248
    v_fma_f32 v182, v182, s51, -v248
    v_fma_f32 v183, v183, s51, -v248
    v_exp_f32 v172, v172
    v_mfma_f32_16x16x32_bf16 a[12:15], a[100:103], v[232:235], a[12:15]
    v_exp_f32 v173, v173
    v_exp_f32 v174, v174
    v_exp_f32 v175, v175
    v_exp_f32 v180, v180
    v_exp_f32 v181, v181
    v_exp_f32 v182, v182
    v_mfma_f32_16x16x32_bf16 a[16:19], a[100:103], v[240:243], a[16:19]
    v_exp_f32 v183, v183
    v_cvt_pk_bf16_f32 v52, v172, v173
    v_cvt_pk_bf16_f32 v53, v174, v175
    v_cvt_pk_bf16_f32 v54, v180, v181
    v_cvt_pk_bf16_f32 v55, v182, v183
    v_mul_u32_u24 v20, 0xccd, v0
    s_waitcnt lgkmcnt(4)
    v_mfma_f32_16x16x32_bf16 a[20:23], a[104:107], v[208:211], a[20:23]
    v_accvgpr_read_b32 v188, a144
    v_accvgpr_read_b32 v189, a145
    v_accvgpr_read_b32 v190, a146
    v_accvgpr_read_b32 v191, a147
    v_accvgpr_read_b32 v196, a148
    v_accvgpr_read_b32 v197, a149
    v_mfma_f32_16x16x32_bf16 a[24:27], a[104:107], v[216:219], a[24:27]
    ds_read_b64_tr_b16 a[100:101], v36 offset:4096
    ds_read_b64_tr_b16 a[102:103], v36 offset:6144
    v_accvgpr_read_b32 v198, a150
    v_accvgpr_read_b32 v199, a151
    v_fma_f32 v188, v188, s51, -v249
    v_fma_f32 v189, v189, s51, -v249
    v_fma_f32 v190, v190, s51, -v249
    v_fma_f32 v191, v191, s51, -v249
    v_lshrrev_b32 v20, 16, v20
    v_mfma_f32_16x16x32_bf16 a[28:31], a[104:107], v[224:227], a[28:31]
    v_fma_f32 v196, v196, s51, -v249
    v_fma_f32 v197, v197, s51, -v249
    v_fma_f32 v198, v198, s51, -v249
    v_fma_f32 v199, v199, s51, -v249
    v_exp_f32 v188, v188
    v_mfma_f32_16x16x32_bf16 a[32:35], a[104:107], v[232:235], a[32:35]
    v_exp_f32 v189, v189
    v_exp_f32 v190, v190
    v_exp_f32 v191, v191
    v_exp_f32 v196, v196
    v_exp_f32 v197, v197
    v_exp_f32 v198, v198
    v_mfma_f32_16x16x32_bf16 a[36:39], a[104:107], v[240:243], a[36:39]
    v_exp_f32 v199, v199
    v_cvt_pk_bf16_f32 v60, v188, v189
    v_cvt_pk_bf16_f32 v61, v190, v191
    v_cvt_pk_bf16_f32 v62, v196, v197
    v_cvt_pk_bf16_f32 v63, v198, v199
    v_mul_u32_u24 v19, 20, v20
    s_waitcnt lgkmcnt(4)
    v_mfma_f32_16x16x32_bf16 a[40:43], a[108:111], v[208:211], a[40:43]
    v_accvgpr_read_b32 v204, a152
    v_accvgpr_read_b32 v205, a153
    v_accvgpr_read_b32 v206, a154
    v_accvgpr_read_b32 v207, a155
    v_accvgpr_read_b32 v212, a156
    v_accvgpr_read_b32 v213, a157
    buffer_load_dwordx4 v33, s[20:23], s48 offen nt lds
    v_mfma_f32_16x16x32_bf16 a[44:47], a[108:111], v[216:219], a[44:47]
    ds_read_b64_tr_b16 a[104:105], v37 offset:4096
    ds_read_b64_tr_b16 a[106:107], v37 offset:6144
    v_accvgpr_read_b32 v214, a158
    v_accvgpr_read_b32 v215, a159
    v_fma_f32 v204, v204, s51, -v250
    v_fma_f32 v205, v205, s51, -v250
    v_fma_f32 v206, v206, s51, -v250
    v_fma_f32 v207, v207, s51, -v250
    v_mfma_f32_16x16x32_bf16 a[48:51], a[108:111], v[224:227], a[48:51]
    v_fma_f32 v212, v212, s51, -v250
    v_fma_f32 v213, v213, s51, -v250
    v_fma_f32 v214, v214, s51, -v250
    v_fma_f32 v215, v215, s51, -v250
    v_exp_f32 v204, v204
    v_sub_u32 v19, v0, v19
    v_mfma_f32_16x16x32_bf16 a[52:55], a[108:111], v[232:235], a[52:55]
    v_exp_f32 v205, v205
    v_exp_f32 v206, v206
    v_exp_f32 v207, v207
    v_exp_f32 v212, v212
    v_exp_f32 v213, v213
    v_exp_f32 v214, v214
    v_mfma_f32_16x16x32_bf16 a[56:59], a[108:111], v[240:243], a[56:59]
    v_exp_f32 v215, v215
    v_cvt_pk_bf16_f32 v68, v204, v205
    v_cvt_pk_bf16_f32 v69, v206, v207
    v_cvt_pk_bf16_f32 v70, v212, v213
    v_cvt_pk_bf16_f32 v71, v214, v215
    s_waitcnt lgkmcnt(4)
    v_mfma_f32_16x16x32_bf16 a[60:63], a[112:115], v[208:211], a[60:63]
    v_accvgpr_read_b32 v220, a160
    v_accvgpr_read_b32 v221, a161
    v_accvgpr_read_b32 v222, a162
    v_accvgpr_read_b32 v223, a163
    v_accvgpr_read_b32 v228, a164
    v_accvgpr_read_b32 v229, a165
    v_lshlrev_b32 v19, 4, v19
    v_mfma_f32_16x16x32_bf16 a[64:67], a[112:115], v[216:219], a[64:67]
    ds_read_b64_tr_b16 a[108:109], v38 offset:4096
    ds_read_b64_tr_b16 a[110:111], v38 offset:6144
    v_accvgpr_read_b32 v230, a166
    v_accvgpr_read_b32 v231, a167
    v_fma_f32 v220, v220, s51, -v251
    v_fma_f32 v221, v221, s51, -v251
    v_fma_f32 v222, v222, s51, -v251
    v_fma_f32 v223, v223, s51, -v251
    v_mfma_f32_16x16x32_bf16 a[68:71], a[112:115], v[224:227], a[68:71]
    v_fma_f32 v228, v228, s51, -v251
    v_fma_f32 v229, v229, s51, -v251
    v_fma_f32 v230, v230, s51, -v251
    v_fma_f32 v231, v231, s51, -v251
    v_exp_f32 v220, v220
    v_mfma_f32_16x16x32_bf16 a[72:75], a[112:115], v[232:235], a[72:75]
    v_exp_f32 v221, v221
    v_exp_f32 v222, v222
    v_exp_f32 v223, v223
    v_exp_f32 v228, v228
    v_exp_f32 v229, v229
    v_exp_f32 v230, v230
    v_mul_u32_u24 v20, 0x500, v20
    v_mfma_f32_16x16x32_bf16 a[76:79], a[112:115], v[240:243], a[76:79]
    v_exp_f32 v231, v231
    v_cvt_pk_bf16_f32 v76, v220, v221
    v_cvt_pk_bf16_f32 v77, v222, v223
    v_cvt_pk_bf16_f32 v78, v228, v229
    v_cvt_pk_bf16_f32 v79, v230, v231
    v_mfma_f32_16x16x32_bf16 a[80:83], v[44:47], v[208:211], a[80:83]
    v_accvgpr_read_b32 v236, a168
    v_accvgpr_read_b32 v237, a169
    v_accvgpr_read_b32 v238, a170
    v_accvgpr_read_b32 v239, a171
    v_accvgpr_read_b32 v244, a172
    v_accvgpr_read_b32 v245, a173
    buffer_load_dwordx4 v30, s[20:23], s48 offen offset:1024 nt lds
    v_add_u32 v19, v19, v20
    v_mfma_f32_16x16x32_bf16 a[84:87], v[44:47], v[216:219], a[84:87]
    v_accvgpr_read_b32 v246, a174
    v_accvgpr_read_b32 v247, a175
    v_fma_f32 v236, v236, s51, -v252
    v_fma_f32 v237, v237, s51, -v252
    v_fma_f32 v238, v238, s51, -v252
    v_fma_f32 v239, v239, s51, -v252
    v_mfma_f32_16x16x32_bf16 a[88:91], v[44:47], v[224:227], a[88:91]
    v_fma_f32 v244, v244, s51, -v252
    v_fma_f32 v245, v245, s51, -v252
    v_fma_f32 v246, v246, s51, -v252
    v_fma_f32 v247, v247, s51, -v252
    v_exp_f32 v236, v236
    v_mfma_f32_16x16x32_bf16 a[92:95], v[44:47], v[232:235], a[92:95]
    v_exp_f32 v237, v237
    v_exp_f32 v238, v238
    v_exp_f32 v239, v239
    v_exp_f32 v244, v244
    v_exp_f32 v245, v245
    v_exp_f32 v246, v246
    s_mul_i32 s50, s74, 983040
    s_mul_i32 s49, s29, 122880
    s_add_u32 s50, s50, s49
    s_mul_i32 s49, s28, 30720
    s_add_u32 s50, s50, s49
    v_mfma_f32_16x16x32_bf16 a[96:99], v[44:47], v[240:243], a[96:99]
    v_exp_f32 v247, v247
    v_cvt_pk_bf16_f32 v84, v236, v237
    v_cvt_pk_bf16_f32 v85, v238, v239
    v_cvt_pk_bf16_f32 v86, v244, v245
    v_cvt_pk_bf16_f32 v87, v246, v247
    s_waitcnt lgkmcnt(4)
    v_mfma_f32_16x16x32_bf16 a[0:3], a[100:103], v[52:55], a[0:3]
    v_accvgpr_read_b32 v172, a176
    v_accvgpr_read_b32 v173, a177
    v_accvgpr_read_b32 v174, a178
    v_accvgpr_read_b32 v175, a179
    v_accvgpr_read_b32 v180, a180
    v_accvgpr_read_b32 v181, a181
    v_mfma_f32_16x16x32_bf16 a[4:7], a[100:103], v[60:63], a[4:7]
    ds_read_b64_tr_b16 a[112:113], v39 offset:4096
    ds_read_b64_tr_b16 a[114:115], v39 offset:6144
    v_accvgpr_read_b32 v182, a182
    v_accvgpr_read_b32 v183, a183
    v_fma_f32 v172, v172, s51, -v248
    v_fma_f32 v173, v173, s51, -v248
    v_fma_f32 v174, v174, s51, -v248
    v_fma_f32 v175, v175, s51, -v248
    buffer_load_dwordx4 v[24:27], v19, s[40:43], s50 offen
    s_add_u32 s50, s50, 3840
    v_mfma_f32_16x16x32_bf16 a[8:11], a[100:103], v[68:71], a[8:11]
    v_fma_f32 v180, v180, s51, -v248
    v_fma_f32 v181, v181, s51, -v248
    v_fma_f32 v182, v182, s51, -v248
    v_fma_f32 v183, v183, s51, -v248
    v_exp_f32 v172, v172
    v_mfma_f32_16x16x32_bf16 a[12:15], a[100:103], v[76:79], a[12:15]
    v_exp_f32 v173, v173
    v_exp_f32 v174, v174
    v_exp_f32 v175, v175
    v_exp_f32 v180, v180
    v_exp_f32 v181, v181
    v_exp_f32 v182, v182
    v_mfma_f32_16x16x32_bf16 a[16:19], a[100:103], v[84:87], a[16:19]
    v_exp_f32 v183, v183
    v_cvt_pk_bf16_f32 v92, v172, v173
    v_cvt_pk_bf16_f32 v93, v174, v175
    v_cvt_pk_bf16_f32 v94, v180, v181
    v_cvt_pk_bf16_f32 v95, v182, v183
    buffer_load_dwordx4 v31, s[20:23], s48 offen offset:2048 nt lds
    buffer_load_dwordx4 v[24:27], v19, s[40:43], s50 offen
    s_add_u32 s50, s50, 3840
    s_waitcnt lgkmcnt(4)
    v_mfma_f32_16x16x32_bf16 a[20:23], a[104:107], v[52:55], a[20:23]
    v_add_u32 v40, 0x4000, v34
    v_xor_b32 v41, 32, v40
    v_xor_b32 v42, 64, v40
    v_xor_b32 v43, 0x60, v40
    v_accvgpr_read_b32 v188, a184
    v_accvgpr_read_b32 v189, a185
    v_accvgpr_read_b32 v190, a186
    v_accvgpr_read_b32 v191, a187
    v_accvgpr_read_b32 v196, a188
    v_accvgpr_read_b32 v197, a189
    v_mfma_f32_16x16x32_bf16 a[24:27], a[104:107], v[60:63], a[24:27]
    ds_read_b64_tr_b16 a[100:101], v40
    ds_read_b64_tr_b16 a[102:103], v40 offset:2048
    v_accvgpr_read_b32 v198, a190
    v_accvgpr_read_b32 v199, a191
    v_fma_f32 v188, v188, s51, -v249
    v_fma_f32 v189, v189, s51, -v249
    v_fma_f32 v190, v190, s51, -v249
    v_fma_f32 v191, v191, s51, -v249
    v_mfma_f32_16x16x32_bf16 a[28:31], a[104:107], v[68:71], a[28:31]
    v_fma_f32 v196, v196, s51, -v249
    v_fma_f32 v197, v197, s51, -v249
    v_fma_f32 v198, v198, s51, -v249
    v_fma_f32 v199, v199, s51, -v249
    v_exp_f32 v188, v188
    buffer_load_dwordx4 v[24:27], v19, s[40:43], s50 offen
    s_add_u32 s50, s50, 3840
    v_mfma_f32_16x16x32_bf16 a[32:35], a[104:107], v[76:79], a[32:35]
    v_exp_f32 v189, v189
    v_exp_f32 v190, v190
    v_exp_f32 v191, v191
    v_exp_f32 v196, v196
    v_exp_f32 v197, v197
    v_exp_f32 v198, v198
    v_mfma_f32_16x16x32_bf16 a[36:39], a[104:107], v[84:87], a[36:39]
    v_exp_f32 v199, v199
    v_cvt_pk_bf16_f32 v100, v188, v189
    v_cvt_pk_bf16_f32 v101, v190, v191
    v_cvt_pk_bf16_f32 v102, v196, v197
    v_cvt_pk_bf16_f32 v103, v198, v199
    buffer_load_dwordx4 v[24:27], v19, s[40:43], s50 offen
    s_add_u32 s50, s50, 3840
    s_waitcnt lgkmcnt(4)
    v_mfma_f32_16x16x32_bf16 a[40:43], a[108:111], v[52:55], a[40:43]
    v_accvgpr_read_b32 v204, a192
    v_accvgpr_read_b32 v205, a193
    v_accvgpr_read_b32 v206, a194
    v_accvgpr_read_b32 v207, a195
    v_accvgpr_read_b32 v212, a196
    v_accvgpr_read_b32 v213, a197
    v_mfma_f32_16x16x32_bf16 a[44:47], a[108:111], v[60:63], a[44:47]
    ds_read_b64_tr_b16 a[104:105], v41
    ds_read_b64_tr_b16 a[106:107], v41 offset:2048
    v_accvgpr_read_b32 v214, a198
    v_accvgpr_read_b32 v215, a199
    v_fma_f32 v204, v204, s51, -v250
    v_fma_f32 v205, v205, s51, -v250
    v_fma_f32 v206, v206, s51, -v250
    v_fma_f32 v207, v207, s51, -v250
    v_mfma_f32_16x16x32_bf16 a[48:51], a[108:111], v[68:71], a[48:51]
    v_fma_f32 v212, v212, s51, -v250
    v_fma_f32 v213, v213, s51, -v250
    v_fma_f32 v214, v214, s51, -v250
    v_fma_f32 v215, v215, s51, -v250
    v_exp_f32 v204, v204
    buffer_load_dwordx4 v[24:27], v19, s[40:43], s50 offen
    s_add_u32 s50, s50, 3840
    v_mfma_f32_16x16x32_bf16 a[52:55], a[108:111], v[76:79], a[52:55]
    v_exp_f32 v205, v205
    v_exp_f32 v206, v206
    v_exp_f32 v207, v207
    v_exp_f32 v212, v212
    v_exp_f32 v213, v213
    v_exp_f32 v214, v214
    v_mfma_f32_16x16x32_bf16 a[56:59], a[108:111], v[84:87], a[56:59]
    v_exp_f32 v215, v215
    v_cvt_pk_bf16_f32 v108, v204, v205
    v_cvt_pk_bf16_f32 v109, v206, v207
    v_cvt_pk_bf16_f32 v110, v212, v213
    v_cvt_pk_bf16_f32 v111, v214, v215
    buffer_load_dwordx4 v32, s[20:23], s48 offen offset:3072 nt lds
    s_waitcnt lgkmcnt(4)
    v_mfma_f32_16x16x32_bf16 a[60:63], a[112:115], v[52:55], a[60:63]
    v_accvgpr_read_b32 v220, a200
    v_accvgpr_read_b32 v221, a201
    v_accvgpr_read_b32 v222, a202
    v_accvgpr_read_b32 v223, a203
    v_accvgpr_read_b32 v228, a204
    v_accvgpr_read_b32 v229, a205
    buffer_load_dwordx4 v[24:27], v19, s[40:43], s50 offen
    s_add_u32 s50, s50, 3840
    v_mfma_f32_16x16x32_bf16 a[64:67], a[112:115], v[60:63], a[64:67]
    ds_read_b64_tr_b16 a[108:109], v42
    ds_read_b64_tr_b16 a[110:111], v42 offset:2048
    v_accvgpr_read_b32 v230, a206
    v_accvgpr_read_b32 v231, a207
    v_fma_f32 v220, v220, s51, -v251
    v_fma_f32 v221, v221, s51, -v251
    v_fma_f32 v222, v222, s51, -v251
    v_fma_f32 v223, v223, s51, -v251
    v_mfma_f32_16x16x32_bf16 a[68:71], a[112:115], v[68:71], a[68:71]
    v_fma_f32 v228, v228, s51, -v251
    v_fma_f32 v229, v229, s51, -v251
    v_fma_f32 v230, v230, s51, -v251
    v_fma_f32 v231, v231, s51, -v251
    v_exp_f32 v220, v220
    v_mfma_f32_16x16x32_bf16 a[72:75], a[112:115], v[76:79], a[72:75]
    v_exp_f32 v221, v221
    v_exp_f32 v222, v222
    v_exp_f32 v223, v223
    v_exp_f32 v228, v228
    v_exp_f32 v229, v229
    v_exp_f32 v230, v230
    buffer_load_dwordx4 v[24:27], v19, s[40:43], s50 offen
    s_add_u32 s50, s50, 3840
    v_mfma_f32_16x16x32_bf16 a[76:79], a[112:115], v[84:87], a[76:79]
    v_exp_f32 v231, v231
    v_cvt_pk_bf16_f32 v116, v220, v221
    v_cvt_pk_bf16_f32 v117, v222, v223
    v_cvt_pk_bf16_f32 v118, v228, v229
    v_cvt_pk_bf16_f32 v119, v230, v231
    v_mfma_f32_16x16x32_bf16 a[80:83], v[44:47], v[52:55], a[80:83]
    v_accvgpr_read_b32 v236, a208
    v_accvgpr_read_b32 v237, a209
    v_accvgpr_read_b32 v238, a210
    v_accvgpr_read_b32 v239, a211
    v_accvgpr_read_b32 v244, a212
    v_accvgpr_read_b32 v245, a213
    v_mfma_f32_16x16x32_bf16 a[84:87], v[44:47], v[60:63], a[84:87]
    v_accvgpr_read_b32 v246, a214
    v_accvgpr_read_b32 v247, a215
    v_fma_f32 v236, v236, s51, -v252
    v_fma_f32 v237, v237, s51, -v252
    v_fma_f32 v238, v238, s51, -v252
    v_fma_f32 v239, v239, s51, -v252
    buffer_load_dwordx4 v[24:27], v19, s[40:43], s50 offen
    s_add_u32 s50, s50, 3840
    v_mfma_f32_16x16x32_bf16 a[88:91], v[44:47], v[68:71], a[88:91]
    v_fma_f32 v244, v244, s51, -v252
    v_fma_f32 v245, v245, s51, -v252
    v_fma_f32 v246, v246, s51, -v252
    v_fma_f32 v247, v247, s51, -v252
    v_exp_f32 v236, v236
    v_mfma_f32_16x16x32_bf16 a[92:95], v[44:47], v[76:79], a[92:95]
    v_exp_f32 v237, v237
    v_exp_f32 v238, v238
    v_exp_f32 v239, v239
    v_exp_f32 v244, v244
    v_exp_f32 v245, v245
    v_exp_f32 v246, v246
    v_mfma_f32_16x16x32_bf16 a[96:99], v[44:47], v[84:87], a[96:99]
    v_exp_f32 v247, v247
    v_cvt_pk_bf16_f32 v124, v236, v237
    v_cvt_pk_bf16_f32 v125, v238, v239
    v_cvt_pk_bf16_f32 v126, v244, v245
    v_cvt_pk_bf16_f32 v127, v246, v247
    s_waitcnt vmcnt(24)
    s_barrier
    s_waitcnt lgkmcnt(4)
    v_mfma_f32_16x16x32_bf16 a[0:3], a[100:103], v[92:95], a[0:3]
    v_accvgpr_read_b32 v172, a216
    v_accvgpr_read_b32 v173, a217
    v_accvgpr_read_b32 v174, a218
    v_accvgpr_read_b32 v175, a219
    v_accvgpr_read_b32 v180, a220
    v_accvgpr_read_b32 v181, a221
    v_mfma_f32_16x16x32_bf16 a[4:7], a[100:103], v[100:103], a[4:7]
    ds_read_b64_tr_b16 a[112:113], v43
    ds_read_b64_tr_b16 a[114:115], v43 offset:2048
    v_accvgpr_read_b32 v182, a222
    v_accvgpr_read_b32 v183, a223
    v_fma_f32 v172, v172, s51, -v248
    v_fma_f32 v173, v173, s51, -v248
    v_fma_f32 v174, v174, s51, -v248
    v_fma_f32 v175, v175, s51, -v248
    s_add_u32 m0, s53, 98304
    s_add_u32 s48, s54, 24832
    v_mfma_f32_16x16x32_bf16 a[8:11], a[100:103], v[108:111], a[8:11]
    v_fma_f32 v180, v180, s51, -v248
    v_fma_f32 v181, v181, s51, -v248
    v_fma_f32 v182, v182, s51, -v248
    v_fma_f32 v183, v183, s51, -v248
    v_exp_f32 v172, v172
    v_mfma_f32_16x16x32_bf16 a[12:15], a[100:103], v[116:119], a[12:15]
    v_exp_f32 v173, v173
    v_exp_f32 v174, v174
    v_exp_f32 v175, v175
    v_exp_f32 v180, v180
    v_exp_f32 v181, v181
    v_exp_f32 v182, v182
    v_mfma_f32_16x16x32_bf16 a[16:19], a[100:103], v[124:127], a[16:19]
    v_exp_f32 v183, v183
    v_cvt_pk_bf16_f32 v132, v172, v173
    v_cvt_pk_bf16_f32 v133, v174, v175
    v_cvt_pk_bf16_f32 v134, v180, v181
    v_cvt_pk_bf16_f32 v135, v182, v183
    s_waitcnt lgkmcnt(4)
    v_mfma_f32_16x16x32_bf16 a[20:23], a[104:107], v[92:95], a[20:23]
    v_accvgpr_read_b32 v188, a224
    v_accvgpr_read_b32 v189, a225
    v_accvgpr_read_b32 v190, a226
    v_accvgpr_read_b32 v191, a227
    v_accvgpr_read_b32 v196, a228
    v_accvgpr_read_b32 v197, a229
    v_mfma_f32_16x16x32_bf16 a[24:27], a[104:107], v[100:103], a[24:27]
    ds_read_b64_tr_b16 a[100:101], v40 offset:4096
    ds_read_b64_tr_b16 a[102:103], v40 offset:6144
    v_accvgpr_read_b32 v198, a230
    v_accvgpr_read_b32 v199, a231
    v_fma_f32 v188, v188, s51, -v249
    v_fma_f32 v189, v189, s51, -v249
    v_fma_f32 v190, v190, s51, -v249
    v_fma_f32 v191, v191, s51, -v249
    v_mfma_f32_16x16x32_bf16 a[28:31], a[104:107], v[108:111], a[28:31]
    v_fma_f32 v196, v196, s51, -v249
    v_fma_f32 v197, v197, s51, -v249
    v_fma_f32 v198, v198, s51, -v249
    v_fma_f32 v199, v199, s51, -v249
    v_exp_f32 v188, v188
    v_mfma_f32_16x16x32_bf16 a[32:35], a[104:107], v[116:119], a[32:35]
    v_exp_f32 v189, v189
    v_exp_f32 v190, v190
    v_exp_f32 v191, v191
    v_exp_f32 v196, v196
    v_exp_f32 v197, v197
    v_exp_f32 v198, v198
    v_mfma_f32_16x16x32_bf16 a[36:39], a[104:107], v[124:127], a[36:39]
    v_exp_f32 v199, v199
    v_cvt_pk_bf16_f32 v140, v188, v189
    v_cvt_pk_bf16_f32 v141, v190, v191
    v_cvt_pk_bf16_f32 v142, v196, v197
    v_cvt_pk_bf16_f32 v143, v198, v199
    s_waitcnt lgkmcnt(4)
    v_mfma_f32_16x16x32_bf16 a[40:43], a[108:111], v[92:95], a[40:43]
    v_accvgpr_read_b32 v204, a232
    v_accvgpr_read_b32 v205, a233
    v_accvgpr_read_b32 v206, a234
    v_accvgpr_read_b32 v207, a235
    v_accvgpr_read_b32 v212, a236
    v_accvgpr_read_b32 v213, a237
    buffer_load_dwordx4 v33, s[20:23], s48 offen nt lds
    v_mfma_f32_16x16x32_bf16 a[44:47], a[108:111], v[100:103], a[44:47]
    ds_read_b64_tr_b16 a[104:105], v41 offset:4096
    ds_read_b64_tr_b16 a[106:107], v41 offset:6144
    v_accvgpr_read_b32 v214, a238
    v_accvgpr_read_b32 v215, a239
    v_fma_f32 v204, v204, s51, -v250
    v_fma_f32 v205, v205, s51, -v250
    v_fma_f32 v206, v206, s51, -v250
    v_fma_f32 v207, v207, s51, -v250
    v_mfma_f32_16x16x32_bf16 a[48:51], a[108:111], v[108:111], a[48:51]
    v_fma_f32 v212, v212, s51, -v250
    v_fma_f32 v213, v213, s51, -v250
    v_fma_f32 v214, v214, s51, -v250
    v_fma_f32 v215, v215, s51, -v250
    v_exp_f32 v204, v204
    v_mfma_f32_16x16x32_bf16 a[52:55], a[108:111], v[116:119], a[52:55]
    v_exp_f32 v205, v205
    v_exp_f32 v206, v206
    v_exp_f32 v207, v207
    v_exp_f32 v212, v212
    v_exp_f32 v213, v213
    v_exp_f32 v214, v214
    v_mfma_f32_16x16x32_bf16 a[56:59], a[108:111], v[124:127], a[56:59]
    v_exp_f32 v215, v215
    v_cvt_pk_bf16_f32 v148, v204, v205
    v_cvt_pk_bf16_f32 v149, v206, v207
    v_cvt_pk_bf16_f32 v150, v212, v213
    v_cvt_pk_bf16_f32 v151, v214, v215
    s_waitcnt lgkmcnt(4)
    v_mfma_f32_16x16x32_bf16 a[60:63], a[112:115], v[92:95], a[60:63]
    v_accvgpr_read_b32 v220, a240
    v_accvgpr_read_b32 v221, a241
    v_accvgpr_read_b32 v222, a242
    v_accvgpr_read_b32 v223, a243
    v_accvgpr_read_b32 v228, a244
    v_accvgpr_read_b32 v229, a245
    v_mfma_f32_16x16x32_bf16 a[64:67], a[112:115], v[100:103], a[64:67]
    ds_read_b64_tr_b16 a[108:109], v42 offset:4096
    ds_read_b64_tr_b16 a[110:111], v42 offset:6144
    v_accvgpr_read_b32 v230, a246
    v_accvgpr_read_b32 v231, a247
    v_fma_f32 v220, v220, s51, -v251
    v_fma_f32 v221, v221, s51, -v251
    v_fma_f32 v222, v222, s51, -v251
    v_fma_f32 v223, v223, s51, -v251
    v_mfma_f32_16x16x32_bf16 a[68:71], a[112:115], v[108:111], a[68:71]
    v_fma_f32 v228, v228, s51, -v251
    v_fma_f32 v229, v229, s51, -v251
    v_fma_f32 v230, v230, s51, -v251
    v_fma_f32 v231, v231, s51, -v251
    v_exp_f32 v220, v220
    v_mfma_f32_16x16x32_bf16 a[72:75], a[112:115], v[116:119], a[72:75]
    v_exp_f32 v221, v221
    v_exp_f32 v222, v222
    v_exp_f32 v223, v223
    v_exp_f32 v228, v228
    v_exp_f32 v229, v229
    v_exp_f32 v230, v230
    v_mfma_f32_16x16x32_bf16 a[76:79], a[112:115], v[124:127], a[76:79]
    v_exp_f32 v231, v231
    v_cvt_pk_bf16_f32 v156, v220, v221
    v_cvt_pk_bf16_f32 v157, v222, v223
    v_cvt_pk_bf16_f32 v158, v228, v229
    v_cvt_pk_bf16_f32 v159, v230, v231
    v_mfma_f32_16x16x32_bf16 a[80:83], v[44:47], v[92:95], a[80:83]
    v_accvgpr_read_b32 v236, a248
    v_accvgpr_read_b32 v237, a249
    v_accvgpr_read_b32 v238, a250
    v_accvgpr_read_b32 v239, a251
    v_accvgpr_read_b32 v244, a252
    v_accvgpr_read_b32 v245, a253
    buffer_load_dwordx4 v30, s[20:23], s48 offen offset:1024 nt lds
    v_mfma_f32_16x16x32_bf16 a[84:87], v[44:47], v[100:103], a[84:87]
    v_accvgpr_read_b32 v246, a254
    v_accvgpr_read_b32 v247, a255
    v_fma_f32 v236, v236, s51, -v252
    v_fma_f32 v237, v237, s51, -v252
    v_fma_f32 v238, v238, s51, -v252
    v_fma_f32 v239, v239, s51, -v252
    v_mfma_f32_16x16x32_bf16 a[88:91], v[44:47], v[108:111], a[88:91]
    v_fma_f32 v244, v244, s51, -v252
    v_fma_f32 v245, v245, s51, -v252
    v_fma_f32 v246, v246, s51, -v252
    v_fma_f32 v247, v247, s51, -v252
    v_exp_f32 v236, v236
    v_mfma_f32_16x16x32_bf16 a[92:95], v[44:47], v[116:119], a[92:95]
    v_exp_f32 v237, v237
    v_exp_f32 v238, v238
    v_exp_f32 v239, v239
    v_exp_f32 v244, v244
    v_exp_f32 v245, v245
    v_exp_f32 v246, v246
    v_mfma_f32_16x16x32_bf16 a[96:99], v[44:47], v[124:127], a[96:99]
    v_exp_f32 v247, v247
    v_cvt_pk_bf16_f32 v164, v236, v237
    v_cvt_pk_bf16_f32 v165, v238, v239
    v_cvt_pk_bf16_f32 v166, v244, v245
    v_cvt_pk_bf16_f32 v167, v246, v247
    s_waitcnt lgkmcnt(4)
    v_mfma_f32_16x16x32_bf16 a[0:3], a[100:103], v[132:135], a[0:3]
    v_mfma_f32_16x16x32_bf16 a[4:7], a[100:103], v[140:143], a[4:7]
    ds_read_b64_tr_b16 a[112:113], v43 offset:4096
    ds_read_b64_tr_b16 a[114:115], v43 offset:6144
    v_mfma_f32_16x16x32_bf16 a[8:11], a[100:103], v[148:151], a[8:11]
    v_mfma_f32_16x16x32_bf16 a[12:15], a[100:103], v[156:159], a[12:15]
    v_mfma_f32_16x16x32_bf16 a[16:19], a[100:103], v[164:167], a[16:19]
    buffer_load_dwordx4 v31, s[20:23], s48 offen offset:2048 nt lds
    s_waitcnt lgkmcnt(4)
    v_mfma_f32_16x16x32_bf16 a[20:23], a[104:107], v[132:135], a[20:23]
    v_add_u32 v36, 0x8000, v34
    v_xor_b32 v37, 32, v36
    v_xor_b32 v38, 64, v36
    v_xor_b32 v39, 0x60, v36
    v_mfma_f32_16x16x32_bf16 a[24:27], a[104:107], v[140:143], a[24:27]
    ds_read_b64_tr_b16 a[100:101], v36
    ds_read_b64_tr_b16 a[102:103], v36 offset:2048
    v_mfma_f32_16x16x32_bf16 a[28:31], a[104:107], v[148:151], a[28:31]
    v_mfma_f32_16x16x32_bf16 a[32:35], a[104:107], v[156:159], a[32:35]
    v_mfma_f32_16x16x32_bf16 a[36:39], a[104:107], v[164:167], a[36:39]
    s_waitcnt lgkmcnt(4)
    v_mfma_f32_16x16x32_bf16 a[40:43], a[108:111], v[132:135], a[40:43]
    v_mfma_f32_16x16x32_bf16 a[44:47], a[108:111], v[140:143], a[44:47]
    ds_read_b64_tr_b16 a[104:105], v37
    ds_read_b64_tr_b16 a[106:107], v37 offset:2048
    v_mfma_f32_16x16x32_bf16 a[48:51], a[108:111], v[148:151], a[48:51]
    v_mfma_f32_16x16x32_bf16 a[52:55], a[108:111], v[156:159], a[52:55]
    v_mfma_f32_16x16x32_bf16 a[56:59], a[108:111], v[164:167], a[56:59]
    buffer_load_dwordx4 v32, s[20:23], s48 offen offset:3072 nt lds
    s_waitcnt lgkmcnt(4)
    v_mfma_f32_16x16x32_bf16 a[60:63], a[112:115], v[132:135], a[60:63]
    v_mfma_f32_16x16x32_bf16 a[64:67], a[112:115], v[140:143], a[64:67]
    ds_read_b64_tr_b16 a[108:109], v38
    ds_read_b64_tr_b16 a[110:111], v38 offset:2048
    v_mfma_f32_16x16x32_bf16 a[68:71], a[112:115], v[148:151], a[68:71]
    v_mfma_f32_16x16x32_bf16 a[72:75], a[112:115], v[156:159], a[72:75]
    v_mfma_f32_16x16x32_bf16 a[76:79], a[112:115], v[164:167], a[76:79]
    v_mfma_f32_16x16x32_bf16 a[80:83], v[44:47], v[132:135], a[80:83]
    v_mfma_f32_16x16x32_bf16 a[84:87], v[44:47], v[140:143], a[84:87]
    v_mfma_f32_16x16x32_bf16 a[88:91], v[44:47], v[148:151], a[88:91]
    v_mfma_f32_16x16x32_bf16 a[92:95], v[44:47], v[156:159], a[92:95]
    v_mfma_f32_16x16x32_bf16 a[96:99], v[44:47], v[164:167], a[96:99]
    s_waitcnt vmcnt(24)
    s_barrier
    s_waitcnt lgkmcnt(4)
    v_mfma_f32_16x16x32_bf16 a[176:179], a[100:103], v[48:51], 0
    s_lshl_b32 s50, s28, 4
    v_add_u32 v19, 0, v0
    v_mfma_f32_16x16x32_bf16 a[180:183], a[100:103], v[56:59], 0
    ds_read_b64_tr_b16 a[112:113], v39
    ds_read_b64_tr_b16 a[114:115], v39 offset:2048
    s_add_u32 m0, s53, 16384
    s_add_u32 s48, s54, 49408
    v_mul_u32_u24 v20, 0xccd, v19
    v_lshrrev_b32 v20, 16, v20
    v_mfma_f32_16x16x32_bf16 a[184:187], a[100:103], v[64:67], 0
    ds_write_b128 v13, a[40:43]
    v_mul_u32_u24 v22, 20, v20
    v_sub_u32 v21, v19, v22
    v_mfma_f32_16x16x32_bf16 a[188:191], a[100:103], v[72:75], 0
    ds_write_b128 v13, a[44:47] offset:1024
    v_add_u32 v20, s50, v20
    v_bfe_u32 v23, v20, 2, 1
    v_mfma_f32_16x16x32_bf16 a[192:195], a[100:103], v[80:83], 0
    v_lshrrev_b32 v22, 1, v21
    v_xor_b32 v22, v22, v23
    s_waitcnt lgkmcnt(6)
    v_mfma_f32_16x16x32_bf16 a[196:199], a[104:107], v[48:51], 0
    ds_write_b128 v13, a[48:51] offset:2048
    v_and_b32 v21, 1, v21
    v_lshlrev_b32 v21, 4, v21
    v_mfma_f32_16x16x32_bf16 a[200:203], a[104:107], v[56:59], 0
    ds_read_b64_tr_b16 a[100:101], v36 offset:4096
    ds_read_b64_tr_b16 a[102:103], v36 offset:6144
    v_lshl_or_b32 v22, v22, 5, v21
    v_mul_u32_u24 v20, 0x500, v20
    v_mfma_f32_16x16x32_bf16 a[204:207], a[104:107], v[64:67], 0
    ds_write_b128 v13, a[52:55] offset:3072
    v_add_u32 v248, v20, v22
    v_add_u32 v19, 64, v0
    v_mfma_f32_16x16x32_bf16 a[208:211], a[104:107], v[72:75], 0
    buffer_load_dwordx4 v33, s[20:23], s48 offen nt lds
    v_mul_u32_u24 v20, 0xccd, v19
    v_lshrrev_b32 v20, 16, v20
    v_mfma_f32_16x16x32_bf16 a[212:215], a[104:107], v[80:83], 0
    ds_write_b128 v13, a[56:59] offset:4096
    v_mul_u32_u24 v22, 20, v20
    s_waitcnt lgkmcnt(9)
    v_mfma_f32_16x16x32_bf16 a[216:219], a[108:111], v[48:51], 0
    ds_write_b128 v13, a[60:63] offset:5120
    v_sub_u32 v21, v19, v22
    v_add_u32 v20, s50, v20
    v_mfma_f32_16x16x32_bf16 a[220:223], a[108:111], v[56:59], 0
    ds_read_b64_tr_b16 a[104:105], v37 offset:4096
    ds_read_b64_tr_b16 a[106:107], v37 offset:6144
    v_bfe_u32 v23, v20, 2, 1
    v_lshrrev_b32 v22, 1, v21
    v_mfma_f32_16x16x32_bf16 a[224:227], a[108:111], v[64:67], 0
    ds_write_b128 v13, a[64:67] offset:6144
    v_xor_b32 v22, v22, v23
    v_and_b32 v21, 1, v21
    v_mfma_f32_16x16x32_bf16 a[228:231], a[108:111], v[72:75], 0
    v_lshlrev_b32 v21, 4, v21
    v_lshl_or_b32 v22, v22, 5, v21
    v_mfma_f32_16x16x32_bf16 a[232:235], a[108:111], v[80:83], 0
    ds_write_b128 v13, a[68:71] offset:7168
    v_mul_u32_u24 v20, 0x500, v20
    v_add_u32 v249, v20, v22
    s_waitcnt lgkmcnt(12)
    v_mfma_f32_16x16x32_bf16 a[236:239], a[112:115], v[48:51], 0
    v_subrev_u32 v249, 0x400, v249
    v_add_u32 v19, 0x80, v0
    v_mfma_f32_16x16x32_bf16 a[240:243], a[112:115], v[56:59], 0
    ds_read_b64_tr_b16 a[108:109], v38 offset:4096
    ds_read_b64_tr_b16 a[110:111], v38 offset:6144
    buffer_load_dwordx4 v30, s[20:23], s48 offen offset:1024 nt lds
    ds_write_b128 v13, a[72:75] offset:8192
    v_mul_u32_u24 v20, 0xccd, v19
    v_lshrrev_b32 v20, 16, v20
    v_mfma_f32_16x16x32_bf16 a[244:247], a[112:115], v[64:67], 0
    ds_write_b128 v13, a[76:79] offset:9216
    v_mul_u32_u24 v22, 20, v20
    v_sub_u32 v21, v19, v22
    v_mfma_f32_16x16x32_bf16 a[248:251], a[112:115], v[72:75], 0
    v_add_u32 v20, s50, v20
    v_bfe_u32 v23, v20, 2, 1
    v_mfma_f32_16x16x32_bf16 a[252:255], a[112:115], v[80:83], 0
    v_accvgpr_read_b32 v8, a80
    v_lshrrev_b32 v22, 1, v21
    s_waitcnt lgkmcnt(11)
    v_mfma_f32_16x16x32_bf16 a[176:179], a[100:103], v[88:91], a[176:179]
    v_xor_b32 v22, v22, v23
    v_and_b32 v21, 1, v21
    v_mfma_f32_16x16x32_bf16 a[180:183], a[100:103], v[96:99], a[180:183]
    ds_read_b64_tr_b16 a[112:113], v39 offset:4096
    ds_read_b64_tr_b16 a[114:115], v39 offset:6144
    ds_write_b32 v16, v8
    v_lshlrev_b32 v21, 4, v21
    v_lshl_or_b32 v22, v22, 5, v21
    v_mfma_f32_16x16x32_bf16 a[184:187], a[100:103], v[104:107], a[184:187]
    v_mul_u32_u24 v20, 0x500, v20
    v_add_u32 v250, v20, v22
    v_mfma_f32_16x16x32_bf16 a[188:191], a[100:103], v[112:115], a[188:191]
    buffer_load_dwordx4 v31, s[20:23], s48 offen offset:2048 nt lds
    v_accvgpr_read_b32 v9, a84
    v_subrev_u32 v250, 0x800, v250
    v_add_u32 v19, 0xc0, v0
    v_mfma_f32_16x16x32_bf16 a[192:195], a[100:103], v[120:123], a[192:195]
    ds_write_b32 v16, v9 offset:64
    v_mul_u32_u24 v20, 0xccd, v19
    v_lshrrev_b32 v20, 16, v20
    s_waitcnt lgkmcnt(10)
    v_mfma_f32_16x16x32_bf16 a[196:199], a[104:107], v[88:91], a[196:199]
    v_add_u32 v40, 0x10000, v34
    v_xor_b32 v41, 32, v40
    v_xor_b32 v42, 64, v40
    v_xor_b32 v43, 0x60, v40
    v_mul_u32_u24 v22, 20, v20
    v_sub_u32 v21, v19, v22
    v_mfma_f32_16x16x32_bf16 a[200:203], a[104:107], v[96:99], a[200:203]
    ds_read_b64_tr_b16 a[100:101], v40
    ds_read_b64_tr_b16 a[102:103], v40 offset:2048
    v_accvgpr_read_b32 v10, a88
    v_add_u32 v20, s50, v20
    v_bfe_u32 v23, v20, 2, 1
    v_mfma_f32_16x16x32_bf16 a[204:207], a[104:107], v[104:107], a[204:207]
    v_lshrrev_b32 v22, 1, v21
    v_xor_b32 v22, v22, v23
    v_mfma_f32_16x16x32_bf16 a[208:211], a[104:107], v[112:115], a[208:211]
    ds_write_b32 v16, v10 offset:128
    v_and_b32 v21, 1, v21
    v_lshlrev_b32 v21, 4, v21
    v_mfma_f32_16x16x32_bf16 a[212:215], a[104:107], v[120:123], a[212:215]
    v_lshl_or_b32 v22, v22, 5, v21
    s_waitcnt lgkmcnt(9)
    v_mfma_f32_16x16x32_bf16 a[216:219], a[108:111], v[88:91], a[216:219]
    v_accvgpr_read_b32 v11, a92
    v_mul_u32_u24 v20, 0x500, v20
    v_add_u32 v251, v20, v22
    v_mfma_f32_16x16x32_bf16 a[220:223], a[108:111], v[96:99], a[220:223]
    ds_read_b64_tr_b16 a[104:105], v41
    ds_read_b64_tr_b16 a[106:107], v41 offset:2048
    buffer_load_dwordx4 v32, s[20:23], s48 offen offset:3072 nt lds
    ds_write_b32 v16, v11 offset:192
    v_subrev_u32 v251, 0xc00, v251
    v_add_u32 v19, 0x100, v0
    v_mfma_f32_16x16x32_bf16 a[224:227], a[108:111], v[104:107], a[224:227]
    v_mul_u32_u24 v20, 0xccd, v19
    v_lshrrev_b32 v20, 16, v20
    v_mfma_f32_16x16x32_bf16 a[228:231], a[108:111], v[112:115], a[228:231]
    v_accvgpr_read_b32 v12, a96
    v_mul_u32_u24 v22, 20, v20
    v_sub_u32 v21, v19, v22
    v_mfma_f32_16x16x32_bf16 a[232:235], a[108:111], v[120:123], a[232:235]
    v_add_u32 v20, s50, v20
    v_bfe_u32 v23, v20, 2, 1
    s_waitcnt lgkmcnt(8)
    v_mfma_f32_16x16x32_bf16 a[236:239], a[112:115], v[88:91], a[236:239]
    ds_write_b32 v16, v12 offset:256
    v_lshrrev_b32 v22, 1, v21
    v_xor_b32 v22, v22, v23
    v_mfma_f32_16x16x32_bf16 a[240:243], a[112:115], v[96:99], a[240:243]
    ds_read_b64_tr_b16 a[108:109], v42
    ds_read_b64_tr_b16 a[110:111], v42 offset:2048
    v_and_b32 v21, 1, v21
    v_lshlrev_b32 v21, 4, v21
    v_mfma_f32_16x16x32_bf16 a[244:247], a[112:115], v[104:107], a[244:247]
    v_lshl_or_b32 v22, v22, 5, v21
    v_mul_u32_u24 v20, 0x500, v20
    v_mfma_f32_16x16x32_bf16 a[248:251], a[112:115], v[112:115], a[248:251]
    v_add_u32 v252, v20, v22
    v_lshlrev_b32 v22, 4, v0
    v_mfma_f32_16x16x32_bf16 a[252:255], a[112:115], v[120:123], a[252:255]
    v_add_u32 v253, s78, v22
    s_waitcnt vmcnt(24) lgkmcnt(0)
    s_barrier
    v_mfma_f32_16x16x32_bf16 a[176:179], a[100:103], v[128:131], a[176:179]
    ds_read_b32 v1, v17
    ds_read_b32 v2, v17 offset:64
    v_mfma_f32_16x16x32_bf16 a[180:183], a[100:103], v[136:139], a[180:183]
    ds_read_b64_tr_b16 a[112:113], v43
    ds_read_b64_tr_b16 a[114:115], v43 offset:2048
    s_add_u32 m0, s53, 32768
    s_add_u32 s48, s54, 73984
    ds_read_b32 v3, v17 offset:128
    v_mfma_f32_16x16x32_bf16 a[184:187], a[100:103], v[144:147], a[184:187]
    ds_read_b32 v4, v17 offset:192
    ds_read_b32 v5, v17 offset:256
    v_mfma_f32_16x16x32_bf16 a[188:191], a[100:103], v[152:155], a[188:191]
    ds_read_b128 v[172:175], v14
    v_mfma_f32_16x16x32_bf16 a[192:195], a[100:103], v[160:163], a[192:195]
    ds_read_b128 v[212:215], v14 offset:5120
    v_mfma_f32_16x16x32_bf16 a[196:199], a[104:107], v[128:131], a[196:199]
    ds_read_b128 v[180:183], v14 offset:1024
    ds_read_b128 v[220:223], v14 offset:6144
    v_mfma_f32_16x16x32_bf16 a[200:203], a[104:107], v[136:139], a[200:203]
    ds_read_b64_tr_b16 a[100:101], v40 offset:4096
    ds_read_b64_tr_b16 a[102:103], v40 offset:6144
    ds_read_b128 v[188:191], v14 offset:2048
    v_mfma_f32_16x16x32_bf16 a[204:207], a[104:107], v[144:147], a[204:207]
    ds_read_b128 v[228:231], v14 offset:7168
    ds_read_b128 v[196:199], v14 offset:3072
    v_mfma_f32_16x16x32_bf16 a[208:211], a[104:107], v[152:155], a[208:211]
    buffer_load_dwordx4 v33, s[20:23], s48 offen nt lds
    ds_read_b128 v[236:239], v14 offset:8192
    v_mfma_f32_16x16x32_bf16 a[212:215], a[104:107], v[160:163], a[212:215]
    ds_read_b128 v[204:207], v14 offset:4096
    v_mfma_f32_16x16x32_bf16 a[216:219], a[108:111], v[128:131], a[216:219]
    ds_read_b128 v[244:247], v14 offset:9216
    s_waitcnt lgkmcnt(15)
    v_add_f32 v8, v8, v1
    v_mfma_f32_16x16x32_bf16 a[220:223], a[108:111], v[136:139], a[220:223]
    ds_read_b64_tr_b16 a[104:105], v41 offset:4096
    ds_read_b64_tr_b16 a[106:107], v41 offset:6144
    v_rcp_f32 v8, v8
    v_mfma_f32_16x16x32_bf16 a[224:227], a[108:111], v[144:147], a[224:227]
    v_add_f32 v9, v9, v2
    v_rcp_f32 v9, v9
    v_mfma_f32_16x16x32_bf16 a[228:231], a[108:111], v[152:155], a[228:231]
    s_waitcnt lgkmcnt(15)
    v_add_f32 v10, v10, v3
    v_mfma_f32_16x16x32_bf16 a[232:235], a[108:111], v[160:163], a[232:235]
    v_rcp_f32 v10, v10
    v_mfma_f32_16x16x32_bf16 a[236:239], a[112:115], v[128:131], a[236:239]
    v_add_f32 v11, v11, v4
    v_rcp_f32 v11, v11
    v_mfma_f32_16x16x32_bf16 a[240:243], a[112:115], v[136:139], a[240:243]
    ds_read_b64_tr_b16 a[108:109], v42 offset:4096
    ds_read_b64_tr_b16 a[110:111], v42 offset:6144
    buffer_load_dwordx4 v30, s[20:23], s48 offen offset:1024 nt lds
    s_waitcnt lgkmcnt(15)
    v_add_f32 v12, v12, v5
    v_mfma_f32_16x16x32_bf16 a[244:247], a[112:115], v[144:147], a[244:247]
    v_rcp_f32 v12, v12
    v_accvgpr_read_b32 v6, a0
    v_mfma_f32_16x16x32_bf16 a[248:251], a[112:115], v[152:155], a[248:251]
    v_add_f32 v172, v172, v6
    v_mfma_f32_16x16x32_bf16 a[252:255], a[112:115], v[160:163], a[252:255]
    v_mul_f32 v172, v172, v8
    s_waitcnt lgkmcnt(10)
    v_mfma_f32_16x16x32_bf16 a[176:179], a[100:103], v[168:171], a[176:179]
    v_accvgpr_read_b32 v7, a1
    v_add_f32 v173, v173, v7
    v_mfma_f32_16x16x32_bf16 a[180:183], a[100:103], v[176:179], a[180:183]
    ds_read_b64_tr_b16 a[112:113], v43 offset:4096
    ds_read_b64_tr_b16 a[114:115], v43 offset:6144
    v_mul_f32 v173, v173, v8
    v_mfma_f32_16x16x32_bf16 a[184:187], a[100:103], v[184:187], a[184:187]
    v_accvgpr_read_b32 v6, a2
    v_add_f32 v174, v174, v6
    v_mfma_f32_16x16x32_bf16 a[188:191], a[100:103], v[192:195], a[188:191]
    buffer_load_dwordx4 v31, s[20:23], s48 offen offset:2048 nt lds
    v_mul_f32 v174, v174, v8
    v_mfma_f32_16x16x32_bf16 a[192:195], a[100:103], v[200:203], a[192:195]
    v_accvgpr_read_b32 v7, a3
    s_waitcnt lgkmcnt(4)
    v_mfma_f32_16x16x32_bf16 a[196:199], a[104:107], v[168:171], a[196:199]
    v_add_u32 v36, 0x14000, v34
    v_xor_b32 v37, 32, v36
    v_xor_b32 v38, 64, v36
    v_xor_b32 v39, 0x60, v36
    v_add_f32 v175, v175, v7
    v_mul_f32 v175, v175, v8
    v_mfma_f32_16x16x32_bf16 a[200:203], a[104:107], v[176:179], a[200:203]
    ds_read_b64_tr_b16 a[100:101], v36
    ds_read_b64_tr_b16 a[102:103], v36 offset:2048
    v_accvgpr_read_b32 v6, a20
    v_mfma_f32_16x16x32_bf16 a[204:207], a[104:107], v[184:187], a[204:207]
    v_add_f32 v212, v212, v6
    v_mul_f32 v212, v212, v8
    v_mfma_f32_16x16x32_bf16 a[208:211], a[104:107], v[192:195], a[208:211]
    v_accvgpr_read_b32 v7, a21
    v_mfma_f32_16x16x32_bf16 a[212:215], a[104:107], v[200:203], a[212:215]
    v_add_f32 v213, v213, v7
    s_waitcnt lgkmcnt(4)
    v_mfma_f32_16x16x32_bf16 a[216:219], a[108:111], v[168:171], a[216:219]
    v_mul_f32 v213, v213, v8
    v_accvgpr_read_b32 v6, a22
    v_mfma_f32_16x16x32_bf16 a[220:223], a[108:111], v[176:179], a[220:223]
    ds_read_b64_tr_b16 a[104:105], v37
    ds_read_b64_tr_b16 a[106:107], v37 offset:2048
    buffer_load_dwordx4 v32, s[20:23], s48 offen offset:3072 nt lds
    v_add_f32 v214, v214, v6
    v_mfma_f32_16x16x32_bf16 a[224:227], a[108:111], v[184:187], a[224:227]
    v_mul_f32 v214, v214, v8
    v_accvgpr_read_b32 v7, a23
    v_mfma_f32_16x16x32_bf16 a[228:231], a[108:111], v[192:195], a[228:231]
    v_add_f32 v215, v215, v7
    v_mfma_f32_16x16x32_bf16 a[232:235], a[108:111], v[200:203], a[232:235]
    v_mul_f32 v215, v215, v8
    s_waitcnt lgkmcnt(4)
    v_mfma_f32_16x16x32_bf16 a[236:239], a[112:115], v[168:171], a[236:239]
    v_cvt_pk_bf16_f32 v172, v172, v173
    v_cvt_pk_bf16_f32 v173, v174, v175
    v_mfma_f32_16x16x32_bf16 a[240:243], a[112:115], v[176:179], a[240:243]
    ds_read_b64_tr_b16 a[108:109], v38
    ds_read_b64_tr_b16 a[110:111], v38 offset:2048
    v_cvt_pk_bf16_f32 v174, v212, v213
    v_mfma_f32_16x16x32_bf16 a[244:247], a[112:115], v[184:187], a[244:247]
    v_cvt_pk_bf16_f32 v175, v214, v215
    s_mov_b32 s49, 0
    buffer_store_dwordx4 v[172:175], v15, s[24:27], s49 offen sc1
    v_mfma_f32_16x16x32_bf16 a[248:251], a[112:115], v[192:195], a[248:251]
    v_accvgpr_read_b32 v6, a4
    v_mfma_f32_16x16x32_bf16 a[252:255], a[112:115], v[200:203], a[252:255]
    v_add_f32 v180, v180, v6
    s_waitcnt vmcnt(25)
    s_barrier
    s_waitcnt lgkmcnt(4)
    v_mfma_f32_16x16x32_bf16 a[176:179], a[100:103], v[208:211], a[176:179]
    v_mul_f32 v180, v180, v9
    v_accvgpr_read_b32 v7, a5
    v_mfma_f32_16x16x32_bf16 a[180:183], a[100:103], v[216:219], a[180:183]
    ds_read_b64_tr_b16 a[112:113], v39
    ds_read_b64_tr_b16 a[114:115], v39 offset:2048
    v_add_f32 v181, v181, v7
    v_mfma_f32_16x16x32_bf16 a[184:187], a[100:103], v[224:227], a[184:187]
    v_mul_f32 v181, v181, v9
    v_accvgpr_read_b32 v6, a6
    v_mfma_f32_16x16x32_bf16 a[188:191], a[100:103], v[232:235], a[188:191]
    v_add_f32 v182, v182, v6
    v_mfma_f32_16x16x32_bf16 a[192:195], a[100:103], v[240:243], a[192:195]
    v_mul_f32 v182, v182, v9
    v_accvgpr_read_b32 v7, a7
    s_waitcnt lgkmcnt(4)
    v_mfma_f32_16x16x32_bf16 a[196:199], a[104:107], v[208:211], a[196:199]
    v_add_f32 v183, v183, v7
    v_mfma_f32_16x16x32_bf16 a[200:203], a[104:107], v[216:219], a[200:203]
    ds_read_b64_tr_b16 a[100:101], v36 offset:4096
    ds_read_b64_tr_b16 a[102:103], v36 offset:6144
    v_mul_f32 v183, v183, v9
    v_mfma_f32_16x16x32_bf16 a[204:207], a[104:107], v[224:227], a[204:207]
    v_accvgpr_read_b32 v6, a24
    v_add_f32 v220, v220, v6
    v_mfma_f32_16x16x32_bf16 a[208:211], a[104:107], v[232:235], a[208:211]
    v_mul_f32 v220, v220, v9
    v_mfma_f32_16x16x32_bf16 a[212:215], a[104:107], v[240:243], a[212:215]
    v_accvgpr_read_b32 v7, a25
    v_add_f32 v221, v221, v7
    s_waitcnt lgkmcnt(4)
    v_mfma_f32_16x16x32_bf16 a[216:219], a[108:111], v[208:211], a[216:219]
    v_mul_f32 v221, v221, v9
    v_mfma_f32_16x16x32_bf16 a[220:223], a[108:111], v[216:219], a[220:223]
    ds_read_b64_tr_b16 a[104:105], v37 offset:4096
    ds_read_b64_tr_b16 a[106:107], v37 offset:6144
    v_accvgpr_read_b32 v6, a26
    v_add_f32 v222, v222, v6
    v_mfma_f32_16x16x32_bf16 a[224:227], a[108:111], v[224:227], a[224:227]
    v_mul_f32 v222, v222, v9
    v_mfma_f32_16x16x32_bf16 a[228:231], a[108:111], v[232:235], a[228:231]
    v_accvgpr_read_b32 v7, a27
    v_mfma_f32_16x16x32_bf16 a[232:235], a[108:111], v[240:243], a[232:235]
    v_add_f32 v223, v223, v7
    v_mul_f32 v223, v223, v9
    s_waitcnt lgkmcnt(4)
    v_mfma_f32_16x16x32_bf16 a[236:239], a[112:115], v[208:211], a[236:239]
    v_cvt_pk_bf16_f32 v180, v180, v181
    v_mfma_f32_16x16x32_bf16 a[240:243], a[112:115], v[216:219], a[240:243]
    ds_read_b64_tr_b16 a[108:109], v38 offset:4096
    ds_read_b64_tr_b16 a[110:111], v38 offset:6144
    v_cvt_pk_bf16_f32 v181, v182, v183
    v_cvt_pk_bf16_f32 v182, v220, v221
    v_mfma_f32_16x16x32_bf16 a[244:247], a[112:115], v[224:227], a[244:247]
    v_cvt_pk_bf16_f32 v183, v222, v223
    v_mfma_f32_16x16x32_bf16 a[248:251], a[112:115], v[232:235], a[248:251]
    s_mov_b32 s49, 1024
    buffer_store_dwordx4 v[180:183], v15, s[24:27], s49 offen sc1
    v_accvgpr_read_b32 v6, a8
    v_mfma_f32_16x16x32_bf16 a[252:255], a[112:115], v[240:243], a[252:255]
    v_add_f32 v188, v188, v6
    s_waitcnt lgkmcnt(4)
    v_mfma_f32_16x16x32_bf16 a[176:179], a[100:103], v[52:55], a[176:179]
    v_mul_f32 v188, v188, v10
    v_mfma_f32_16x16x32_bf16 a[180:183], a[100:103], v[60:63], a[180:183]
    ds_read_b64_tr_b16 a[112:113], v39 offset:4096
    ds_read_b64_tr_b16 a[114:115], v39 offset:6144
    v_accvgpr_read_b32 v7, a9
    v_add_f32 v189, v189, v7
    v_mfma_f32_16x16x32_bf16 a[184:187], a[100:103], v[68:71], a[184:187]
    v_mul_f32 v189, v189, v10
    v_mfma_f32_16x16x32_bf16 a[188:191], a[100:103], v[76:79], a[188:191]
    v_accvgpr_read_b32 v6, a10
    v_add_f32 v190, v190, v6
    v_mfma_f32_16x16x32_bf16 a[192:195], a[100:103], v[84:87], a[192:195]
    v_mul_f32 v190, v190, v10
    s_waitcnt lgkmcnt(4)
    v_mfma_f32_16x16x32_bf16 a[196:199], a[104:107], v[52:55], a[196:199]
    v_add_u32 v40, 0xc000, v34
    v_xor_b32 v41, 32, v40
    v_xor_b32 v42, 64, v40
    v_xor_b32 v43, 0x60, v40
    v_accvgpr_read_b32 v7, a11
    v_add_f32 v191, v191, v7
    v_mfma_f32_16x16x32_bf16 a[200:203], a[104:107], v[60:63], a[200:203]
    ds_read_b64_tr_b16 a[100:101], v40
    ds_read_b64_tr_b16 a[102:103], v40 offset:2048
    v_mul_f32 v191, v191, v10
    v_mfma_f32_16x16x32_bf16 a[204:207], a[104:107], v[68:71], a[204:207]
    v_accvgpr_read_b32 v6, a28
    v_mfma_f32_16x16x32_bf16 a[208:211], a[104:107], v[76:79], a[208:211]
    v_add_f32 v228, v228, v6
    v_mul_f32 v228, v228, v10
    v_mfma_f32_16x16x32_bf16 a[212:215], a[104:107], v[84:87], a[212:215]
    v_accvgpr_read_b32 v7, a29
    s_waitcnt lgkmcnt(4)
    v_mfma_f32_16x16x32_bf16 a[216:219], a[108:111], v[52:55], a[216:219]
    v_add_f32 v229, v229, v7
    v_mul_f32 v229, v229, v10
    v_mfma_f32_16x16x32_bf16 a[220:223], a[108:111], v[60:63], a[220:223]
    ds_read_b64_tr_b16 a[104:105], v41
    ds_read_b64_tr_b16 a[106:107], v41 offset:2048
    v_accvgpr_read_b32 v6, a30
    v_mfma_f32_16x16x32_bf16 a[224:227], a[108:111], v[68:71], a[224:227]
    v_add_f32 v230, v230, v6
    v_mul_f32 v230, v230, v10
    v_mfma_f32_16x16x32_bf16 a[228:231], a[108:111], v[76:79], a[228:231]
    v_accvgpr_read_b32 v7, a31
    v_mfma_f32_16x16x32_bf16 a[232:235], a[108:111], v[84:87], a[232:235]
    v_add_f32 v231, v231, v7
    s_waitcnt lgkmcnt(4)
    v_mfma_f32_16x16x32_bf16 a[236:239], a[112:115], v[52:55], a[236:239]
    v_mul_f32 v231, v231, v10
    v_cvt_pk_bf16_f32 v188, v188, v189
    v_mfma_f32_16x16x32_bf16 a[240:243], a[112:115], v[60:63], a[240:243]
    ds_read_b64_tr_b16 a[108:109], v42
    ds_read_b64_tr_b16 a[110:111], v42 offset:2048
    v_cvt_pk_bf16_f32 v189, v190, v191
    v_mfma_f32_16x16x32_bf16 a[244:247], a[112:115], v[68:71], a[244:247]
    v_cvt_pk_bf16_f32 v190, v228, v229
    v_cvt_pk_bf16_f32 v191, v230, v231
    v_mfma_f32_16x16x32_bf16 a[248:251], a[112:115], v[76:79], a[248:251]
    s_mov_b32 s49, 2048
    buffer_store_dwordx4 v[188:191], v15, s[24:27], s49 offen sc1
    v_mfma_f32_16x16x32_bf16 a[252:255], a[112:115], v[84:87], a[252:255]
    v_accvgpr_read_b32 v6, a12
    s_waitcnt vmcnt(18)
    s_barrier
    s_waitcnt lgkmcnt(4)
    v_mfma_f32_16x16x32_bf16 a[176:179], a[100:103], v[92:95], a[176:179]
    v_add_f32 v196, v196, v6
    v_mul_f32 v196, v196, v11
    v_mfma_f32_16x16x32_bf16 a[180:183], a[100:103], v[100:103], a[180:183]
    ds_read_b64_tr_b16 a[112:113], v43
    ds_read_b64_tr_b16 a[114:115], v43 offset:2048
    v_accvgpr_read_b32 v7, a13
    v_mfma_f32_16x16x32_bf16 a[184:187], a[100:103], v[108:111], a[184:187]
    v_add_f32 v197, v197, v7
    v_mul_f32 v197, v197, v11
    v_mfma_f32_16x16x32_bf16 a[188:191], a[100:103], v[116:119], a[188:191]
    v_accvgpr_read_b32 v6, a14
    v_mfma_f32_16x16x32_bf16 a[192:195], a[100:103], v[124:127], a[192:195]
    v_add_f32 v198, v198, v6
    v_mul_f32 v198, v198, v11
    s_waitcnt lgkmcnt(4)
    v_mfma_f32_16x16x32_bf16 a[196:199], a[104:107], v[92:95], a[196:199]
    v_accvgpr_read_b32 v7, a15
    v_mfma_f32_16x16x32_bf16 a[200:203], a[104:107], v[100:103], a[200:203]
    ds_read_b64_tr_b16 a[100:101], v40 offset:4096
    ds_read_b64_tr_b16 a[102:103], v40 offset:6144
    v_add_f32 v199, v199, v7
    v_mfma_f32_16x16x32_bf16 a[204:207], a[104:107], v[108:111], a[204:207]
    v_mul_f32 v199, v199, v11
    v_accvgpr_read_b32 v6, a32
    v_mfma_f32_16x16x32_bf16 a[208:211], a[104:107], v[116:119], a[208:211]
    v_add_f32 v236, v236, v6
    v_mfma_f32_16x16x32_bf16 a[212:215], a[104:107], v[124:127], a[212:215]
    v_mul_f32 v236, v236, v11
    v_accvgpr_read_b32 v7, a33
    s_waitcnt lgkmcnt(4)
    v_mfma_f32_16x16x32_bf16 a[216:219], a[108:111], v[92:95], a[216:219]
    v_add_f32 v237, v237, v7
    v_mfma_f32_16x16x32_bf16 a[220:223], a[108:111], v[100:103], a[220:223]
    ds_read_b64_tr_b16 a[104:105], v41 offset:4096
    ds_read_b64_tr_b16 a[106:107], v41 offset:6144
    v_mul_f32 v237, v237, v11
    v_accvgpr_read_b32 v6, a34
    v_mfma_f32_16x16x32_bf16 a[224:227], a[108:111], v[108:111], a[224:227]
    v_add_f32 v238, v238, v6
    v_mfma_f32_16x16x32_bf16 a[228:231], a[108:111], v[116:119], a[228:231]
    v_mul_f32 v238, v238, v11
    v_mfma_f32_16x16x32_bf16 a[232:235], a[108:111], v[124:127], a[232:235]
    v_accvgpr_read_b32 v7, a35
    v_add_f32 v239, v239, v7
    s_waitcnt lgkmcnt(4)
    v_mfma_f32_16x16x32_bf16 a[236:239], a[112:115], v[92:95], a[236:239]
    v_mul_f32 v239, v239, v11
    v_mfma_f32_16x16x32_bf16 a[240:243], a[112:115], v[100:103], a[240:243]
    ds_read_b64_tr_b16 a[108:109], v42 offset:4096
    ds_read_b64_tr_b16 a[110:111], v42 offset:6144
    v_cvt_pk_bf16_f32 v196, v196, v197
    v_cvt_pk_bf16_f32 v197, v198, v199
    v_mfma_f32_16x16x32_bf16 a[244:247], a[112:115], v[108:111], a[244:247]
    v_cvt_pk_bf16_f32 v198, v236, v237
    v_mfma_f32_16x16x32_bf16 a[248:251], a[112:115], v[116:119], a[248:251]
    v_cvt_pk_bf16_f32 v199, v238, v239
    s_mov_b32 s49, 3072
    buffer_store_dwordx4 v[196:199], v15, s[24:27], s49 offen sc1
    v_mfma_f32_16x16x32_bf16 a[252:255], a[112:115], v[124:127], a[252:255]
    v_accvgpr_read_b32 v6, a16
    s_waitcnt lgkmcnt(4)
    v_mfma_f32_16x16x32_bf16 a[176:179], a[100:103], v[132:135], a[176:179]
    v_add_f32 v204, v204, v6
    v_mfma_f32_16x16x32_bf16 a[180:183], a[100:103], v[140:143], a[180:183]
    ds_read_b64_tr_b16 a[112:113], v43 offset:4096
    ds_read_b64_tr_b16 a[114:115], v43 offset:6144
    v_mul_f32 v204, v204, v12
    v_accvgpr_read_b32 v7, a17
    v_mfma_f32_16x16x32_bf16 a[184:187], a[100:103], v[148:151], a[184:187]
    v_add_f32 v205, v205, v7
    v_mfma_f32_16x16x32_bf16 a[188:191], a[100:103], v[156:159], a[188:191]
    v_mul_f32 v205, v205, v12
    v_accvgpr_read_b32 v6, a18
    v_mfma_f32_16x16x32_bf16 a[192:195], a[100:103], v[164:167], a[192:195]
    v_add_f32 v206, v206, v6
    s_waitcnt lgkmcnt(4)
    v_mfma_f32_16x16x32_bf16 a[196:199], a[104:107], v[132:135], a[196:199]
    v_add_u32 v36, 0, v34
    v_xor_b32 v37, 32, v36
    v_xor_b32 v38, 64, v36
    v_xor_b32 v39, 0x60, v36
    v_mul_f32 v206, v206, v12
    v_accvgpr_read_b32 v7, a19
    v_mfma_f32_16x16x32_bf16 a[200:203], a[104:107], v[140:143], a[200:203]
    ds_read_b64_tr_b16 a[100:101], v36
    ds_read_b64_tr_b16 a[102:103], v36 offset:2048
    v_add_f32 v207, v207, v7
    v_mfma_f32_16x16x32_bf16 a[204:207], a[104:107], v[148:151], a[204:207]
    v_mul_f32 v207, v207, v12
    v_mfma_f32_16x16x32_bf16 a[208:211], a[104:107], v[156:159], a[208:211]
    v_accvgpr_read_b32 v6, a36
    v_add_f32 v244, v244, v6
    v_mfma_f32_16x16x32_bf16 a[212:215], a[104:107], v[164:167], a[212:215]
    v_mul_f32 v244, v244, v12
    s_waitcnt lgkmcnt(4)
    v_mfma_f32_16x16x32_bf16 a[216:219], a[108:111], v[132:135], a[216:219]
    v_accvgpr_read_b32 v7, a37
    v_add_f32 v245, v245, v7
    v_mfma_f32_16x16x32_bf16 a[220:223], a[108:111], v[140:143], a[220:223]
    ds_read_b64_tr_b16 a[104:105], v37
    ds_read_b64_tr_b16 a[106:107], v37 offset:2048
    v_mul_f32 v245, v245, v12
    v_mfma_f32_16x16x32_bf16 a[224:227], a[108:111], v[148:151], a[224:227]
    v_accvgpr_read_b32 v6, a38
    v_add_f32 v246, v246, v6
    v_mfma_f32_16x16x32_bf16 a[228:231], a[108:111], v[156:159], a[228:231]
    v_mul_f32 v246, v246, v12
    v_mfma_f32_16x16x32_bf16 a[232:235], a[108:111], v[164:167], a[232:235]
    v_accvgpr_read_b32 v7, a39
    s_waitcnt lgkmcnt(4)
    v_mfma_f32_16x16x32_bf16 a[236:239], a[112:115], v[132:135], a[236:239]
    v_add_f32 v247, v247, v7
    v_mul_f32 v247, v247, v12
    v_mfma_f32_16x16x32_bf16 a[240:243], a[112:115], v[140:143], a[240:243]
    ds_read_b64_tr_b16 a[108:109], v38
    ds_read_b64_tr_b16 a[110:111], v38 offset:2048
    v_cvt_pk_bf16_f32 v204, v204, v205
    v_mfma_f32_16x16x32_bf16 a[244:247], a[112:115], v[148:151], a[244:247]
    v_cvt_pk_bf16_f32 v205, v206, v207
    v_cvt_pk_bf16_f32 v206, v244, v245
    v_mfma_f32_16x16x32_bf16 a[248:251], a[112:115], v[156:159], a[248:251]
    v_cvt_pk_bf16_f32 v207, v246, v247
    v_mfma_f32_16x16x32_bf16 a[252:255], a[112:115], v[164:167], a[252:255]
    s_mov_b32 s49, 4096
    buffer_store_dwordx4 v[204:207], v15, s[24:27], s49 offen sc1
    s_waitcnt vmcnt(13)
    s_barrier
    s_waitcnt lgkmcnt(4)
    v_mfma_f32_16x16x32_bf16 a[0:3], a[100:103], v[48:51], 0
    v_mfma_f32_16x16x32_bf16 a[4:7], a[100:103], v[56:59], 0
    ds_read_b64_tr_b16 a[112:113], v39
    ds_read_b64_tr_b16 a[114:115], v39 offset:2048
    s_add_u32 m0, s78, 61440
    s_add_u32 s79, s66, 0
    v_mfma_f32_16x16x32_bf16 a[8:11], a[100:103], v[64:67], 0
    ds_write_b128 v13, a[216:219]
    v_mfma_f32_16x16x32_bf16 a[12:15], a[100:103], v[72:75], 0
    v_mfma_f32_16x16x32_bf16 a[16:19], a[100:103], v[80:83], 0
    s_waitcnt lgkmcnt(5)
    v_mfma_f32_16x16x32_bf16 a[20:23], a[104:107], v[48:51], 0
    ds_write_b128 v13, a[220:223] offset:1024
    v_mfma_f32_16x16x32_bf16 a[24:27], a[104:107], v[56:59], 0
    ds_read_b64_tr_b16 a[100:101], v36 offset:4096
    ds_read_b64_tr_b16 a[102:103], v36 offset:6144
    buffer_load_dwordx4 v248, s[40:43], s79 offen lds
    v_mfma_f32_16x16x32_bf16 a[28:31], a[104:107], v[64:67], 0
    v_mfma_f32_16x16x32_bf16 a[32:35], a[104:107], v[72:75], 0
    v_mfma_f32_16x16x32_bf16 a[36:39], a[104:107], v[80:83], 0
    ds_write_b128 v13, a[224:227] offset:2048
    s_waitcnt lgkmcnt(7)
    v_mfma_f32_16x16x32_bf16 a[40:43], a[108:111], v[48:51], 0
    v_mfma_f32_16x16x32_bf16 a[44:47], a[108:111], v[56:59], 0
    ds_read_b64_tr_b16 a[104:105], v37 offset:4096
    ds_read_b64_tr_b16 a[106:107], v37 offset:6144
    buffer_load_dwordx4 v249, s[40:43], s79 offen offset:1024 lds
    v_mfma_f32_16x16x32_bf16 a[48:51], a[108:111], v[64:67], 0
    ds_write_b128 v13, a[228:231] offset:3072
    v_mfma_f32_16x16x32_bf16 a[52:55], a[108:111], v[72:75], 0
    v_mfma_f32_16x16x32_bf16 a[56:59], a[108:111], v[80:83], 0
    s_waitcnt lgkmcnt(8)
    v_mfma_f32_16x16x32_bf16 a[60:63], a[112:115], v[48:51], 0
    v_mfma_f32_16x16x32_bf16 a[64:67], a[112:115], v[56:59], 0
    ds_read_b64_tr_b16 a[108:109], v38 offset:4096
    ds_read_b64_tr_b16 a[110:111], v38 offset:6144
    ds_write_b128 v13, a[232:235] offset:4096
    v_mfma_f32_16x16x32_bf16 a[68:71], a[112:115], v[64:67], 0
    buffer_load_dwordx4 v250, s[40:43], s79 offen offset:2048 lds
    v_mfma_f32_16x16x32_bf16 a[72:75], a[112:115], v[72:75], 0
    v_mfma_f32_16x16x32_bf16 a[76:79], a[112:115], v[80:83], 0
    ds_write_b128 v13, a[236:239] offset:5120
    s_waitcnt lgkmcnt(8)
    v_mfma_f32_16x16x32_bf16 a[0:3], a[100:103], v[88:91], a[0:3]
    v_mfma_f32_16x16x32_bf16 a[4:7], a[100:103], v[96:99], a[4:7]
    ds_read_b64_tr_b16 a[112:113], v39 offset:4096
    ds_read_b64_tr_b16 a[114:115], v39 offset:6144
    v_mfma_f32_16x16x32_bf16 a[8:11], a[100:103], v[104:107], a[8:11]
    buffer_load_dwordx4 v251, s[40:43], s79 offen offset:3072 lds
    v_mfma_f32_16x16x32_bf16 a[12:15], a[100:103], v[112:115], a[12:15]
    ds_write_b128 v13, a[240:243] offset:6144
    v_mfma_f32_16x16x32_bf16 a[16:19], a[100:103], v[120:123], a[16:19]
    s_waitcnt lgkmcnt(8)
    v_mfma_f32_16x16x32_bf16 a[20:23], a[104:107], v[88:91], a[20:23]
    v_add_u32 v40, 0x18000, v34
    v_xor_b32 v41, 32, v40
    v_xor_b32 v42, 64, v40
    v_xor_b32 v43, 0x60, v40
    v_mfma_f32_16x16x32_bf16 a[24:27], a[104:107], v[96:99], a[24:27]
    ds_read_b64_tr_b16 a[100:101], v40
    ds_read_b64_tr_b16 a[102:103], v40 offset:2048
    ds_write_b128 v13, a[244:247] offset:7168
    v_mfma_f32_16x16x32_bf16 a[28:31], a[104:107], v[104:107], a[28:31]
    v_mfma_f32_16x16x32_bf16 a[32:35], a[104:107], v[112:115], a[32:35]
    s_add_u32 m0, s78, 65536
    v_mfma_f32_16x16x32_bf16 a[36:39], a[104:107], v[120:123], a[36:39]
    s_waitcnt lgkmcnt(8)
    v_mfma_f32_16x16x32_bf16 a[40:43], a[108:111], v[88:91], a[40:43]
    ds_write_b128 v13, a[248:251] offset:8192
    v_mfma_f32_16x16x32_bf16 a[44:47], a[108:111], v[96:99], a[44:47]
    ds_read_b64_tr_b16 a[104:105], v41
    ds_read_b64_tr_b16 a[106:107], v41 offset:2048
    v_mfma_f32_16x16x32_bf16 a[48:51], a[108:111], v[104:107], a[48:51]
    v_mfma_f32_16x16x32_bf16 a[52:55], a[108:111], v[112:115], a[52:55]
    buffer_load_dwordx4 v252, s[40:43], s79 offen lds
    ds_write_b128 v13, a[252:255] offset:9216
    v_mfma_f32_16x16x32_bf16 a[56:59], a[108:111], v[120:123], a[56:59]
    s_waitcnt lgkmcnt(8)
    v_mfma_f32_16x16x32_bf16 a[60:63], a[112:115], v[88:91], a[60:63]
    v_mfma_f32_16x16x32_bf16 a[64:67], a[112:115], v[96:99], a[64:67]
    ds_read_b64_tr_b16 a[108:109], v42
    ds_read_b64_tr_b16 a[110:111], v42 offset:2048
    v_mfma_f32_16x16x32_bf16 a[68:71], a[112:115], v[104:107], a[68:71]
    v_mfma_f32_16x16x32_bf16 a[72:75], a[112:115], v[112:115], a[72:75]
    v_mfma_f32_16x16x32_bf16 a[76:79], a[112:115], v[120:123], a[76:79]
    s_waitcnt vmcnt(14) lgkmcnt(0)
    s_barrier
    v_mfma_f32_16x16x32_bf16 a[0:3], a[100:103], v[128:131], a[0:3]
    ds_read_b128 v[172:175], v14
    ds_read_b128 v[212:215], v14 offset:5120
    v_mfma_f32_16x16x32_bf16 a[4:7], a[100:103], v[136:139], a[4:7]
    ds_read_b64_tr_b16 a[112:113], v43
    ds_read_b64_tr_b16 a[114:115], v43 offset:2048
    ds_read_b128 v[180:183], v14 offset:1024
    ds_read_b128 v[220:223], v14 offset:6144
    v_mfma_f32_16x16x32_bf16 a[8:11], a[100:103], v[144:147], a[8:11]
    ds_read_b128 v[188:191], v14 offset:2048
    ds_read_b128 v[228:231], v14 offset:7168
    v_and_b32 v21, 7, v0
    v_lshlrev_b32 v21, 2, v21
    s_lshl_b32 s50, s29, 5
    buffer_load_dword v45, v21, s[60:63], s50 offen sc1
    v_mfma_f32_16x16x32_bf16 a[12:15], a[100:103], v[152:155], a[12:15]
    ds_read_b128 v[196:199], v14 offset:3072
    ds_read_b128 v[236:239], v14 offset:8192
    v_mfma_f32_16x16x32_bf16 a[16:19], a[100:103], v[160:163], a[16:19]
    ds_read_b128 v[204:207], v14 offset:4096
    ds_read_b128 v[244:247], v14 offset:9216
    v_mfma_f32_16x16x32_bf16 a[20:23], a[104:107], v[128:131], a[20:23]
    v_accvgpr_read_b32 v6, a176
    s_waitcnt lgkmcnt(11)
    v_add_f32 v172, v172, v6
    v_mfma_f32_16x16x32_bf16 a[24:27], a[104:107], v[136:139], a[24:27]
    ds_read_b64_tr_b16 a[100:101], v40 offset:4096
    ds_read_b64_tr_b16 a[102:103], v40 offset:6144
    v_mul_f32 v172, v172, v8
    v_accvgpr_read_b32 v7, a177
    v_mfma_f32_16x16x32_bf16 a[28:31], a[104:107], v[144:147], a[28:31]
    v_add_f32 v173, v173, v7
    v_mul_f32 v173, v173, v8
    v_mfma_f32_16x16x32_bf16 a[32:35], a[104:107], v[152:155], a[32:35]
    v_accvgpr_read_b32 v6, a178
    v_add_f32 v174, v174, v6
    v_mfma_f32_16x16x32_bf16 a[36:39], a[104:107], v[160:163], a[36:39]
    v_mul_f32 v174, v174, v8
    v_accvgpr_read_b32 v7, a179
    v_mfma_f32_16x16x32_bf16 a[40:43], a[108:111], v[128:131], a[40:43]
    v_add_f32 v175, v175, v7
    v_mul_f32 v175, v175, v8
    v_mfma_f32_16x16x32_bf16 a[44:47], a[108:111], v[136:139], a[44:47]
    ds_read_b64_tr_b16 a[104:105], v41 offset:4096
    ds_read_b64_tr_b16 a[106:107], v41 offset:6144
    v_accvgpr_read_b32 v6, a196
    s_waitcnt lgkmcnt(14)
    v_add_f32 v212, v212, v6
    v_mfma_f32_16x16x32_bf16 a[48:51], a[108:111], v[144:147], a[48:51]
    v_mul_f32 v212, v212, v8
    v_accvgpr_read_b32 v7, a197
    v_mfma_f32_16x16x32_bf16 a[52:55], a[108:111], v[152:155], a[52:55]
    v_add_f32 v213, v213, v7
    v_mfma_f32_16x16x32_bf16 a[56:59], a[108:111], v[160:163], a[56:59]
    v_mul_f32 v213, v213, v8
    v_accvgpr_read_b32 v6, a198
    s_waitcnt lgkmcnt(12)
    v_mfma_f32_16x16x32_bf16 a[60:63], a[112:115], v[128:131], a[60:63]
    v_add_f32 v214, v214, v6
    v_mul_f32 v214, v214, v8
    v_mfma_f32_16x16x32_bf16 a[64:67], a[112:115], v[136:139], a[64:67]
    ds_read_b64_tr_b16 a[108:109], v42 offset:4096
    ds_read_b64_tr_b16 a[110:111], v42 offset:6144
    v_accvgpr_read_b32 v7, a199
    v_add_f32 v215, v215, v7
    v_mfma_f32_16x16x32_bf16 a[68:71], a[112:115], v[144:147], a[68:71]
    v_mul_f32 v215, v215, v8
    v_cvt_pk_bf16_f32 v172, v172, v173
    v_mfma_f32_16x16x32_bf16 a[72:75], a[112:115], v[152:155], a[72:75]
    v_cvt_pk_bf16_f32 v173, v174, v175
    v_cvt_pk_bf16_f32 v174, v212, v213
    v_mfma_f32_16x16x32_bf16 a[76:79], a[112:115], v[160:163], a[76:79]
    v_cvt_pk_bf16_f32 v175, v214, v215
    s_mov_b32 s49, 20480
    buffer_store_dwordx4 v[172:175], v15, s[24:27], s49 offen sc1
    s_waitcnt lgkmcnt(4)
    v_mfma_f32_16x16x32_bf16 a[0:3], a[100:103], v[168:171], a[0:3]
    v_accvgpr_read_b32 v6, a180
    v_add_f32 v180, v180, v6
    v_mfma_f32_16x16x32_bf16 a[4:7], a[100:103], v[176:179], a[4:7]
    ds_read_b64_tr_b16 a[112:113], v43 offset:4096
    ds_read_b64_tr_b16 a[114:115], v43 offset:6144
    v_mul_f32 v180, v180, v9
    v_accvgpr_read_b32 v7, a181
    v_mfma_f32_16x16x32_bf16 a[8:11], a[100:103], v[184:187], a[8:11]
    v_add_f32 v181, v181, v7
    v_mul_f32 v181, v181, v9
    v_mfma_f32_16x16x32_bf16 a[12:15], a[100:103], v[192:195], a[12:15]
    v_accvgpr_read_b32 v6, a182
    v_add_f32 v182, v182, v6
    v_mfma_f32_16x16x32_bf16 a[16:19], a[100:103], v[200:203], a[16:19]
    v_mul_f32 v182, v182, v9
    v_accvgpr_read_b32 v7, a183
    s_waitcnt lgkmcnt(4)
    v_mfma_f32_16x16x32_bf16 a[20:23], a[104:107], v[168:171], a[20:23]
    v_add_u32 v36, 0x4000, v34
    v_xor_b32 v37, 32, v36
    v_xor_b32 v38, 64, v36
    v_xor_b32 v39, 0x60, v36
    v_add_f32 v183, v183, v7
    v_mul_f32 v183, v183, v9
    v_mfma_f32_16x16x32_bf16 a[24:27], a[104:107], v[176:179], a[24:27]
    ds_read_b64_tr_b16 a[100:101], v36
    ds_read_b64_tr_b16 a[102:103], v36 offset:2048
    v_accvgpr_read_b32 v6, a200
    v_mfma_f32_16x16x32_bf16 a[28:31], a[104:107], v[184:187], a[28:31]
    v_add_f32 v220, v220, v6
    v_mul_f32 v220, v220, v9
    v_mfma_f32_16x16x32_bf16 a[32:35], a[104:107], v[192:195], a[32:35]
    v_accvgpr_read_b32 v7, a201
    v_add_f32 v221, v221, v7
    v_mfma_f32_16x16x32_bf16 a[36:39], a[104:107], v[200:203], a[36:39]
    v_mul_f32 v221, v221, v9
    v_accvgpr_read_b32 v6, a202
    s_waitcnt lgkmcnt(4)
    v_mfma_f32_16x16x32_bf16 a[40:43], a[108:111], v[168:171], a[40:43]
    v_add_f32 v222, v222, v6
    v_mul_f32 v222, v222, v9
    v_mfma_f32_16x16x32_bf16 a[44:47], a[108:111], v[176:179], a[44:47]
    ds_read_b64_tr_b16 a[104:105], v37
    ds_read_b64_tr_b16 a[106:107], v37 offset:2048
    v_accvgpr_read_b32 v7, a203
    v_add_f32 v223, v223, v7
    v_mfma_f32_16x16x32_bf16 a[48:51], a[108:111], v[184:187], a[48:51]
    v_mul_f32 v223, v223, v9
    v_cvt_pk_bf16_f32 v180, v180, v181
    v_mfma_f32_16x16x32_bf16 a[52:55], a[108:111], v[192:195], a[52:55]
    v_cvt_pk_bf16_f32 v181, v182, v183
    v_cvt_pk_bf16_f32 v182, v220, v221
    v_mfma_f32_16x16x32_bf16 a[56:59], a[108:111], v[200:203], a[56:59]
    v_cvt_pk_bf16_f32 v183, v222, v223
    s_mov_b32 s49, 21504
    buffer_store_dwordx4 v[180:183], v15, s[24:27], s49 offen sc1
    s_waitcnt lgkmcnt(4)
    v_mfma_f32_16x16x32_bf16 a[60:63], a[112:115], v[168:171], a[60:63]
    v_accvgpr_read_b32 v6, a184
    v_add_f32 v188, v188, v6
    v_mfma_f32_16x16x32_bf16 a[64:67], a[112:115], v[176:179], a[64:67]
    ds_read_b64_tr_b16 a[108:109], v38
    ds_read_b64_tr_b16 a[110:111], v38 offset:2048
    v_mul_f32 v188, v188, v10
    v_accvgpr_read_b32 v7, a185
    v_mfma_f32_16x16x32_bf16 a[68:71], a[112:115], v[184:187], a[68:71]
    v_add_f32 v189, v189, v7
    v_mul_f32 v189, v189, v10
    v_mfma_f32_16x16x32_bf16 a[72:75], a[112:115], v[192:195], a[72:75]
    v_accvgpr_read_b32 v6, a186
    v_add_f32 v190, v190, v6
    v_mfma_f32_16x16x32_bf16 a[76:79], a[112:115], v[200:203], a[76:79]
    v_mul_f32 v190, v190, v10
    s_waitcnt vmcnt(8)
    s_barrier
    s_waitcnt lgkmcnt(4)
    v_mfma_f32_16x16x32_bf16 a[0:3], a[100:103], v[208:211], a[0:3]
    v_accvgpr_read_b32 v7, a187
    v_add_f32 v191, v191, v7
    v_mfma_f32_16x16x32_bf16 a[4:7], a[100:103], v[216:219], a[4:7]
    ds_read_b64_tr_b16 a[112:113], v39
    ds_read_b64_tr_b16 a[114:115], v39 offset:2048
    s_add_u32 m0, s78, 81920
    s_add_u32 s48, s70, 0
    v_mul_f32 v191, v191, v10
    v_accvgpr_read_b32 v6, a204
    v_mfma_f32_16x16x32_bf16 a[8:11], a[100:103], v[224:227], a[8:11]
    v_add_f32 v228, v228, v6
    v_mul_f32 v228, v228, v10
    v_mfma_f32_16x16x32_bf16 a[12:15], a[100:103], v[232:235], a[12:15]
    v_accvgpr_read_b32 v7, a205
    v_add_f32 v229, v229, v7
    v_mfma_f32_16x16x32_bf16 a[16:19], a[100:103], v[240:243], a[16:19]
    v_mul_f32 v229, v229, v10
    v_accvgpr_read_b32 v6, a206
    s_waitcnt lgkmcnt(4)
    v_mfma_f32_16x16x32_bf16 a[20:23], a[104:107], v[208:211], a[20:23]
    v_add_f32 v230, v230, v6
    v_mul_f32 v230, v230, v10
    v_mfma_f32_16x16x32_bf16 a[24:27], a[104:107], v[216:219], a[24:27]
    ds_read_b64_tr_b16 a[100:101], v36 offset:4096
    ds_read_b64_tr_b16 a[102:103], v36 offset:6144
    buffer_load_dwordx4 v253, s[24:27], s48 offen lds
    v_accvgpr_read_b32 v7, a207
    v_add_f32 v231, v231, v7
    v_mfma_f32_16x16x32_bf16 a[28:31], a[104:107], v[224:227], a[28:31]
    v_mul_f32 v231, v231, v10
    v_cvt_pk_bf16_f32 v188, v188, v189
    v_mfma_f32_16x16x32_bf16 a[32:35], a[104:107], v[232:235], a[32:35]
    v_cvt_pk_bf16_f32 v189, v190, v191
    v_cvt_pk_bf16_f32 v190, v228, v229
    v_mfma_f32_16x16x32_bf16 a[36:39], a[104:107], v[240:243], a[36:39]
    v_cvt_pk_bf16_f32 v191, v230, v231
    s_mov_b32 s49, 22528
    buffer_store_dwordx4 v[188:191], v15, s[24:27], s49 offen sc1
    s_waitcnt lgkmcnt(4)
    v_mfma_f32_16x16x32_bf16 a[40:43], a[108:111], v[208:211], a[40:43]
    v_accvgpr_read_b32 v6, a188
    v_add_f32 v196, v196, v6
    v_mfma_f32_16x16x32_bf16 a[44:47], a[108:111], v[216:219], a[44:47]
    ds_read_b64_tr_b16 a[104:105], v37 offset:4096
    ds_read_b64_tr_b16 a[106:107], v37 offset:6144
    buffer_load_dwordx4 v253, s[24:27], s48 offen offset:1024 lds
    v_mul_f32 v196, v196, v11
    v_accvgpr_read_b32 v7, a189
    v_mfma_f32_16x16x32_bf16 a[48:51], a[108:111], v[224:227], a[48:51]
    v_add_f32 v197, v197, v7
    v_mul_f32 v197, v197, v11
    v_mfma_f32_16x16x32_bf16 a[52:55], a[108:111], v[232:235], a[52:55]
    v_accvgpr_read_b32 v6, a190
    v_add_f32 v198, v198, v6
    v_mfma_f32_16x16x32_bf16 a[56:59], a[108:111], v[240:243], a[56:59]
    v_mul_f32 v198, v198, v11
    v_accvgpr_read_b32 v7, a191
    s_waitcnt lgkmcnt(4)
    v_mfma_f32_16x16x32_bf16 a[60:63], a[112:115], v[208:211], a[60:63]
    v_add_f32 v199, v199, v7
    v_mul_f32 v199, v199, v11
    v_mfma_f32_16x16x32_bf16 a[64:67], a[112:115], v[216:219], a[64:67]
    ds_read_b64_tr_b16 a[108:109], v38 offset:4096
    ds_read_b64_tr_b16 a[110:111], v38 offset:6144
    v_accvgpr_read_b32 v6, a208
    v_add_f32 v236, v236, v6
    v_mfma_f32_16x16x32_bf16 a[68:71], a[112:115], v[224:227], a[68:71]
    buffer_load_dwordx4 v253, s[24:27], s48 offen offset:2048 lds
    v_mul_f32 v236, v236, v11
    v_accvgpr_read_b32 v7, a209
    v_mfma_f32_16x16x32_bf16 a[72:75], a[112:115], v[232:235], a[72:75]
    v_add_f32 v237, v237, v7
    v_mul_f32 v237, v237, v11
    v_mfma_f32_16x16x32_bf16 a[76:79], a[112:115], v[240:243], a[76:79]
    v_accvgpr_read_b32 v6, a210
    s_waitcnt lgkmcnt(4)
    v_mfma_f32_16x16x32_bf16 a[0:3], a[100:103], v[52:55], a[0:3]
    v_add_f32 v238, v238, v6
    v_mul_f32 v238, v238, v11
    v_mfma_f32_16x16x32_bf16 a[4:7], a[100:103], v[60:63], a[4:7]
    ds_read_b64_tr_b16 a[112:113], v39 offset:4096
    ds_read_b64_tr_b16 a[114:115], v39 offset:6144
    v_accvgpr_read_b32 v7, a211
    v_add_f32 v239, v239, v7
    v_mfma_f32_16x16x32_bf16 a[8:11], a[100:103], v[68:71], a[8:11]
    buffer_load_dwordx4 v253, s[24:27], s48 offen offset:3072 lds
    v_mul_f32 v239, v239, v11
    v_cvt_pk_bf16_f32 v196, v196, v197
    v_mfma_f32_16x16x32_bf16 a[12:15], a[100:103], v[76:79], a[12:15]
    v_cvt_pk_bf16_f32 v197, v198, v199
    v_cvt_pk_bf16_f32 v198, v236, v237
    v_mfma_f32_16x16x32_bf16 a[16:19], a[100:103], v[84:87], a[16:19]
    v_cvt_pk_bf16_f32 v199, v238, v239
    s_mov_b32 s49, 23552
    buffer_store_dwordx4 v[196:199], v15, s[24:27], s49 offen sc1
    s_waitcnt lgkmcnt(4)
    v_mfma_f32_16x16x32_bf16 a[20:23], a[104:107], v[52:55], a[20:23]
    v_add_u32 v40, 0x8000, v34
    v_xor_b32 v41, 32, v40
    v_xor_b32 v42, 64, v40
    v_xor_b32 v43, 0x60, v40
    v_accvgpr_read_b32 v6, a192
    v_add_f32 v204, v204, v6
    v_mfma_f32_16x16x32_bf16 a[24:27], a[104:107], v[60:63], a[24:27]
    ds_read_b64_tr_b16 a[100:101], v42
    ds_read_b64_tr_b16 a[102:103], v42 offset:2048
    v_mul_f32 v204, v204, v12
    v_accvgpr_read_b32 v7, a193
    v_mfma_f32_16x16x32_bf16 a[28:31], a[104:107], v[68:71], a[28:31]
    v_add_f32 v205, v205, v7
    v_mul_f32 v205, v205, v12
    v_mfma_f32_16x16x32_bf16 a[32:35], a[104:107], v[76:79], a[32:35]
    s_add_u32 m0, s78, 86016
    s_add_u32 s48, s70, 4096
    v_accvgpr_read_b32 v6, a194
    v_add_f32 v206, v206, v6
    v_mfma_f32_16x16x32_bf16 a[36:39], a[104:107], v[84:87], a[36:39]
    v_mul_f32 v206, v206, v12
    v_accvgpr_read_b32 v7, a195
    s_waitcnt lgkmcnt(4)
    v_mfma_f32_16x16x32_bf16 a[40:43], a[108:111], v[52:55], a[40:43]
    v_add_f32 v207, v207, v7
    v_mul_f32 v207, v207, v12
    v_mfma_f32_16x16x32_bf16 a[44:47], a[108:111], v[60:63], a[44:47]
    ds_read_b64_tr_b16 a[104:105], v43
    ds_read_b64_tr_b16 a[106:107], v43 offset:2048
    v_accvgpr_read_b32 v6, a212
    v_add_f32 v244, v244, v6
    v_mfma_f32_16x16x32_bf16 a[48:51], a[108:111], v[68:71], a[48:51]
    v_mul_f32 v244, v244, v12
    v_accvgpr_read_b32 v7, a213
    v_mfma_f32_16x16x32_bf16 a[52:55], a[108:111], v[76:79], a[52:55]
    buffer_load_dwordx4 v253, s[24:27], s48 offen lds
    v_add_f32 v245, v245, v7
    v_mul_f32 v245, v245, v12
    v_mfma_f32_16x16x32_bf16 a[56:59], a[108:111], v[84:87], a[56:59]
    v_accvgpr_read_b32 v6, a214
    v_add_f32 v246, v246, v6
    s_waitcnt lgkmcnt(4)
    v_mfma_f32_16x16x32_bf16 a[60:63], a[112:115], v[52:55], a[60:63]
    v_mul_f32 v246, v246, v12
    v_accvgpr_read_b32 v7, a215
    v_mfma_f32_16x16x32_bf16 a[64:67], a[112:115], v[60:63], a[64:67]
    ds_read_b64_tr_b16 a[108:109], v42 offset:4096
    ds_read_b64_tr_b16 a[110:111], v42 offset:6144
    v_add_f32 v247, v247, v7
    v_mul_f32 v247, v247, v12
    v_mfma_f32_16x16x32_bf16 a[68:71], a[112:115], v[68:71], a[68:71]
    v_cvt_pk_bf16_f32 v204, v204, v205
    v_cvt_pk_bf16_f32 v205, v206, v207
    v_mfma_f32_16x16x32_bf16 a[72:75], a[112:115], v[76:79], a[72:75]
    v_cvt_pk_bf16_f32 v206, v244, v245
    v_cvt_pk_bf16_f32 v207, v246, v247
    v_mfma_f32_16x16x32_bf16 a[76:79], a[112:115], v[84:87], a[76:79]
    s_mov_b32 s49, 24576
    buffer_store_dwordx4 v[204:207], v15, s[24:27], s49 offen sc1
    s_barrier
    s_waitcnt lgkmcnt(4)
    v_mfma_f32_16x16x32_bf16 a[40:43], a[100:103], v[92:95], a[40:43]
    v_mfma_f32_16x16x32_bf16 a[44:47], a[100:103], v[100:103], a[44:47]
    ds_read_b64_tr_b16 a[112:113], v43 offset:4096
    ds_read_b64_tr_b16 a[114:115], v43 offset:6144
    s_add_u32 m0, s78, 0
    s_add_u32 s79, s66, 163840
    v_mfma_f32_16x16x32_bf16 a[48:51], a[100:103], v[108:111], a[48:51]
    v_mfma_f32_16x16x32_bf16 a[52:55], a[100:103], v[116:119], a[52:55]
    v_mfma_f32_16x16x32_bf16 a[56:59], a[100:103], v[124:127], a[56:59]
    s_waitcnt lgkmcnt(4)
    v_mfma_f32_16x16x32_bf16 a[60:63], a[104:107], v[92:95], a[60:63]
    v_mfma_f32_16x16x32_bf16 a[64:67], a[104:107], v[100:103], a[64:67]
    ds_read_b64_tr_b16 a[100:101], v40
    ds_read_b64_tr_b16 a[102:103], v40 offset:2048
    buffer_load_dwordx4 v248, s[40:43], s79 offen lds
    v_mfma_f32_16x16x32_bf16 a[68:71], a[104:107], v[108:111], a[68:71]
    v_mfma_f32_16x16x32_bf16 a[72:75], a[104:107], v[116:119], a[72:75]
    v_mfma_f32_16x16x32_bf16 a[76:79], a[104:107], v[124:127], a[76:79]
    s_waitcnt lgkmcnt(4)
    v_mfma_f32_16x16x32_bf16 a[40:43], a[108:111], v[132:135], a[40:43]
    v_mfma_f32_16x16x32_bf16 a[44:47], a[108:111], v[140:143], a[44:47]
    ds_read_b64_tr_b16 a[104:105], v41
    ds_read_b64_tr_b16 a[106:107], v41 offset:2048
    buffer_load_dwordx4 v249, s[40:43], s79 offen offset:1024 lds
    v_mfma_f32_16x16x32_bf16 a[48:51], a[108:111], v[148:151], a[48:51]
    v_mfma_f32_16x16x32_bf16 a[52:55], a[108:111], v[156:159], a[52:55]
    v_mfma_f32_16x16x32_bf16 a[56:59], a[108:111], v[164:167], a[56:59]
    s_waitcnt lgkmcnt(4)
    v_mfma_f32_16x16x32_bf16 a[60:63], a[112:115], v[132:135], a[60:63]
    v_mfma_f32_16x16x32_bf16 a[64:67], a[112:115], v[140:143], a[64:67]
    ds_read_b64_tr_b16 a[108:109], v40 offset:4096
    ds_read_b64_tr_b16 a[110:111], v40 offset:6144
    v_mfma_f32_16x16x32_bf16 a[68:71], a[112:115], v[148:151], a[68:71]
    buffer_load_dwordx4 v250, s[40:43], s79 offen offset:2048 lds
    v_mfma_f32_16x16x32_bf16 a[72:75], a[112:115], v[156:159], a[72:75]
    v_mfma_f32_16x16x32_bf16 a[76:79], a[112:115], v[164:167], a[76:79]
    s_waitcnt lgkmcnt(4)
    v_mfma_f32_16x16x32_bf16 a[0:3], a[100:103], v[92:95], a[0:3]
    v_mfma_f32_16x16x32_bf16 a[4:7], a[100:103], v[100:103], a[4:7]
    ds_read_b64_tr_b16 a[112:113], v41 offset:4096
    ds_read_b64_tr_b16 a[114:115], v41 offset:6144
    v_mfma_f32_16x16x32_bf16 a[8:11], a[100:103], v[108:111], a[8:11]
    buffer_load_dwordx4 v251, s[40:43], s79 offen offset:3072 lds
    v_mfma_f32_16x16x32_bf16 a[12:15], a[100:103], v[116:119], a[12:15]
    ds_write_b128 v13, a[40:43]
    v_mfma_f32_16x16x32_bf16 a[16:19], a[100:103], v[124:127], a[16:19]
    ds_write_b128 v13, a[44:47] offset:1024
    s_waitcnt lgkmcnt(6)
    v_mfma_f32_16x16x32_bf16 a[20:23], a[104:107], v[92:95], a[20:23]
    v_mfma_f32_16x16x32_bf16 a[24:27], a[104:107], v[100:103], a[24:27]
    ds_write_b128 v13, a[48:51] offset:2048
    v_mfma_f32_16x16x32_bf16 a[28:31], a[104:107], v[108:111], a[28:31]
    v_mfma_f32_16x16x32_bf16 a[32:35], a[104:107], v[116:119], a[32:35]
    ds_write_b128 v13, a[52:55] offset:3072
    s_add_u32 m0, s78, 4096
    v_mfma_f32_16x16x32_bf16 a[36:39], a[104:107], v[124:127], a[36:39]
    ds_write_b128 v13, a[56:59] offset:4096
    s_waitcnt lgkmcnt(7)
    v_mfma_f32_16x16x32_bf16 a[0:3], a[108:111], v[132:135], a[0:3]
    v_mfma_f32_16x16x32_bf16 a[4:7], a[108:111], v[140:143], a[4:7]
    ds_write_b128 v13, a[60:63] offset:5120
    v_mfma_f32_16x16x32_bf16 a[8:11], a[108:111], v[148:151], a[8:11]
    v_mfma_f32_16x16x32_bf16 a[12:15], a[108:111], v[156:159], a[12:15]
    ds_write_b128 v13, a[64:67] offset:6144
    buffer_load_dwordx4 v252, s[40:43], s79 offen lds
    v_mfma_f32_16x16x32_bf16 a[16:19], a[108:111], v[164:167], a[16:19]
    ds_write_b128 v13, a[68:71] offset:7168
    s_waitcnt lgkmcnt(8)
    v_mfma_f32_16x16x32_bf16 a[20:23], a[112:115], v[132:135], a[20:23]
    v_mfma_f32_16x16x32_bf16 a[24:27], a[112:115], v[140:143], a[24:27]
    ds_write_b128 v13, a[72:75] offset:8192
    v_mfma_f32_16x16x32_bf16 a[28:31], a[112:115], v[148:151], a[28:31]
    v_mfma_f32_16x16x32_bf16 a[32:35], a[112:115], v[156:159], a[32:35]
    ds_write_b128 v13, a[76:79] offset:9216
    v_mfma_f32_16x16x32_bf16 a[36:39], a[112:115], v[164:167], a[36:39]
    s_mov_b32 s49, 0x01010101
    s_waitcnt vmcnt(15)
    s_mov_b32 s39, 200000
L_INIT_L:
    v_cmp_eq_u32 vcc, s49, v45
    s_nop 4
    s_cmp_eq_u64 vcc, -1
    s_cbranch_scc1 L_INIT_D
    s_sub_u32 s39, s39, 1
    s_cmp_eq_u32 s39, 0
    s_cbranch_scc1 L_INIT_D
    v_and_b32 v6, 7, v0
    v_lshlrev_b32 v6, 2, v6
    s_lshl_b32 s48, s29, 5
    buffer_load_dword v45, v6, s[60:63], s48 offen sc1
    s_waitcnt vmcnt(0)
    s_branch L_INIT_L
L_INIT_D:
    s_waitcnt lgkmcnt(0)
    s_barrier
    ds_read_b128 v[172:175], v14
    ds_read_b128 v[212:215], v14 offset:5120
    ds_read_b128 v[180:183], v14 offset:1024
    ds_read_b128 v[220:223], v14 offset:6144
    ds_read_b128 v[188:191], v14 offset:2048
    ds_read_b128 v[228:231], v14 offset:7168
    ds_read_b128 v[196:199], v14 offset:3072
    ds_read_b128 v[236:239], v14 offset:8192
    ds_read_b128 v[204:207], v14 offset:4096
    ds_read_b128 v[244:247], v14 offset:9216
    v_accvgpr_read_b32 v6, a0
    s_waitcnt lgkmcnt(9)
    v_add_f32 v172, v172, v6
    v_mul_f32 v172, v172, v8
    v_accvgpr_read_b32 v7, a1
    v_add_f32 v173, v173, v7
    v_mul_f32 v173, v173, v8
    v_accvgpr_read_b32 v6, a2
    v_add_f32 v174, v174, v6
    v_mul_f32 v174, v174, v8
    v_accvgpr_read_b32 v7, a3
    v_add_f32 v175, v175, v7
    v_mul_f32 v175, v175, v8
    v_accvgpr_read_b32 v6, a20
    s_waitcnt lgkmcnt(8)
    v_add_f32 v212, v212, v6
    v_mul_f32 v212, v212, v8
    v_accvgpr_read_b32 v7, a21
    v_add_f32 v213, v213, v7
    v_mul_f32 v213, v213, v8
    v_accvgpr_read_b32 v6, a22
    v_add_f32 v214, v214, v6
    v_mul_f32 v214, v214, v8
    v_accvgpr_read_b32 v7, a23
    v_add_f32 v215, v215, v7
    v_mul_f32 v215, v215, v8
    v_cvt_pk_bf16_f32 v172, v172, v173
    v_cvt_pk_bf16_f32 v173, v174, v175
    v_cvt_pk_bf16_f32 v174, v212, v213
    v_cvt_pk_bf16_f32 v175, v214, v215
    s_mov_b32 s49, 40960
    buffer_store_dwordx4 v[172:175], v15, s[24:27], s49 offen sc1
    ds_write_b128 v18, v[172:175] offset:40960
    v_accvgpr_read_b32 v6, a4
    s_waitcnt lgkmcnt(8)
    v_add_f32 v180, v180, v6
    v_mul_f32 v180, v180, v9
    v_accvgpr_read_b32 v7, a5
    v_add_f32 v181, v181, v7
    v_mul_f32 v181, v181, v9
    v_accvgpr_read_b32 v6, a6
    v_add_f32 v182, v182, v6
    v_mul_f32 v182, v182, v9
    v_accvgpr_read_b32 v7, a7
    v_add_f32 v183, v183, v7
    v_mul_f32 v183, v183, v9
    v_accvgpr_read_b32 v6, a24
    s_waitcnt lgkmcnt(7)
    v_add_f32 v220, v220, v6
    v_mul_f32 v220, v220, v9
    v_accvgpr_read_b32 v7, a25
    v_add_f32 v221, v221, v7
    v_mul_f32 v221, v221, v9
    v_accvgpr_read_b32 v6, a26
    v_add_f32 v222, v222, v6
    v_mul_f32 v222, v222, v9
    v_accvgpr_read_b32 v7, a27
    v_add_f32 v223, v223, v7
    v_mul_f32 v223, v223, v9
    v_cvt_pk_bf16_f32 v180, v180, v181
    v_cvt_pk_bf16_f32 v181, v182, v183
    v_cvt_pk_bf16_f32 v182, v220, v221
    v_cvt_pk_bf16_f32 v183, v222, v223
    s_mov_b32 s49, 41984
    buffer_store_dwordx4 v[180:183], v15, s[24:27], s49 offen sc1
    ds_write_b128 v18, v[180:183] offset:41984
    v_accvgpr_read_b32 v6, a8
    s_waitcnt lgkmcnt(7)
    v_add_f32 v188, v188, v6
    v_mul_f32 v188, v188, v10
    v_accvgpr_read_b32 v7, a9
    v_add_f32 v189, v189, v7
    v_mul_f32 v189, v189, v10
    v_accvgpr_read_b32 v6, a10
    v_add_f32 v190, v190, v6
    v_mul_f32 v190, v190, v10
    v_accvgpr_read_b32 v7, a11
    v_add_f32 v191, v191, v7
    v_mul_f32 v191, v191, v10
    v_accvgpr_read_b32 v6, a28
    s_waitcnt lgkmcnt(6)
    v_add_f32 v228, v228, v6
    v_mul_f32 v228, v228, v10
    v_accvgpr_read_b32 v7, a29
    v_add_f32 v229, v229, v7
    v_mul_f32 v229, v229, v10
    v_accvgpr_read_b32 v6, a30
    v_add_f32 v230, v230, v6
    v_mul_f32 v230, v230, v10
    v_accvgpr_read_b32 v7, a31
    v_add_f32 v231, v231, v7
    v_mul_f32 v231, v231, v10
    v_cvt_pk_bf16_f32 v188, v188, v189
    v_cvt_pk_bf16_f32 v189, v190, v191
    v_cvt_pk_bf16_f32 v190, v228, v229
    v_cvt_pk_bf16_f32 v191, v230, v231
    s_mov_b32 s49, 43008
    buffer_store_dwordx4 v[188:191], v15, s[24:27], s49 offen sc1
    ds_write_b128 v18, v[188:191] offset:43008
    v_accvgpr_read_b32 v6, a12
    s_waitcnt lgkmcnt(6)
    v_add_f32 v196, v196, v6
    v_mul_f32 v196, v196, v11
    v_accvgpr_read_b32 v7, a13
    v_add_f32 v197, v197, v7
    v_mul_f32 v197, v197, v11
    v_accvgpr_read_b32 v6, a14
    v_add_f32 v198, v198, v6
    v_mul_f32 v198, v198, v11
    v_accvgpr_read_b32 v7, a15
    v_add_f32 v199, v199, v7
    v_mul_f32 v199, v199, v11
    v_accvgpr_read_b32 v6, a32
    s_waitcnt lgkmcnt(5)
    v_add_f32 v236, v236, v6
    v_mul_f32 v236, v236, v11
    v_accvgpr_read_b32 v7, a33
    v_add_f32 v237, v237, v7
    v_mul_f32 v237, v237, v11
    v_accvgpr_read_b32 v6, a34
    v_add_f32 v238, v238, v6
    v_mul_f32 v238, v238, v11
    v_accvgpr_read_b32 v7, a35
    v_add_f32 v239, v239, v7
    v_mul_f32 v239, v239, v11
    v_cvt_pk_bf16_f32 v196, v196, v197
    v_cvt_pk_bf16_f32 v197, v198, v199
    v_cvt_pk_bf16_f32 v198, v236, v237
    v_cvt_pk_bf16_f32 v199, v238, v239
    s_mov_b32 s49, 44032
    buffer_store_dwordx4 v[196:199], v15, s[24:27], s49 offen sc1
    ds_write_b128 v18, v[196:199] offset:44032
    v_accvgpr_read_b32 v6, a16
    s_waitcnt lgkmcnt(5)
    v_add_f32 v204, v204, v6
    v_mul_f32 v204, v204, v12
    v_accvgpr_read_b32 v7, a17
    v_add_f32 v205, v205, v7
    v_mul_f32 v205, v205, v12
    v_accvgpr_read_b32 v6, a18
    v_add_f32 v206, v206, v6
    v_mul_f32 v206, v206, v12
    v_accvgpr_read_b32 v7, a19
    v_add_f32 v207, v207, v7
    v_mul_f32 v207, v207, v12
    v_accvgpr_read_b32 v6, a36
    s_waitcnt lgkmcnt(4)
    v_add_f32 v244, v244, v6
    v_mul_f32 v244, v244, v12
    v_accvgpr_read_b32 v7, a37
    v_add_f32 v245, v245, v7
    v_mul_f32 v245, v245, v12
    v_accvgpr_read_b32 v6, a38
    v_add_f32 v246, v246, v6
    v_mul_f32 v246, v246, v12
    v_accvgpr_read_b32 v7, a39
    v_add_f32 v247, v247, v7
    v_mul_f32 v247, v247, v12
    v_cvt_pk_bf16_f32 v204, v204, v205
    v_cvt_pk_bf16_f32 v205, v206, v207
    v_cvt_pk_bf16_f32 v206, v244, v245
    v_cvt_pk_bf16_f32 v207, v246, v247
    s_mov_b32 s49, 45056
    buffer_store_dwordx4 v[204:207], v15, s[24:27], s49 offen sc1
    ds_write_b128 v18, v[204:207] offset:45056
    v_and_b32 v1, 15, v0
    v_lshrrev_b32 v2, 4, v0
    s_and_b32 s31, s28, 1
    s_lshr_b32 s48, s28, 1
    s_mul_i32 s49, s31, 5120
    v_lshlrev_b32 v3, 4, v0
    v_add_u32 v8, s49, v3
    v_add_u32 v9, 0xc000, v8
    v_add_u32 v10, 0x18000, v8
    v_add_u32 v11, 0x24000, v8
    v_lshrrev_b32 v3, 2, v1
    v_lshl_add_u32 v3, v2, 2, v3
    v_mul_u32_u24 v3, 0x140, v3
    v_and_b32 v4, 3, v1
    v_lshl_add_u32 v3, v4, 3, v3
    v_and_b32 v5, 1, v2
    s_mul_i32 s49, s48, 5
    s_add_u32 s50, s49, 0
    v_xor_b32 v4, s50, v5
    v_lshl_add_u32 v228, v4, 5, v3
    v_add_u32 v233, 0xc000, v228
    v_add_u32 v238, 0x18000, v228
    v_add_u32 v243, 0x24000, v228
    s_add_u32 s50, s49, 1
    v_xor_b32 v4, s50, v5
    v_lshl_add_u32 v229, v4, 5, v3
    v_add_u32 v234, 0xc000, v229
    v_add_u32 v239, 0x18000, v229
    v_add_u32 v244, 0x24000, v229
    s_add_u32 s50, s49, 2
    v_xor_b32 v4, s50, v5
    v_lshl_add_u32 v230, v4, 5, v3
    v_add_u32 v235, 0xc000, v230
    v_add_u32 v240, 0x18000, v230
    v_add_u32 v245, 0x24000, v230
    s_add_u32 s50, s49, 3
    v_xor_b32 v4, s50, v5
    v_lshl_add_u32 v231, v4, 5, v3
    v_add_u32 v236, 0xc000, v231
    v_add_u32 v241, 0x18000, v231
    v_add_u32 v246, 0x24000, v231
    s_add_u32 s50, s49, 4
    v_xor_b32 v4, s50, v5
    v_lshl_add_u32 v232, v4, 5, v3
    v_add_u32 v237, 0xc000, v232
    v_add_u32 v242, 0x18000, v232
    v_add_u32 v247, 0x24000, v232
    s_waitcnt vmcnt(10)
    s_waitcnt lgkmcnt(0)
    s_barrier
    s_cmp_eq_u32 s28, 0
    s_cbranch_scc0 L_FS0
    s_lshl_b32 s48, s75, 2
    s_add_u32 s48, s48, s76
    v_mov_b32 v6, 1
    v_mov_b32 v7, 0
    s_mov_b64 exec, 1
    buffer_store_dword v6, v7, s[24:27], s48 offen sc1
    s_mov_b64 exec, -1
L_FS0:
    s_add_u32 m0, s78, 20480
    s_add_u32 s79, s66, 81920
    buffer_load_dwordx4 v248, s[40:43], s79 offen lds
    buffer_load_dwordx4 v249, s[40:43], s79 offen offset:1024 lds
    buffer_load_dwordx4 v250, s[40:43], s79 offen offset:2048 lds
    buffer_load_dwordx4 v251, s[40:43], s79 offen offset:3072 lds
    s_add_u32 m0, s78, 24576
    s_nop 0
    buffer_load_dwordx4 v252, s[40:43], s79 offen lds
    s_add_u32 m0, s78, 102400
    s_add_u32 s48, s70, 20480
    buffer_load_dwordx4 v253, s[24:27], s48 offen lds
    buffer_load_dwordx4 v253, s[24:27], s48 offen offset:1024 lds
    buffer_load_dwordx4 v253, s[24:27], s48 offen offset:2048 lds
    buffer_load_dwordx4 v253, s[24:27], s48 offen offset:3072 lds
    s_add_u32 m0, s78, 106496
    s_add_u32 s48, s70, 24576
    buffer_load_dwordx4 v253, s[24:27], s48 offen lds
    ds_read_b128 v[188:191], v9 offset:32768
    ds_read_b64_tr_b16 v[148:149], v233 offset:12288
    ds_read_b64_tr_b16 v[150:151], v233 offset:17408
    ds_read_b128 v[192:195], v9 offset:33792
    ds_read_b128 v[196:199], v9 offset:34816
    ds_read_b64_tr_b16 v[152:153], v234 offset:12288
    ds_read_b64_tr_b16 v[154:155], v234 offset:17408
    ds_read_b128 v[200:203], v9 offset:35840
    ds_read_b128 v[204:207], v9 offset:36864
    ds_read_b64_tr_b16 v[156:157], v235 offset:12288
    ds_read_b64_tr_b16 v[158:159], v235 offset:17408
    ds_read_b64_tr_b16 v[160:161], v236 offset:12288
    ds_read_b64_tr_b16 v[162:163], v236 offset:17408
    ds_read_b64_tr_b16 v[164:165], v237 offset:12288
    ds_read_b64_tr_b16 v[166:167], v237 offset:17408
    s_waitcnt lgkmcnt(12)
    v_mfma_f32_16x16x32_bf16 v[48:51], v[148:151], v[188:191], 0
    ds_read_b128 v[208:211], v9 offset:43008
    s_waitcnt lgkmcnt(12)
    v_mfma_f32_16x16x32_bf16 v[52:55], v[148:151], v[192:195], 0
    ds_read_b64_tr_b16 v[168:169], v233 offset:22528
    s_waitcnt lgkmcnt(12)
    v_mfma_f32_16x16x32_bf16 v[56:59], v[148:151], v[196:199], 0
    ds_read_b64_tr_b16 v[170:171], v233 offset:27648
    s_waitcnt lgkmcnt(10)
    v_mfma_f32_16x16x32_bf16 v[60:63], v[148:151], v[200:203], 0
    ds_read_b128 v[212:215], v9 offset:44032
    s_waitcnt lgkmcnt(10)
    v_mfma_f32_16x16x32_bf16 v[64:67], v[148:151], v[204:207], 0
    ds_read_b128 v[216:219], v9 offset:45056
    v_mfma_f32_16x16x32_bf16 v[68:71], v[152:155], v[188:191], 0
    v_mfma_f32_16x16x32_bf16 v[72:75], v[152:155], v[192:195], 0
    ds_read_b64_tr_b16 v[172:173], v234 offset:22528
    v_mfma_f32_16x16x32_bf16 v[76:79], v[152:155], v[196:199], 0
    ds_read_b64_tr_b16 v[174:175], v234 offset:27648
    v_mfma_f32_16x16x32_bf16 v[80:83], v[152:155], v[200:203], 0
    ds_read_b128 v[220:223], v9 offset:46080
    v_mfma_f32_16x16x32_bf16 v[84:87], v[152:155], v[204:207], 0
    ds_read_b128 v[224:227], v9 offset:47104
    s_waitcnt lgkmcnt(13)
    v_mfma_f32_16x16x32_bf16 v[88:91], v[156:159], v[188:191], 0
    ds_read_b64_tr_b16 v[176:177], v235 offset:22528
    v_mfma_f32_16x16x32_bf16 v[92:95], v[156:159], v[192:195], 0
    v_mfma_f32_16x16x32_bf16 v[96:99], v[156:159], v[196:199], 0
    ds_read_b64_tr_b16 v[178:179], v235 offset:27648
    v_mfma_f32_16x16x32_bf16 v[100:103], v[156:159], v[200:203], 0
    ds_read_b64_tr_b16 v[180:181], v236 offset:22528
    v_mfma_f32_16x16x32_bf16 v[104:107], v[156:159], v[204:207], 0
    ds_read_b64_tr_b16 v[182:183], v236 offset:27648
    s_waitcnt lgkmcnt(15)
    v_mfma_f32_16x16x32_bf16 v[108:111], v[160:163], v[188:191], 0
    ds_read_b64_tr_b16 v[184:185], v237 offset:22528
    v_mfma_f32_16x16x32_bf16 v[112:115], v[160:163], v[192:195], 0
    ds_read_b64_tr_b16 v[186:187], v237 offset:27648
    v_mfma_f32_16x16x32_bf16 v[116:119], v[160:163], v[196:199], 0
    v_mfma_f32_16x16x32_bf16 v[120:123], v[160:163], v[200:203], 0
    v_mfma_f32_16x16x32_bf16 v[124:127], v[160:163], v[204:207], 0
    s_waitcnt lgkmcnt(15)
    v_mfma_f32_16x16x32_bf16 v[128:131], v[164:167], v[188:191], 0
    v_mfma_f32_16x16x32_bf16 v[132:135], v[164:167], v[192:195], 0
    v_mfma_f32_16x16x32_bf16 v[136:139], v[164:167], v[196:199], 0
    v_mfma_f32_16x16x32_bf16 v[140:143], v[164:167], v[200:203], 0
    v_mfma_f32_16x16x32_bf16 v[144:147], v[164:167], v[204:207], 0
    s_waitcnt vmcnt(15) lgkmcnt(0)
    s_barrier
    v_mfma_f32_16x16x32_bf16 v[48:51], v[168:171], v[208:211], v[48:51]
    ds_read_b128 v[188:191], v8 offset:40960
    v_mfma_f32_16x16x32_bf16 v[52:55], v[168:171], v[212:215], v[52:55]
    ds_read_b64_tr_b16 v[148:149], v228
    s_add_u32 m0, s78, 61440
    s_add_u32 s79, s67, 0
    v_mfma_f32_16x16x32_bf16 v[56:59], v[168:171], v[216:219], v[56:59]
    ds_read_b64_tr_b16 v[150:151], v228 offset:5120
    v_mfma_f32_16x16x32_bf16 v[60:63], v[168:171], v[220:223], v[60:63]
    ds_read_b128 v[192:195], v8 offset:41984
    v_mfma_f32_16x16x32_bf16 v[64:67], v[168:171], v[224:227], v[64:67]
    ds_read_b128 v[196:199], v8 offset:43008
    buffer_load_dwordx4 v248, s[40:43], s79 offen lds
    v_mfma_f32_16x16x32_bf16 v[68:71], v[172:175], v[208:211], v[68:71]
    v_mfma_f32_16x16x32_bf16 v[72:75], v[172:175], v[212:215], v[72:75]
    ds_read_b64_tr_b16 v[152:153], v229
    v_mfma_f32_16x16x32_bf16 v[76:79], v[172:175], v[216:219], v[76:79]
    ds_read_b64_tr_b16 v[154:155], v229 offset:5120
    buffer_load_dwordx4 v249, s[40:43], s79 offen offset:1024 lds
    v_mfma_f32_16x16x32_bf16 v[80:83], v[172:175], v[220:223], v[80:83]
    ds_read_b128 v[200:203], v8 offset:44032
    v_mfma_f32_16x16x32_bf16 v[84:87], v[172:175], v[224:227], v[84:87]
    ds_read_b128 v[204:207], v8 offset:45056
    v_mfma_f32_16x16x32_bf16 v[88:91], v[176:179], v[208:211], v[88:91]
    ds_read_b64_tr_b16 v[156:157], v230
    buffer_load_dwordx4 v250, s[40:43], s79 offen offset:2048 lds
    v_mfma_f32_16x16x32_bf16 v[92:95], v[176:179], v[212:215], v[92:95]
    v_mfma_f32_16x16x32_bf16 v[96:99], v[176:179], v[216:219], v[96:99]
    ds_read_b64_tr_b16 v[158:159], v230 offset:5120
    v_mfma_f32_16x16x32_bf16 v[100:103], v[176:179], v[220:223], v[100:103]
    ds_read_b64_tr_b16 v[160:161], v231
    v_mfma_f32_16x16x32_bf16 v[104:107], v[176:179], v[224:227], v[104:107]
    ds_read_b64_tr_b16 v[162:163], v231 offset:5120
    buffer_load_dwordx4 v251, s[40:43], s79 offen offset:3072 lds
    v_mfma_f32_16x16x32_bf16 v[108:111], v[180:183], v[208:211], v[108:111]
    ds_read_b64_tr_b16 v[164:165], v232
    v_mfma_f32_16x16x32_bf16 v[112:115], v[180:183], v[212:215], v[112:115]
    ds_read_b64_tr_b16 v[166:167], v232 offset:5120
    v_mfma_f32_16x16x32_bf16 v[116:119], v[180:183], v[216:219], v[116:119]
    s_add_u32 m0, s78, 65536
    v_mfma_f32_16x16x32_bf16 v[120:123], v[180:183], v[220:223], v[120:123]
    v_and_b32 v28, 3, v0
    v_mfma_f32_16x16x32_bf16 v[124:127], v[180:183], v[224:227], v[124:127]
    v_mfma_f32_16x16x32_bf16 v[128:131], v[184:187], v[208:211], v[128:131]
    buffer_load_dwordx4 v252, s[40:43], s79 offen lds
    v_lshlrev_b32 v28, 2, v28
    v_mfma_f32_16x16x32_bf16 v[132:135], v[184:187], v[212:215], v[132:135]
    v_mfma_f32_16x16x32_bf16 v[136:139], v[184:187], v[216:219], v[136:139]
    buffer_load_dword v27, v28, s[24:27], s76 offen sc1
    v_mfma_f32_16x16x32_bf16 v[140:143], v[184:187], v[220:223], v[140:143]
    v_mfma_f32_16x16x32_bf16 v[144:147], v[184:187], v[224:227], v[144:147]
    s_waitcnt lgkmcnt(12)
    v_mfma_f32_16x16x32_bf16 v[48:51], v[148:151], v[188:191], v[48:51]
    ds_read_b128 v[208:211], v8 offset:51200
    s_waitcnt lgkmcnt(12)
    v_mfma_f32_16x16x32_bf16 v[52:55], v[148:151], v[192:195], v[52:55]
    ds_read_b64_tr_b16 v[168:169], v228 offset:10240
    s_waitcnt lgkmcnt(12)
    v_mfma_f32_16x16x32_bf16 v[56:59], v[148:151], v[196:199], v[56:59]
    ds_read_b64_tr_b16 v[170:171], v228 offset:15360
    s_waitcnt lgkmcnt(10)
    v_mfma_f32_16x16x32_bf16 v[60:63], v[148:151], v[200:203], v[60:63]
    ds_read_b128 v[212:215], v8 offset:52224
    s_mul_i32 s98, s29, 160
    s_lshl_b32 s99, s74, 1
    s_add_u32 s98, s98, s99
    s_mul_i32 s98, s98, 1280
    s_mul_i32 s99, s75, 320
    s_add_u32 s99, s99, 127
    s_and_b32 s99, s99, 0xffffff80
    s_add_u32 s98, s98, s99
    v_mov_b32 v29, 0
    buffer_load_dword v30, v29, s[44:47], s98 offen
    s_waitcnt lgkmcnt(10)
    v_mfma_f32_16x16x32_bf16 v[64:67], v[148:151], v[204:207], v[64:67]
    ds_read_b128 v[216:219], v8 offset:53248
    v_mfma_f32_16x16x32_bf16 v[68:71], v[152:155], v[188:191], v[68:71]
    v_mfma_f32_16x16x32_bf16 v[72:75], v[152:155], v[192:195], v[72:75]
    ds_read_b64_tr_b16 v[172:173], v229 offset:10240
    v_mfma_f32_16x16x32_bf16 v[76:79], v[152:155], v[196:199], v[76:79]
    ds_read_b64_tr_b16 v[174:175], v229 offset:15360
    v_mfma_f32_16x16x32_bf16 v[80:83], v[152:155], v[200:203], v[80:83]
    ds_read_b128 v[220:223], v8 offset:54272
    v_mfma_f32_16x16x32_bf16 v[84:87], v[152:155], v[204:207], v[84:87]
    ds_read_b128 v[224:227], v8 offset:55296
    s_waitcnt lgkmcnt(13)
    v_mfma_f32_16x16x32_bf16 v[88:91], v[156:159], v[188:191], v[88:91]
    ds_read_b64_tr_b16 v[176:177], v230 offset:10240
    v_mfma_f32_16x16x32_bf16 v[92:95], v[156:159], v[192:195], v[92:95]
    v_mfma_f32_16x16x32_bf16 v[96:99], v[156:159], v[196:199], v[96:99]
    ds_read_b64_tr_b16 v[178:179], v230 offset:15360
    v_mfma_f32_16x16x32_bf16 v[100:103], v[156:159], v[200:203], v[100:103]
    ds_read_b64_tr_b16 v[180:181], v231 offset:10240
    v_mfma_f32_16x16x32_bf16 v[104:107], v[156:159], v[204:207], v[104:107]
    ds_read_b64_tr_b16 v[182:183], v231 offset:15360
    s_waitcnt lgkmcnt(15)
    v_mfma_f32_16x16x32_bf16 v[108:111], v[160:163], v[188:191], v[108:111]
    ds_read_b64_tr_b16 v[184:185], v232 offset:10240
    v_mfma_f32_16x16x32_bf16 v[112:115], v[160:163], v[192:195], v[112:115]
    ds_read_b64_tr_b16 v[186:187], v232 offset:15360
    v_mfma_f32_16x16x32_bf16 v[116:119], v[160:163], v[196:199], v[116:119]
    v_mfma_f32_16x16x32_bf16 v[120:123], v[160:163], v[200:203], v[120:123]
    v_mfma_f32_16x16x32_bf16 v[124:127], v[160:163], v[204:207], v[124:127]
    s_waitcnt lgkmcnt(15)
    v_mfma_f32_16x16x32_bf16 v[128:131], v[164:167], v[188:191], v[128:131]
    v_mfma_f32_16x16x32_bf16 v[132:135], v[164:167], v[192:195], v[132:135]
    v_mfma_f32_16x16x32_bf16 v[136:139], v[164:167], v[196:199], v[136:139]
    v_mfma_f32_16x16x32_bf16 v[140:143], v[164:167], v[200:203], v[140:143]
    v_mfma_f32_16x16x32_bf16 v[144:147], v[164:167], v[204:207], v[144:147]
    s_waitcnt vmcnt(7) lgkmcnt(0)
    s_waitcnt vmcnt(1)
    s_mov_b32 s39, 200000
L_P1_L:
    v_cmp_eq_u32 vcc, 1, v27
    s_nop 4
    s_cmp_eq_u64 vcc, -1
    s_cbranch_scc1 L_P1_D
    s_sub_u32 s39, s39, 1
    s_cmp_eq_u32 s39, 0
    s_cbranch_scc1 L_P1_D
    buffer_load_dword v27, v28, s[24:27], s76 offen sc1
    s_waitcnt vmcnt(0)
    s_branch L_P1_L
L_P1_D:
    s_barrier
    s_cmp_eq_u32 s28, 0
    s_cbranch_scc0 L_FS1
    s_lshl_b32 s48, s75, 2
    s_add_u32 s48, s48, s76
    v_mov_b32 v6, 1
    v_mov_b32 v7, 16
    s_mov_b64 exec, 1
    buffer_store_dword v6, v7, s[24:27], s48 offen sc1
    s_mov_b64 exec, -1
L_FS1:
    v_mfma_f32_16x16x32_bf16 v[48:51], v[168:171], v[208:211], v[48:51]
    ds_read_b128 v[188:191], v10 offset:4096
    v_mfma_f32_16x16x32_bf16 v[52:55], v[168:171], v[212:215], v[52:55]
    ds_read_b64_tr_b16 v[148:149], v228 offset:20480
    s_add_u32 m0, s78, 0
    s_add_u32 s48, s71, 0
    v_mfma_f32_16x16x32_bf16 v[56:59], v[168:171], v[216:219], v[56:59]
    ds_read_b64_tr_b16 v[150:151], v228 offset:25600
    v_mfma_f32_16x16x32_bf16 v[60:63], v[168:171], v[220:223], v[60:63]
    ds_read_b128 v[192:195], v10 offset:5120
    v_mfma_f32_16x16x32_bf16 v[64:67], v[168:171], v[224:227], v[64:67]
    ds_read_b128 v[196:199], v10 offset:6144
    buffer_load_dwordx4 v253, s[24:27], s48 offen lds
    v_mfma_f32_16x16x32_bf16 v[68:71], v[172:175], v[208:211], v[68:71]
    v_mfma_f32_16x16x32_bf16 v[72:75], v[172:175], v[212:215], v[72:75]
    ds_read_b64_tr_b16 v[152:153], v229 offset:20480
    v_mfma_f32_16x16x32_bf16 v[76:79], v[172:175], v[216:219], v[76:79]
    ds_read_b64_tr_b16 v[154:155], v229 offset:25600
    buffer_load_dwordx4 v253, s[24:27], s48 offen offset:1024 lds
    v_mfma_f32_16x16x32_bf16 v[80:83], v[172:175], v[220:223], v[80:83]
    ds_read_b128 v[200:203], v10 offset:7168
    v_mfma_f32_16x16x32_bf16 v[84:87], v[172:175], v[224:227], v[84:87]
    ds_read_b128 v[204:207], v10 offset:8192
    v_mfma_f32_16x16x32_bf16 v[88:91], v[176:179], v[208:211], v[88:91]
    ds_read_b64_tr_b16 v[156:157], v230 offset:20480
    buffer_load_dwordx4 v253, s[24:27], s48 offen offset:2048 lds
    v_mfma_f32_16x16x32_bf16 v[92:95], v[176:179], v[212:215], v[92:95]
    v_mfma_f32_16x16x32_bf16 v[96:99], v[176:179], v[216:219], v[96:99]
    ds_read_b64_tr_b16 v[158:159], v230 offset:25600
    v_mfma_f32_16x16x32_bf16 v[100:103], v[176:179], v[220:223], v[100:103]
    ds_read_b64_tr_b16 v[160:161], v231 offset:20480
    v_mfma_f32_16x16x32_bf16 v[104:107], v[176:179], v[224:227], v[104:107]
    ds_read_b64_tr_b16 v[162:163], v231 offset:25600
    buffer_load_dwordx4 v253, s[24:27], s48 offen offset:3072 lds
    v_mfma_f32_16x16x32_bf16 v[108:111], v[180:183], v[208:211], v[108:111]
    ds_read_b64_tr_b16 v[164:165], v232 offset:20480
    v_mfma_f32_16x16x32_bf16 v[112:115], v[180:183], v[212:215], v[112:115]
    ds_read_b64_tr_b16 v[166:167], v232 offset:25600
    v_mfma_f32_16x16x32_bf16 v[116:119], v[180:183], v[216:219], v[116:119]
    s_add_u32 m0, s78, 4096
    s_add_u32 s48, s71, 4096
    v_mfma_f32_16x16x32_bf16 v[120:123], v[180:183], v[220:223], v[120:123]
    v_mfma_f32_16x16x32_bf16 v[124:127], v[180:183], v[224:227], v[124:127]
    v_mfma_f32_16x16x32_bf16 v[128:131], v[184:187], v[208:211], v[128:131]
    buffer_load_dwordx4 v253, s[24:27], s48 offen lds
    v_mfma_f32_16x16x32_bf16 v[132:135], v[184:187], v[212:215], v[132:135]
    v_mfma_f32_16x16x32_bf16 v[136:139], v[184:187], v[216:219], v[136:139]
    v_mfma_f32_16x16x32_bf16 v[140:143], v[184:187], v[220:223], v[140:143]
    v_mfma_f32_16x16x32_bf16 v[144:147], v[184:187], v[224:227], v[144:147]
    s_waitcnt lgkmcnt(12)
    v_mfma_f32_16x16x32_bf16 v[48:51], v[148:151], v[188:191], v[48:51]
    ds_read_b128 v[208:211], v10 offset:14336
    s_add_u32 m0, s78, 40960
    s_add_u32 s79, s67, 81920
    s_waitcnt lgkmcnt(12)
    v_mfma_f32_16x16x32_bf16 v[52:55], v[148:151], v[192:195], v[52:55]
    ds_read_b64_tr_b16 v[168:169], v228 offset:30720
    s_waitcnt lgkmcnt(12)
    v_mfma_f32_16x16x32_bf16 v[56:59], v[148:151], v[196:199], v[56:59]
    ds_read_b64_tr_b16 v[170:171], v228 offset:35840
    s_waitcnt lgkmcnt(10)
    v_mfma_f32_16x16x32_bf16 v[60:63], v[148:151], v[200:203], v[60:63]
    ds_read_b128 v[212:215], v10 offset:15360
    buffer_load_dwordx4 v248, s[40:43], s79 offen lds
    s_waitcnt lgkmcnt(10)
    v_mfma_f32_16x16x32_bf16 v[64:67], v[148:151], v[204:207], v[64:67]
    ds_read_b128 v[216:219], v10 offset:16384
    v_mfma_f32_16x16x32_bf16 v[68:71], v[152:155], v[188:191], v[68:71]
    v_mfma_f32_16x16x32_bf16 v[72:75], v[152:155], v[192:195], v[72:75]
    ds_read_b64_tr_b16 v[172:173], v229 offset:30720
    buffer_load_dwordx4 v249, s[40:43], s79 offen offset:1024 lds
    v_mfma_f32_16x16x32_bf16 v[76:79], v[152:155], v[196:199], v[76:79]
    ds_read_b64_tr_b16 v[174:175], v229 offset:35840
    v_mfma_f32_16x16x32_bf16 v[80:83], v[152:155], v[200:203], v[80:83]
    ds_read_b128 v[220:223], v10 offset:17408
    v_mfma_f32_16x16x32_bf16 v[84:87], v[152:155], v[204:207], v[84:87]
    ds_read_b128 v[224:227], v10 offset:18432
    buffer_load_dwordx4 v250, s[40:43], s79 offen offset:2048 lds
    s_waitcnt lgkmcnt(13)
    v_mfma_f32_16x16x32_bf16 v[88:91], v[156:159], v[188:191], v[88:91]
    ds_read_b64_tr_b16 v[176:177], v230 offset:30720
    v_mfma_f32_16x16x32_bf16 v[92:95], v[156:159], v[192:195], v[92:95]
    v_mfma_f32_16x16x32_bf16 v[96:99], v[156:159], v[196:199], v[96:99]
    ds_read_b64_tr_b16 v[178:179], v230 offset:35840
    v_mfma_f32_16x16x32_bf16 v[100:103], v[156:159], v[200:203], v[100:103]
    ds_read_b64_tr_b16 v[180:181], v231 offset:30720
    buffer_load_dwordx4 v251, s[40:43], s79 offen offset:3072 lds
    v_mfma_f32_16x16x32_bf16 v[104:107], v[156:159], v[204:207], v[104:107]
    ds_read_b64_tr_b16 v[182:183], v231 offset:35840
    s_waitcnt lgkmcnt(15)
    v_mfma_f32_16x16x32_bf16 v[108:111], v[160:163], v[188:191], v[108:111]
    ds_read_b64_tr_b16 v[184:185], v232 offset:30720
    v_mfma_f32_16x16x32_bf16 v[112:115], v[160:163], v[192:195], v[112:115]
    ds_read_b64_tr_b16 v[186:187], v232 offset:35840
    s_add_u32 m0, s78, 45056
    v_mfma_f32_16x16x32_bf16 v[116:119], v[160:163], v[196:199], v[116:119]
    v_mfma_f32_16x16x32_bf16 v[120:123], v[160:163], v[200:203], v[120:123]
    v_mfma_f32_16x16x32_bf16 v[124:127], v[160:163], v[204:207], v[124:127]
    buffer_load_dwordx4 v252, s[40:43], s79 offen lds
    s_waitcnt lgkmcnt(15)
    v_mfma_f32_16x16x32_bf16 v[128:131], v[164:167], v[188:191], v[128:131]
    v_mfma_f32_16x16x32_bf16 v[132:135], v[164:167], v[192:195], v[132:135]
    v_mfma_f32_16x16x32_bf16 v[136:139], v[164:167], v[196:199], v[136:139]
    v_mfma_f32_16x16x32_bf16 v[140:143], v[164:167], v[200:203], v[140:143]
    v_mfma_f32_16x16x32_bf16 v[144:147], v[164:167], v[204:207], v[144:147]
    s_waitcnt vmcnt(5) lgkmcnt(0)
    s_barrier
    v_mfma_f32_16x16x32_bf16 v[48:51], v[168:171], v[208:211], v[48:51]
    ds_read_b128 v[188:191], v8
    v_mfma_f32_16x16x32_bf16 v[52:55], v[168:171], v[212:215], v[52:55]
    ds_read_b64_tr_b16 v[148:149], v233 offset:12288
    s_add_u32 m0, s78, 20480
    s_add_u32 s48, s71, 20480
    v_mfma_f32_16x16x32_bf16 v[56:59], v[168:171], v[216:219], v[56:59]
    ds_read_b64_tr_b16 v[150:151], v233 offset:17408
    v_mfma_f32_16x16x32_bf16 v[60:63], v[168:171], v[220:223], v[60:63]
    ds_read_b128 v[192:195], v8 offset:1024
    v_mfma_f32_16x16x32_bf16 v[64:67], v[168:171], v[224:227], v[64:67]
    ds_read_b128 v[196:199], v8 offset:2048
    buffer_load_dwordx4 v253, s[24:27], s48 offen lds
    v_mfma_f32_16x16x32_bf16 v[68:71], v[172:175], v[208:211], v[68:71]
    v_mfma_f32_16x16x32_bf16 v[72:75], v[172:175], v[212:215], v[72:75]
    ds_read_b64_tr_b16 v[152:153], v234 offset:12288
    v_mfma_f32_16x16x32_bf16 v[76:79], v[172:175], v[216:219], v[76:79]
    ds_read_b64_tr_b16 v[154:155], v234 offset:17408
    buffer_load_dwordx4 v253, s[24:27], s48 offen offset:1024 lds
    v_mfma_f32_16x16x32_bf16 v[80:83], v[172:175], v[220:223], v[80:83]
    ds_read_b128 v[200:203], v8 offset:3072
    v_mfma_f32_16x16x32_bf16 v[84:87], v[172:175], v[224:227], v[84:87]
    ds_read_b128 v[204:207], v8 offset:4096
    v_mfma_f32_16x16x32_bf16 v[88:91], v[176:179], v[208:211], v[88:91]
    ds_read_b64_tr_b16 v[156:157], v235 offset:12288
    buffer_load_dwordx4 v253, s[24:27], s48 offen offset:2048 lds
    v_mfma_f32_16x16x32_bf16 v[92:95], v[176:179], v[212:215], v[92:95]
    v_mfma_f32_16x16x32_bf16 v[96:99], v[176:179], v[216:219], v[96:99]
    ds_read_b64_tr_b16 v[158:159], v235 offset:17408
    v_mfma_f32_16x16x32_bf16 v[100:103], v[176:179], v[220:223], v[100:103]
    ds_read_b64_tr_b16 v[160:161], v236 offset:12288
    v_mfma_f32_16x16x32_bf16 v[104:107], v[176:179], v[224:227], v[104:107]
    ds_read_b64_tr_b16 v[162:163], v236 offset:17408
    buffer_load_dwordx4 v253, s[24:27], s48 offen offset:3072 lds
    v_mfma_f32_16x16x32_bf16 v[108:111], v[180:183], v[208:211], v[108:111]
    ds_read_b64_tr_b16 v[164:165], v237 offset:12288
    v_mfma_f32_16x16x32_bf16 v[112:115], v[180:183], v[212:215], v[112:115]
    ds_read_b64_tr_b16 v[166:167], v237 offset:17408
    v_mfma_f32_16x16x32_bf16 v[116:119], v[180:183], v[216:219], v[116:119]
    s_add_u32 m0, s78, 24576
    s_add_u32 s48, s71, 24576
    v_mfma_f32_16x16x32_bf16 v[120:123], v[180:183], v[220:223], v[120:123]
    v_mfma_f32_16x16x32_bf16 v[124:127], v[180:183], v[224:227], v[124:127]
    v_mfma_f32_16x16x32_bf16 v[128:131], v[184:187], v[208:211], v[128:131]
    buffer_load_dwordx4 v253, s[24:27], s48 offen lds
    v_mfma_f32_16x16x32_bf16 v[132:135], v[184:187], v[212:215], v[132:135]
    v_mfma_f32_16x16x32_bf16 v[136:139], v[184:187], v[216:219], v[136:139]
    v_mfma_f32_16x16x32_bf16 v[140:143], v[184:187], v[220:223], v[140:143]
    v_mfma_f32_16x16x32_bf16 v[144:147], v[184:187], v[224:227], v[144:147]
    s_waitcnt lgkmcnt(12)
    v_mfma_f32_16x16x32_bf16 v[48:51], v[148:151], v[188:191], v[48:51]
    ds_read_b128 v[208:211], v8 offset:10240
    s_add_u32 m0, s78, 81920
    s_add_u32 s79, s68, 0
    s_waitcnt lgkmcnt(12)
    v_mfma_f32_16x16x32_bf16 v[52:55], v[148:151], v[192:195], v[52:55]
    ds_read_b64_tr_b16 v[168:169], v233 offset:22528
    s_waitcnt lgkmcnt(12)
    v_mfma_f32_16x16x32_bf16 v[56:59], v[148:151], v[196:199], v[56:59]
    ds_read_b64_tr_b16 v[170:171], v233 offset:27648
    s_waitcnt lgkmcnt(10)
    v_mfma_f32_16x16x32_bf16 v[60:63], v[148:151], v[200:203], v[60:63]
    ds_read_b128 v[212:215], v8 offset:11264
    buffer_load_dwordx4 v248, s[40:43], s79 offen lds
    s_lshl_b32 s98, s29, 2
    s_add_u32 s98, s98, s75
    s_mul_i32 s98, s98, 427008
    s_mul_i32 s99, s74, 53376
    s_add_u32 s98, s98, s99
    s_add_u32 s98, s98, 16830464
    v_mov_b32 v29, 0
    buffer_load_dword v30, v29, s[24:27], s98 offen
    s_waitcnt lgkmcnt(10)
    v_mfma_f32_16x16x32_bf16 v[64:67], v[148:151], v[204:207], v[64:67]
    ds_read_b128 v[216:219], v8 offset:12288
    v_mfma_f32_16x16x32_bf16 v[68:71], v[152:155], v[188:191], v[68:71]
    v_mfma_f32_16x16x32_bf16 v[72:75], v[152:155], v[192:195], v[72:75]
    ds_read_b64_tr_b16 v[172:173], v234 offset:22528
    buffer_load_dwordx4 v249, s[40:43], s79 offen offset:1024 lds
    v_mfma_f32_16x16x32_bf16 v[76:79], v[152:155], v[196:199], v[76:79]
    ds_read_b64_tr_b16 v[174:175], v234 offset:27648
    v_mfma_f32_16x16x32_bf16 v[80:83], v[152:155], v[200:203], v[80:83]
    ds_read_b128 v[220:223], v8 offset:13312
    v_mfma_f32_16x16x32_bf16 v[84:87], v[152:155], v[204:207], v[84:87]
    ds_read_b128 v[224:227], v8 offset:14336
    buffer_load_dwordx4 v250, s[40:43], s79 offen offset:2048 lds
    s_waitcnt lgkmcnt(13)
    v_mfma_f32_16x16x32_bf16 v[88:91], v[156:159], v[188:191], v[88:91]
    ds_read_b64_tr_b16 v[176:177], v235 offset:22528
    v_mfma_f32_16x16x32_bf16 v[92:95], v[156:159], v[192:195], v[92:95]
    v_mfma_f32_16x16x32_bf16 v[96:99], v[156:159], v[196:199], v[96:99]
    ds_read_b64_tr_b16 v[178:179], v235 offset:27648
    v_mfma_f32_16x16x32_bf16 v[100:103], v[156:159], v[200:203], v[100:103]
    ds_read_b64_tr_b16 v[180:181], v236 offset:22528
    buffer_load_dwordx4 v251, s[40:43], s79 offen offset:3072 lds
    v_mfma_f32_16x16x32_bf16 v[104:107], v[156:159], v[204:207], v[104:107]
    ds_read_b64_tr_b16 v[182:183], v236 offset:27648
    s_waitcnt lgkmcnt(15)
    v_mfma_f32_16x16x32_bf16 v[108:111], v[160:163], v[188:191], v[108:111]
    ds_read_b64_tr_b16 v[184:185], v237 offset:22528
    v_mfma_f32_16x16x32_bf16 v[112:115], v[160:163], v[192:195], v[112:115]
    ds_read_b64_tr_b16 v[186:187], v237 offset:27648
    s_add_u32 m0, s78, 86016
    v_mfma_f32_16x16x32_bf16 v[116:119], v[160:163], v[196:199], v[116:119]
    v_mfma_f32_16x16x32_bf16 v[120:123], v[160:163], v[200:203], v[120:123]
    v_mfma_f32_16x16x32_bf16 v[124:127], v[160:163], v[204:207], v[124:127]
    buffer_load_dwordx4 v252, s[40:43], s79 offen lds
    s_waitcnt lgkmcnt(15)
    v_mfma_f32_16x16x32_bf16 v[128:131], v[164:167], v[188:191], v[128:131]
    v_mfma_f32_16x16x32_bf16 v[132:135], v[164:167], v[192:195], v[132:135]
    v_mfma_f32_16x16x32_bf16 v[136:139], v[164:167], v[196:199], v[136:139]
    v_mfma_f32_16x16x32_bf16 v[140:143], v[164:167], v[200:203], v[140:143]
    v_mfma_f32_16x16x32_bf16 v[144:147], v[164:167], v[204:207], v[144:147]
    s_waitcnt vmcnt(6) lgkmcnt(0)
    s_barrier
    v_mfma_f32_16x16x32_bf16 v[48:51], v[168:171], v[208:211], v[48:51]
    ds_read_b128 v[188:191], v8 offset:20480
    v_mfma_f32_16x16x32_bf16 v[52:55], v[168:171], v[212:215], v[52:55]
    ds_read_b64_tr_b16 v[148:149], v228 offset:40960
    s_add_u32 m0, s78, 0
    s_add_u32 s48, s72, 0
    v_mfma_f32_16x16x32_bf16 v[56:59], v[168:171], v[216:219], v[56:59]
    ds_read_b64_tr_b16 v[150:151], v228 offset:46080
    v_mfma_f32_16x16x32_bf16 v[60:63], v[168:171], v[220:223], v[60:63]
    ds_read_b128 v[192:195], v8 offset:21504
    v_mfma_f32_16x16x32_bf16 v[64:67], v[168:171], v[224:227], v[64:67]
    ds_read_b128 v[196:199], v8 offset:22528
    buffer_load_dwordx4 v253, s[24:27], s48 offen lds
    v_mfma_f32_16x16x32_bf16 v[68:71], v[172:175], v[208:211], v[68:71]
    v_mfma_f32_16x16x32_bf16 v[72:75], v[172:175], v[212:215], v[72:75]
    ds_read_b64_tr_b16 v[152:153], v229 offset:40960
    v_mfma_f32_16x16x32_bf16 v[76:79], v[172:175], v[216:219], v[76:79]
    ds_read_b64_tr_b16 v[154:155], v229 offset:46080
    buffer_load_dwordx4 v253, s[24:27], s48 offen offset:1024 lds
    v_mfma_f32_16x16x32_bf16 v[80:83], v[172:175], v[220:223], v[80:83]
    ds_read_b128 v[200:203], v8 offset:23552
    v_mfma_f32_16x16x32_bf16 v[84:87], v[172:175], v[224:227], v[84:87]
    ds_read_b128 v[204:207], v8 offset:24576
    v_mfma_f32_16x16x32_bf16 v[88:91], v[176:179], v[208:211], v[88:91]
    ds_read_b64_tr_b16 v[156:157], v230 offset:40960
    buffer_load_dwordx4 v253, s[24:27], s48 offen offset:2048 lds
    v_mfma_f32_16x16x32_bf16 v[92:95], v[176:179], v[212:215], v[92:95]
    v_mfma_f32_16x16x32_bf16 v[96:99], v[176:179], v[216:219], v[96:99]
    ds_read_b64_tr_b16 v[158:159], v230 offset:46080
    v_mfma_f32_16x16x32_bf16 v[100:103], v[176:179], v[220:223], v[100:103]
    ds_read_b64_tr_b16 v[160:161], v231 offset:40960
    v_mfma_f32_16x16x32_bf16 v[104:107], v[176:179], v[224:227], v[104:107]
    ds_read_b64_tr_b16 v[162:163], v231 offset:46080
    buffer_load_dwordx4 v253, s[24:27], s48 offen offset:3072 lds
    v_mfma_f32_16x16x32_bf16 v[108:111], v[180:183], v[208:211], v[108:111]
    ds_read_b64_tr_b16 v[164:165], v232 offset:40960
    v_mfma_f32_16x16x32_bf16 v[112:115], v[180:183], v[212:215], v[112:115]
    ds_read_b64_tr_b16 v[166:167], v232 offset:46080
    v_mfma_f32_16x16x32_bf16 v[116:119], v[180:183], v[216:219], v[116:119]
    s_add_u32 m0, s78, 4096
    s_add_u32 s48, s72, 4096
    v_mfma_f32_16x16x32_bf16 v[120:123], v[180:183], v[220:223], v[120:123]
    v_mfma_f32_16x16x32_bf16 v[124:127], v[180:183], v[224:227], v[124:127]
    v_mfma_f32_16x16x32_bf16 v[128:131], v[184:187], v[208:211], v[128:131]
    buffer_load_dwordx4 v253, s[24:27], s48 offen lds
    v_mfma_f32_16x16x32_bf16 v[132:135], v[184:187], v[212:215], v[132:135]
    v_mfma_f32_16x16x32_bf16 v[136:139], v[184:187], v[216:219], v[136:139]
    v_mfma_f32_16x16x32_bf16 v[140:143], v[184:187], v[220:223], v[140:143]
    v_mfma_f32_16x16x32_bf16 v[144:147], v[184:187], v[224:227], v[144:147]
    s_waitcnt lgkmcnt(12)
    v_mfma_f32_16x16x32_bf16 v[48:51], v[148:151], v[188:191], v[48:51]
    ds_read_b128 v[208:211], v8 offset:30720
    s_add_u32 m0, s78, 61440
    s_add_u32 s79, s68, 81920
    s_waitcnt lgkmcnt(12)
    v_mfma_f32_16x16x32_bf16 v[52:55], v[148:151], v[192:195], v[52:55]
    ds_read_b64_tr_b16 v[168:169], v228 offset:51200
    s_waitcnt lgkmcnt(12)
    v_mfma_f32_16x16x32_bf16 v[56:59], v[148:151], v[196:199], v[56:59]
    ds_read_b64_tr_b16 v[170:171], v228 offset:56320
    s_waitcnt lgkmcnt(10)
    v_mfma_f32_16x16x32_bf16 v[60:63], v[148:151], v[200:203], v[60:63]
    ds_read_b128 v[212:215], v8 offset:31744
    buffer_load_dwordx4 v248, s[40:43], s79 offen lds
    s_waitcnt lgkmcnt(10)
    v_mfma_f32_16x16x32_bf16 v[64:67], v[148:151], v[204:207], v[64:67]
    ds_read_b128 v[216:219], v8 offset:32768
    v_mfma_f32_16x16x32_bf16 v[68:71], v[152:155], v[188:191], v[68:71]
    v_mfma_f32_16x16x32_bf16 v[72:75], v[152:155], v[192:195], v[72:75]
    ds_read_b64_tr_b16 v[172:173], v229 offset:51200
    buffer_load_dwordx4 v249, s[40:43], s79 offen offset:1024 lds
    v_mfma_f32_16x16x32_bf16 v[76:79], v[152:155], v[196:199], v[76:79]
    ds_read_b64_tr_b16 v[174:175], v229 offset:56320
    v_mfma_f32_16x16x32_bf16 v[80:83], v[152:155], v[200:203], v[80:83]
    ds_read_b128 v[220:223], v8 offset:33792
    v_mfma_f32_16x16x32_bf16 v[84:87], v[152:155], v[204:207], v[84:87]
    ds_read_b128 v[224:227], v8 offset:34816
    buffer_load_dwordx4 v250, s[40:43], s79 offen offset:2048 lds
    s_waitcnt lgkmcnt(13)
    v_mfma_f32_16x16x32_bf16 v[88:91], v[156:159], v[188:191], v[88:91]
    ds_read_b64_tr_b16 v[176:177], v230 offset:51200
    v_mfma_f32_16x16x32_bf16 v[92:95], v[156:159], v[192:195], v[92:95]
    v_mfma_f32_16x16x32_bf16 v[96:99], v[156:159], v[196:199], v[96:99]
    ds_read_b64_tr_b16 v[178:179], v230 offset:56320
    v_mfma_f32_16x16x32_bf16 v[100:103], v[156:159], v[200:203], v[100:103]
    ds_read_b64_tr_b16 v[180:181], v231 offset:51200
    buffer_load_dwordx4 v251, s[40:43], s79 offen offset:3072 lds
    v_mfma_f32_16x16x32_bf16 v[104:107], v[156:159], v[204:207], v[104:107]
    ds_read_b64_tr_b16 v[182:183], v231 offset:56320
    s_waitcnt lgkmcnt(15)
    v_mfma_f32_16x16x32_bf16 v[108:111], v[160:163], v[188:191], v[108:111]
    ds_read_b64_tr_b16 v[184:185], v232 offset:51200
    v_mfma_f32_16x16x32_bf16 v[112:115], v[160:163], v[192:195], v[112:115]
    ds_read_b64_tr_b16 v[186:187], v232 offset:56320
    s_add_u32 m0, s78, 65536
    v_mfma_f32_16x16x32_bf16 v[116:119], v[160:163], v[196:199], v[116:119]
    v_mfma_f32_16x16x32_bf16 v[120:123], v[160:163], v[200:203], v[120:123]
    v_mfma_f32_16x16x32_bf16 v[124:127], v[160:163], v[204:207], v[124:127]
    buffer_load_dwordx4 v252, s[40:43], s79 offen lds
    s_waitcnt lgkmcnt(15)
    v_mfma_f32_16x16x32_bf16 v[128:131], v[164:167], v[188:191], v[128:131]
    v_mfma_f32_16x16x32_bf16 v[132:135], v[164:167], v[192:195], v[132:135]
    v_mfma_f32_16x16x32_bf16 v[136:139], v[164:167], v[196:199], v[136:139]
    v_mfma_f32_16x16x32_bf16 v[140:143], v[164:167], v[200:203], v[140:143]
    v_mfma_f32_16x16x32_bf16 v[144:147], v[164:167], v[204:207], v[144:147]
    s_waitcnt vmcnt(5) lgkmcnt(0)
    s_barrier
    v_mfma_f32_16x16x32_bf16 v[48:51], v[168:171], v[208:211], v[48:51]
    ds_read_b128 v[188:191], v8
    v_mfma_f32_16x16x32_bf16 v[52:55], v[168:171], v[212:215], v[52:55]
    ds_read_b64_tr_b16 v[148:149], v233 offset:32768
    s_add_u32 m0, s78, 20480
    s_add_u32 s48, s72, 20480
    v_mfma_f32_16x16x32_bf16 v[56:59], v[168:171], v[216:219], v[56:59]
    ds_read_b64_tr_b16 v[150:151], v233 offset:37888
    v_mfma_f32_16x16x32_bf16 v[60:63], v[168:171], v[220:223], v[60:63]
    ds_read_b128 v[192:195], v8 offset:1024
    v_mfma_f32_16x16x32_bf16 v[64:67], v[168:171], v[224:227], v[64:67]
    ds_read_b128 v[196:199], v8 offset:2048
    buffer_load_dwordx4 v253, s[24:27], s48 offen lds
    v_mfma_f32_16x16x32_bf16 v[68:71], v[172:175], v[208:211], v[68:71]
    v_mfma_f32_16x16x32_bf16 v[72:75], v[172:175], v[212:215], v[72:75]
    ds_read_b64_tr_b16 v[152:153], v234 offset:32768
    v_mfma_f32_16x16x32_bf16 v[76:79], v[172:175], v[216:219], v[76:79]
    ds_read_b64_tr_b16 v[154:155], v234 offset:37888
    buffer_load_dwordx4 v253, s[24:27], s48 offen offset:1024 lds
    v_mfma_f32_16x16x32_bf16 v[80:83], v[172:175], v[220:223], v[80:83]
    ds_read_b128 v[200:203], v8 offset:3072
    v_mfma_f32_16x16x32_bf16 v[84:87], v[172:175], v[224:227], v[84:87]
    ds_read_b128 v[204:207], v8 offset:4096
    v_mfma_f32_16x16x32_bf16 v[88:91], v[176:179], v[208:211], v[88:91]
    ds_read_b64_tr_b16 v[156:157], v235 offset:32768
    buffer_load_dwordx4 v253, s[24:27], s48 offen offset:2048 lds
    v_mfma_f32_16x16x32_bf16 v[92:95], v[176:179], v[212:215], v[92:95]
    v_mfma_f32_16x16x32_bf16 v[96:99], v[176:179], v[216:219], v[96:99]
    ds_read_b64_tr_b16 v[158:159], v235 offset:37888
    v_mfma_f32_16x16x32_bf16 v[100:103], v[176:179], v[220:223], v[100:103]
    ds_read_b64_tr_b16 v[160:161], v236 offset:32768
    v_mfma_f32_16x16x32_bf16 v[104:107], v[176:179], v[224:227], v[104:107]
    ds_read_b64_tr_b16 v[162:163], v236 offset:37888
    buffer_load_dwordx4 v253, s[24:27], s48 offen offset:3072 lds
    v_mfma_f32_16x16x32_bf16 v[108:111], v[180:183], v[208:211], v[108:111]
    ds_read_b64_tr_b16 v[164:165], v237 offset:32768
    v_mfma_f32_16x16x32_bf16 v[112:115], v[180:183], v[212:215], v[112:115]
    ds_read_b64_tr_b16 v[166:167], v237 offset:37888
    v_mfma_f32_16x16x32_bf16 v[116:119], v[180:183], v[216:219], v[116:119]
    s_add_u32 m0, s78, 24576
    s_add_u32 s48, s72, 24576
    v_mfma_f32_16x16x32_bf16 v[120:123], v[180:183], v[220:223], v[120:123]
    v_mfma_f32_16x16x32_bf16 v[124:127], v[180:183], v[224:227], v[124:127]
    v_mfma_f32_16x16x32_bf16 v[128:131], v[184:187], v[208:211], v[128:131]
    buffer_load_dwordx4 v253, s[24:27], s48 offen lds
    v_mfma_f32_16x16x32_bf16 v[132:135], v[184:187], v[212:215], v[132:135]
    v_mfma_f32_16x16x32_bf16 v[136:139], v[184:187], v[216:219], v[136:139]
    v_mfma_f32_16x16x32_bf16 v[140:143], v[184:187], v[220:223], v[140:143]
    v_mfma_f32_16x16x32_bf16 v[144:147], v[184:187], v[224:227], v[144:147]
    s_waitcnt lgkmcnt(12)
    v_mfma_f32_16x16x32_bf16 v[48:51], v[148:151], v[188:191], v[48:51]
    ds_read_b128 v[208:211], v8 offset:10240
    s_add_u32 m0, s78, 40960
    s_add_u32 s79, s69, 0
    s_waitcnt lgkmcnt(12)
    v_mfma_f32_16x16x32_bf16 v[52:55], v[148:151], v[192:195], v[52:55]
    ds_read_b64_tr_b16 v[168:169], v233 offset:43008
    s_waitcnt lgkmcnt(12)
    v_mfma_f32_16x16x32_bf16 v[56:59], v[148:151], v[196:199], v[56:59]
    ds_read_b64_tr_b16 v[170:171], v233 offset:48128
    s_waitcnt lgkmcnt(10)
    v_mfma_f32_16x16x32_bf16 v[60:63], v[148:151], v[200:203], v[60:63]
    ds_read_b128 v[212:215], v8 offset:11264
    buffer_load_dwordx4 v248, s[40:43], s79 offen lds
    s_waitcnt lgkmcnt(10)
    v_mfma_f32_16x16x32_bf16 v[64:67], v[148:151], v[204:207], v[64:67]
    ds_read_b128 v[216:219], v8 offset:12288
    v_mfma_f32_16x16x32_bf16 v[68:71], v[152:155], v[188:191], v[68:71]
    v_mfma_f32_16x16x32_bf16 v[72:75], v[152:155], v[192:195], v[72:75]
    ds_read_b64_tr_b16 v[172:173], v234 offset:43008
    buffer_load_dwordx4 v249, s[40:43], s79 offen offset:1024 lds
    v_mfma_f32_16x16x32_bf16 v[76:79], v[152:155], v[196:199], v[76:79]
    ds_read_b64_tr_b16 v[174:175], v234 offset:48128
    v_mfma_f32_16x16x32_bf16 v[80:83], v[152:155], v[200:203], v[80:83]
    ds_read_b128 v[220:223], v8 offset:13312
    v_mfma_f32_16x16x32_bf16 v[84:87], v[152:155], v[204:207], v[84:87]
    ds_read_b128 v[224:227], v8 offset:14336
    buffer_load_dwordx4 v250, s[40:43], s79 offen offset:2048 lds
    s_waitcnt lgkmcnt(13)
    v_mfma_f32_16x16x32_bf16 v[88:91], v[156:159], v[188:191], v[88:91]
    ds_read_b64_tr_b16 v[176:177], v235 offset:43008
    v_mfma_f32_16x16x32_bf16 v[92:95], v[156:159], v[192:195], v[92:95]
    v_mfma_f32_16x16x32_bf16 v[96:99], v[156:159], v[196:199], v[96:99]
    ds_read_b64_tr_b16 v[178:179], v235 offset:48128
    v_mfma_f32_16x16x32_bf16 v[100:103], v[156:159], v[200:203], v[100:103]
    ds_read_b64_tr_b16 v[180:181], v236 offset:43008
    buffer_load_dwordx4 v251, s[40:43], s79 offen offset:3072 lds
    v_mfma_f32_16x16x32_bf16 v[104:107], v[156:159], v[204:207], v[104:107]
    ds_read_b64_tr_b16 v[182:183], v236 offset:48128
    s_waitcnt lgkmcnt(15)
    v_mfma_f32_16x16x32_bf16 v[108:111], v[160:163], v[188:191], v[108:111]
    ds_read_b64_tr_b16 v[184:185], v237 offset:43008
    v_mfma_f32_16x16x32_bf16 v[112:115], v[160:163], v[192:195], v[112:115]
    ds_read_b64_tr_b16 v[186:187], v237 offset:48128
    s_add_u32 m0, s78, 45056
    v_mfma_f32_16x16x32_bf16 v[116:119], v[160:163], v[196:199], v[116:119]
    v_mfma_f32_16x16x32_bf16 v[120:123], v[160:163], v[200:203], v[120:123]
    v_mfma_f32_16x16x32_bf16 v[124:127], v[160:163], v[204:207], v[124:127]
    buffer_load_dwordx4 v252, s[40:43], s79 offen lds
    s_waitcnt lgkmcnt(15)
    v_mfma_f32_16x16x32_bf16 v[128:131], v[164:167], v[188:191], v[128:131]
    v_mfma_f32_16x16x32_bf16 v[132:135], v[164:167], v[192:195], v[132:135]
    v_mfma_f32_16x16x32_bf16 v[136:139], v[164:167], v[196:199], v[136:139]
    v_mfma_f32_16x16x32_bf16 v[140:143], v[164:167], v[200:203], v[140:143]
    v_mfma_f32_16x16x32_bf16 v[144:147], v[164:167], v[204:207], v[144:147]
    s_waitcnt vmcnt(5) lgkmcnt(0)
    s_barrier
    v_mfma_f32_16x16x32_bf16 v[48:51], v[168:171], v[208:211], v[48:51]
    ds_read_b128 v[188:191], v8 offset:20480
    v_mfma_f32_16x16x32_bf16 v[52:55], v[168:171], v[212:215], v[52:55]
    ds_read_b64_tr_b16 v[148:149], v233 offset:12288
    s_add_u32 m0, s78, 0
    s_add_u32 s48, s73, 0
    v_mfma_f32_16x16x32_bf16 v[56:59], v[168:171], v[216:219], v[56:59]
    ds_read_b64_tr_b16 v[150:151], v233 offset:17408
    v_mfma_f32_16x16x32_bf16 v[60:63], v[168:171], v[220:223], v[60:63]
    ds_read_b128 v[192:195], v8 offset:21504
    v_mfma_f32_16x16x32_bf16 v[64:67], v[168:171], v[224:227], v[64:67]
    ds_read_b128 v[196:199], v8 offset:22528
    buffer_load_dwordx4 v253, s[24:27], s48 offen lds
    v_mfma_f32_16x16x32_bf16 v[68:71], v[172:175], v[208:211], v[68:71]
    v_mfma_f32_16x16x32_bf16 v[72:75], v[172:175], v[212:215], v[72:75]
    ds_read_b64_tr_b16 v[152:153], v234 offset:12288
    v_mfma_f32_16x16x32_bf16 v[76:79], v[172:175], v[216:219], v[76:79]
    ds_read_b64_tr_b16 v[154:155], v234 offset:17408
    buffer_load_dwordx4 v253, s[24:27], s48 offen offset:1024 lds
    v_mfma_f32_16x16x32_bf16 v[80:83], v[172:175], v[220:223], v[80:83]
    ds_read_b128 v[200:203], v8 offset:23552
    v_mfma_f32_16x16x32_bf16 v[84:87], v[172:175], v[224:227], v[84:87]
    ds_read_b128 v[204:207], v8 offset:24576
    v_mfma_f32_16x16x32_bf16 v[88:91], v[176:179], v[208:211], v[88:91]
    ds_read_b64_tr_b16 v[156:157], v235 offset:12288
    buffer_load_dwordx4 v253, s[24:27], s48 offen offset:2048 lds
    v_and_b32 v28, 3, v0
    v_mfma_f32_16x16x32_bf16 v[92:95], v[176:179], v[212:215], v[92:95]
    v_mfma_f32_16x16x32_bf16 v[96:99], v[176:179], v[216:219], v[96:99]
    ds_read_b64_tr_b16 v[158:159], v235 offset:17408
    v_lshlrev_b32 v28, 2, v28
    v_mfma_f32_16x16x32_bf16 v[100:103], v[176:179], v[220:223], v[100:103]
    ds_read_b64_tr_b16 v[160:161], v236 offset:12288
    v_mfma_f32_16x16x32_bf16 v[104:107], v[176:179], v[224:227], v[104:107]
    ds_read_b64_tr_b16 v[162:163], v236 offset:17408
    buffer_load_dwordx4 v253, s[24:27], s48 offen offset:3072 lds
    v_mfma_f32_16x16x32_bf16 v[108:111], v[180:183], v[208:211], v[108:111]
    ds_read_b64_tr_b16 v[164:165], v237 offset:12288
    v_add_u32 v28, 16, v28
    v_mfma_f32_16x16x32_bf16 v[112:115], v[180:183], v[212:215], v[112:115]
    ds_read_b64_tr_b16 v[166:167], v237 offset:17408
    v_mfma_f32_16x16x32_bf16 v[116:119], v[180:183], v[216:219], v[116:119]
    s_add_u32 m0, s78, 4096
    s_add_u32 s48, s73, 4096
    v_mfma_f32_16x16x32_bf16 v[120:123], v[180:183], v[220:223], v[120:123]
    buffer_load_dword v27, v28, s[24:27], s76 offen sc1
    v_mfma_f32_16x16x32_bf16 v[124:127], v[180:183], v[224:227], v[124:127]
    v_mfma_f32_16x16x32_bf16 v[128:131], v[184:187], v[208:211], v[128:131]
    buffer_load_dwordx4 v253, s[24:27], s48 offen lds
    v_mfma_f32_16x16x32_bf16 v[132:135], v[184:187], v[212:215], v[132:135]
    v_mfma_f32_16x16x32_bf16 v[136:139], v[184:187], v[216:219], v[136:139]
    v_mfma_f32_16x16x32_bf16 v[140:143], v[184:187], v[220:223], v[140:143]
    v_mfma_f32_16x16x32_bf16 v[144:147], v[184:187], v[224:227], v[144:147]
    s_waitcnt lgkmcnt(12)
    v_mfma_f32_16x16x32_bf16 v[48:51], v[148:151], v[188:191], v[48:51]
    ds_read_b128 v[208:211], v8 offset:30720
    s_add_u32 m0, s78, 81920
    s_add_u32 s79, s69, 81920
    s_waitcnt lgkmcnt(12)
    v_mfma_f32_16x16x32_bf16 v[52:55], v[148:151], v[192:195], v[52:55]
    ds_read_b64_tr_b16 v[168:169], v233 offset:22528
    s_waitcnt lgkmcnt(12)
    v_mfma_f32_16x16x32_bf16 v[56:59], v[148:151], v[196:199], v[56:59]
    ds_read_b64_tr_b16 v[170:171], v233 offset:27648
    s_waitcnt lgkmcnt(10)
    v_mfma_f32_16x16x32_bf16 v[60:63], v[148:151], v[200:203], v[60:63]
    ds_read_b128 v[212:215], v8 offset:31744
    buffer_load_dwordx4 v248, s[40:43], s79 offen lds
    s_waitcnt lgkmcnt(10)
    v_mfma_f32_16x16x32_bf16 v[64:67], v[148:151], v[204:207], v[64:67]
    ds_read_b128 v[216:219], v8 offset:32768
    v_mfma_f32_16x16x32_bf16 v[68:71], v[152:155], v[188:191], v[68:71]
    v_mfma_f32_16x16x32_bf16 v[72:75], v[152:155], v[192:195], v[72:75]
    ds_read_b64_tr_b16 v[172:173], v234 offset:22528
    buffer_load_dwordx4 v249, s[40:43], s79 offen offset:1024 lds
    v_mfma_f32_16x16x32_bf16 v[76:79], v[152:155], v[196:199], v[76:79]
    ds_read_b64_tr_b16 v[174:175], v234 offset:27648
    v_mfma_f32_16x16x32_bf16 v[80:83], v[152:155], v[200:203], v[80:83]
    ds_read_b128 v[220:223], v8 offset:33792
    v_mfma_f32_16x16x32_bf16 v[84:87], v[152:155], v[204:207], v[84:87]
    ds_read_b128 v[224:227], v8 offset:34816
    buffer_load_dwordx4 v250, s[40:43], s79 offen offset:2048 lds
    s_waitcnt lgkmcnt(13)
    v_mfma_f32_16x16x32_bf16 v[88:91], v[156:159], v[188:191], v[88:91]
    ds_read_b64_tr_b16 v[176:177], v235 offset:22528
    v_mfma_f32_16x16x32_bf16 v[92:95], v[156:159], v[192:195], v[92:95]
    v_mfma_f32_16x16x32_bf16 v[96:99], v[156:159], v[196:199], v[96:99]
    ds_read_b64_tr_b16 v[178:179], v235 offset:27648
    v_mfma_f32_16x16x32_bf16 v[100:103], v[156:159], v[200:203], v[100:103]
    ds_read_b64_tr_b16 v[180:181], v236 offset:22528
    buffer_load_dwordx4 v251, s[40:43], s79 offen offset:3072 lds
    v_mfma_f32_16x16x32_bf16 v[104:107], v[156:159], v[204:207], v[104:107]
    ds_read_b64_tr_b16 v[182:183], v236 offset:27648
    s_waitcnt lgkmcnt(15)
    v_mfma_f32_16x16x32_bf16 v[108:111], v[160:163], v[188:191], v[108:111]
    ds_read_b64_tr_b16 v[184:185], v237 offset:22528
    v_mfma_f32_16x16x32_bf16 v[112:115], v[160:163], v[192:195], v[112:115]
    ds_read_b64_tr_b16 v[186:187], v237 offset:27648
    s_add_u32 m0, s78, 86016
    v_mfma_f32_16x16x32_bf16 v[116:119], v[160:163], v[196:199], v[116:119]
    v_mfma_f32_16x16x32_bf16 v[120:123], v[160:163], v[200:203], v[120:123]
    v_mfma_f32_16x16x32_bf16 v[124:127], v[160:163], v[204:207], v[124:127]
    buffer_load_dwordx4 v252, s[40:43], s79 offen lds
    s_waitcnt lgkmcnt(15)
    v_mfma_f32_16x16x32_bf16 v[128:131], v[164:167], v[188:191], v[128:131]
    v_mfma_f32_16x16x32_bf16 v[132:135], v[164:167], v[192:195], v[132:135]
    v_mfma_f32_16x16x32_bf16 v[136:139], v[164:167], v[196:199], v[136:139]
    v_mfma_f32_16x16x32_bf16 v[140:143], v[164:167], v[200:203], v[140:143]
    v_mfma_f32_16x16x32_bf16 v[144:147], v[164:167], v[204:207], v[144:147]
    s_waitcnt vmcnt(5) lgkmcnt(0)
    s_mov_b32 s39, 200000
L_P1B_L:
    v_cmp_eq_u32 vcc, 1, v27
    s_nop 4
    s_cmp_eq_u64 vcc, -1
    s_cbranch_scc1 L_P1B_D
    s_sub_u32 s39, s39, 1
    s_cmp_eq_u32 s39, 0
    s_cbranch_scc1 L_P1B_D
    buffer_load_dword v27, v28, s[24:27], s76 offen sc1
    s_waitcnt vmcnt(0)
    s_branch L_P1B_L
L_P1B_D:
    s_barrier
    v_mfma_f32_16x16x32_bf16 v[48:51], v[168:171], v[208:211], v[48:51]
    ds_read_b128 v[188:191], v8
    v_mfma_f32_16x16x32_bf16 v[52:55], v[168:171], v[212:215], v[52:55]
    ds_read_b64_tr_b16 v[148:149], v228 offset:40960
    s_add_u32 m0, s78, 20480
    s_add_u32 s48, s73, 20480
    v_mfma_f32_16x16x32_bf16 v[56:59], v[168:171], v[216:219], v[56:59]
    ds_read_b64_tr_b16 v[150:151], v228 offset:46080
    v_mfma_f32_16x16x32_bf16 v[60:63], v[168:171], v[220:223], v[60:63]
    ds_read_b128 v[192:195], v8 offset:1024
    v_mfma_f32_16x16x32_bf16 v[64:67], v[168:171], v[224:227], v[64:67]
    ds_read_b128 v[196:199], v8 offset:2048
    buffer_load_dwordx4 v253, s[24:27], s48 offen lds
    v_mfma_f32_16x16x32_bf16 v[68:71], v[172:175], v[208:211], v[68:71]
    v_mfma_f32_16x16x32_bf16 v[72:75], v[172:175], v[212:215], v[72:75]
    ds_read_b64_tr_b16 v[152:153], v229 offset:40960
    v_mfma_f32_16x16x32_bf16 v[76:79], v[172:175], v[216:219], v[76:79]
    ds_read_b64_tr_b16 v[154:155], v229 offset:46080
    buffer_load_dwordx4 v253, s[24:27], s48 offen offset:1024 lds
    v_mfma_f32_16x16x32_bf16 v[80:83], v[172:175], v[220:223], v[80:83]
    ds_read_b128 v[200:203], v8 offset:3072
    v_mfma_f32_16x16x32_bf16 v[84:87], v[172:175], v[224:227], v[84:87]
    ds_read_b128 v[204:207], v8 offset:4096
    v_mfma_f32_16x16x32_bf16 v[88:91], v[176:179], v[208:211], v[88:91]
    ds_read_b64_tr_b16 v[156:157], v230 offset:40960
    buffer_load_dwordx4 v253, s[24:27], s48 offen offset:2048 lds
    v_mfma_f32_16x16x32_bf16 v[92:95], v[176:179], v[212:215], v[92:95]
    v_mfma_f32_16x16x32_bf16 v[96:99], v[176:179], v[216:219], v[96:99]
    ds_read_b64_tr_b16 v[158:159], v230 offset:46080
    v_mfma_f32_16x16x32_bf16 v[100:103], v[176:179], v[220:223], v[100:103]
    ds_read_b64_tr_b16 v[160:161], v231 offset:40960
    v_mfma_f32_16x16x32_bf16 v[104:107], v[176:179], v[224:227], v[104:107]
    ds_read_b64_tr_b16 v[162:163], v231 offset:46080
    buffer_load_dwordx4 v253, s[24:27], s48 offen offset:3072 lds
    v_mfma_f32_16x16x32_bf16 v[108:111], v[180:183], v[208:211], v[108:111]
    ds_read_b64_tr_b16 v[164:165], v232 offset:40960
    v_mfma_f32_16x16x32_bf16 v[112:115], v[180:183], v[212:215], v[112:115]
    ds_read_b64_tr_b16 v[166:167], v232 offset:46080
    v_mfma_f32_16x16x32_bf16 v[116:119], v[180:183], v[216:219], v[116:119]
    s_add_u32 m0, s78, 24576
    s_add_u32 s48, s73, 24576
    v_mfma_f32_16x16x32_bf16 v[120:123], v[180:183], v[220:223], v[120:123]
    v_mfma_f32_16x16x32_bf16 v[124:127], v[180:183], v[224:227], v[124:127]
    v_mfma_f32_16x16x32_bf16 v[128:131], v[184:187], v[208:211], v[128:131]
    buffer_load_dwordx4 v253, s[24:27], s48 offen lds
    v_mfma_f32_16x16x32_bf16 v[132:135], v[184:187], v[212:215], v[132:135]
    v_mfma_f32_16x16x32_bf16 v[136:139], v[184:187], v[216:219], v[136:139]
    v_mfma_f32_16x16x32_bf16 v[140:143], v[184:187], v[220:223], v[140:143]
    v_mfma_f32_16x16x32_bf16 v[144:147], v[184:187], v[224:227], v[144:147]
    s_waitcnt lgkmcnt(12)
    v_mfma_f32_16x16x32_bf16 v[48:51], v[148:151], v[188:191], v[48:51]
    ds_read_b128 v[208:211], v8 offset:10240
    s_add_u32 m0, s78, 61440
    s_add_u32 s79, s67, 163840
    s_waitcnt lgkmcnt(12)
    v_mfma_f32_16x16x32_bf16 v[52:55], v[148:151], v[192:195], v[52:55]
    ds_read_b64_tr_b16 v[168:169], v228 offset:51200
    s_waitcnt lgkmcnt(12)
    v_mfma_f32_16x16x32_bf16 v[56:59], v[148:151], v[196:199], v[56:59]
    ds_read_b64_tr_b16 v[170:171], v228 offset:56320
    s_waitcnt lgkmcnt(10)
    v_mfma_f32_16x16x32_bf16 v[60:63], v[148:151], v[200:203], v[60:63]
    ds_read_b128 v[212:215], v8 offset:11264
    buffer_load_dwordx4 v248, s[40:43], s79 offen lds
    s_waitcnt lgkmcnt(10)
    v_mfma_f32_16x16x32_bf16 v[64:67], v[148:151], v[204:207], v[64:67]
    ds_read_b128 v[216:219], v8 offset:12288
    v_mfma_f32_16x16x32_bf16 v[68:71], v[152:155], v[188:191], v[68:71]
    v_mfma_f32_16x16x32_bf16 v[72:75], v[152:155], v[192:195], v[72:75]
    ds_read_b64_tr_b16 v[172:173], v229 offset:51200
    buffer_load_dwordx4 v249, s[40:43], s79 offen offset:1024 lds
    v_mfma_f32_16x16x32_bf16 v[76:79], v[152:155], v[196:199], v[76:79]
    ds_read_b64_tr_b16 v[174:175], v229 offset:56320
    v_mfma_f32_16x16x32_bf16 v[80:83], v[152:155], v[200:203], v[80:83]
    ds_read_b128 v[220:223], v8 offset:13312
    v_mfma_f32_16x16x32_bf16 v[84:87], v[152:155], v[204:207], v[84:87]
    ds_read_b128 v[224:227], v8 offset:14336
    buffer_load_dwordx4 v250, s[40:43], s79 offen offset:2048 lds
    s_waitcnt lgkmcnt(13)
    v_mfma_f32_16x16x32_bf16 v[88:91], v[156:159], v[188:191], v[88:91]
    ds_read_b64_tr_b16 v[176:177], v230 offset:51200
    v_mfma_f32_16x16x32_bf16 v[92:95], v[156:159], v[192:195], v[92:95]
    v_mfma_f32_16x16x32_bf16 v[96:99], v[156:159], v[196:199], v[96:99]
    ds_read_b64_tr_b16 v[178:179], v230 offset:56320
    v_mfma_f32_16x16x32_bf16 v[100:103], v[156:159], v[200:203], v[100:103]
    ds_read_b64_tr_b16 v[180:181], v231 offset:51200
    buffer_load_dwordx4 v251, s[40:43], s79 offen offset:3072 lds
    v_mfma_f32_16x16x32_bf16 v[104:107], v[156:159], v[204:207], v[104:107]
    ds_read_b64_tr_b16 v[182:183], v231 offset:56320
    s_waitcnt lgkmcnt(15)
    v_mfma_f32_16x16x32_bf16 v[108:111], v[160:163], v[188:191], v[108:111]
    ds_read_b64_tr_b16 v[184:185], v232 offset:51200
    v_mfma_f32_16x16x32_bf16 v[112:115], v[160:163], v[192:195], v[112:115]
    ds_read_b64_tr_b16 v[186:187], v232 offset:56320
    s_add_u32 m0, s78, 65536
    v_mfma_f32_16x16x32_bf16 v[116:119], v[160:163], v[196:199], v[116:119]
    v_mfma_f32_16x16x32_bf16 v[120:123], v[160:163], v[200:203], v[120:123]
    v_mfma_f32_16x16x32_bf16 v[124:127], v[160:163], v[204:207], v[124:127]
    buffer_load_dwordx4 v252, s[40:43], s79 offen lds
    s_waitcnt lgkmcnt(15)
    v_mfma_f32_16x16x32_bf16 v[128:131], v[164:167], v[188:191], v[128:131]
    v_mfma_f32_16x16x32_bf16 v[132:135], v[164:167], v[192:195], v[132:135]
    v_mfma_f32_16x16x32_bf16 v[136:139], v[164:167], v[196:199], v[136:139]
    v_mfma_f32_16x16x32_bf16 v[140:143], v[164:167], v[200:203], v[140:143]
    v_mfma_f32_16x16x32_bf16 v[144:147], v[164:167], v[204:207], v[144:147]
    s_waitcnt vmcnt(5) lgkmcnt(0)
    s_barrier
    v_mfma_f32_16x16x32_bf16 v[48:51], v[168:171], v[208:211], v[48:51]
    ds_read_b128 v[188:191], v8 offset:20480
    v_mfma_f32_16x16x32_bf16 v[52:55], v[168:171], v[212:215], v[52:55]
    ds_read_b64_tr_b16 v[148:149], v233 offset:32768
    s_add_u32 m0, s78, 0
    s_add_u32 s48, s71, 40960
    v_mfma_f32_16x16x32_bf16 v[56:59], v[168:171], v[216:219], v[56:59]
    ds_read_b64_tr_b16 v[150:151], v233 offset:37888
    v_mfma_f32_16x16x32_bf16 v[60:63], v[168:171], v[220:223], v[60:63]
    ds_read_b128 v[192:195], v8 offset:21504
    v_mfma_f32_16x16x32_bf16 v[64:67], v[168:171], v[224:227], v[64:67]
    ds_read_b128 v[196:199], v8 offset:22528
    buffer_load_dwordx4 v253, s[24:27], s48 offen lds
    v_mfma_f32_16x16x32_bf16 v[68:71], v[172:175], v[208:211], v[68:71]
    v_mfma_f32_16x16x32_bf16 v[72:75], v[172:175], v[212:215], v[72:75]
    ds_read_b64_tr_b16 v[152:153], v234 offset:32768
    v_mfma_f32_16x16x32_bf16 v[76:79], v[172:175], v[216:219], v[76:79]
    ds_read_b64_tr_b16 v[154:155], v234 offset:37888
    buffer_load_dwordx4 v253, s[24:27], s48 offen offset:1024 lds
    v_mfma_f32_16x16x32_bf16 v[80:83], v[172:175], v[220:223], v[80:83]
    ds_read_b128 v[200:203], v8 offset:23552
    v_mfma_f32_16x16x32_bf16 v[84:87], v[172:175], v[224:227], v[84:87]
    ds_read_b128 v[204:207], v8 offset:24576
    v_mfma_f32_16x16x32_bf16 v[88:91], v[176:179], v[208:211], v[88:91]
    ds_read_b64_tr_b16 v[156:157], v235 offset:32768
    buffer_load_dwordx4 v253, s[24:27], s48 offen offset:2048 lds
    v_mfma_f32_16x16x32_bf16 v[92:95], v[176:179], v[212:215], v[92:95]
    v_mfma_f32_16x16x32_bf16 v[96:99], v[176:179], v[216:219], v[96:99]
    ds_read_b64_tr_b16 v[158:159], v235 offset:37888
    v_mfma_f32_16x16x32_bf16 v[100:103], v[176:179], v[220:223], v[100:103]
    ds_read_b64_tr_b16 v[160:161], v236 offset:32768
    v_mfma_f32_16x16x32_bf16 v[104:107], v[176:179], v[224:227], v[104:107]
    ds_read_b64_tr_b16 v[162:163], v236 offset:37888
    buffer_load_dwordx4 v253, s[24:27], s48 offen offset:3072 lds
    v_mfma_f32_16x16x32_bf16 v[108:111], v[180:183], v[208:211], v[108:111]
    ds_read_b64_tr_b16 v[164:165], v237 offset:32768
    v_mfma_f32_16x16x32_bf16 v[112:115], v[180:183], v[212:215], v[112:115]
    ds_read_b64_tr_b16 v[166:167], v237 offset:37888
    v_mfma_f32_16x16x32_bf16 v[116:119], v[180:183], v[216:219], v[116:119]
    s_add_u32 m0, s78, 4096
    s_add_u32 s48, s71, 45056
    v_mfma_f32_16x16x32_bf16 v[120:123], v[180:183], v[220:223], v[120:123]
    v_mfma_f32_16x16x32_bf16 v[124:127], v[180:183], v[224:227], v[124:127]
    v_mfma_f32_16x16x32_bf16 v[128:131], v[184:187], v[208:211], v[128:131]
    buffer_load_dwordx4 v253, s[24:27], s48 offen lds
    v_mfma_f32_16x16x32_bf16 v[132:135], v[184:187], v[212:215], v[132:135]
    v_mfma_f32_16x16x32_bf16 v[136:139], v[184:187], v[216:219], v[136:139]
    v_mfma_f32_16x16x32_bf16 v[140:143], v[184:187], v[220:223], v[140:143]
    v_mfma_f32_16x16x32_bf16 v[144:147], v[184:187], v[224:227], v[144:147]
    s_waitcnt lgkmcnt(12)
    v_mfma_f32_16x16x32_bf16 v[48:51], v[148:151], v[188:191], v[48:51]
    ds_read_b128 v[208:211], v8 offset:30720
    s_add_u32 m0, s78, 40960
    s_add_u32 s79, s68, 163840
    s_waitcnt lgkmcnt(12)
    v_mfma_f32_16x16x32_bf16 v[52:55], v[148:151], v[192:195], v[52:55]
    ds_read_b64_tr_b16 v[168:169], v233 offset:43008
    s_waitcnt lgkmcnt(12)
    v_mfma_f32_16x16x32_bf16 v[56:59], v[148:151], v[196:199], v[56:59]
    ds_read_b64_tr_b16 v[170:171], v233 offset:48128
    s_waitcnt lgkmcnt(10)
    v_mfma_f32_16x16x32_bf16 v[60:63], v[148:151], v[200:203], v[60:63]
    ds_read_b128 v[212:215], v8 offset:31744
    buffer_load_dwordx4 v248, s[40:43], s79 offen lds
    s_waitcnt lgkmcnt(10)
    v_mfma_f32_16x16x32_bf16 v[64:67], v[148:151], v[204:207], v[64:67]
    ds_read_b128 v[216:219], v8 offset:32768
    v_mfma_f32_16x16x32_bf16 v[68:71], v[152:155], v[188:191], v[68:71]
    v_mfma_f32_16x16x32_bf16 v[72:75], v[152:155], v[192:195], v[72:75]
    ds_read_b64_tr_b16 v[172:173], v234 offset:43008
    buffer_load_dwordx4 v249, s[40:43], s79 offen offset:1024 lds
    v_mfma_f32_16x16x32_bf16 v[76:79], v[152:155], v[196:199], v[76:79]
    ds_read_b64_tr_b16 v[174:175], v234 offset:48128
    v_mfma_f32_16x16x32_bf16 v[80:83], v[152:155], v[200:203], v[80:83]
    ds_read_b128 v[220:223], v8 offset:33792
    v_mfma_f32_16x16x32_bf16 v[84:87], v[152:155], v[204:207], v[84:87]
    ds_read_b128 v[224:227], v8 offset:34816
    buffer_load_dwordx4 v250, s[40:43], s79 offen offset:2048 lds
    s_waitcnt lgkmcnt(13)
    v_mfma_f32_16x16x32_bf16 v[88:91], v[156:159], v[188:191], v[88:91]
    ds_read_b64_tr_b16 v[176:177], v235 offset:43008
    v_mfma_f32_16x16x32_bf16 v[92:95], v[156:159], v[192:195], v[92:95]
    v_mfma_f32_16x16x32_bf16 v[96:99], v[156:159], v[196:199], v[96:99]
    ds_read_b64_tr_b16 v[178:179], v235 offset:48128
    v_mfma_f32_16x16x32_bf16 v[100:103], v[156:159], v[200:203], v[100:103]
    ds_read_b64_tr_b16 v[180:181], v236 offset:43008
    buffer_load_dwordx4 v251, s[40:43], s79 offen offset:3072 lds
    v_mfma_f32_16x16x32_bf16 v[104:107], v[156:159], v[204:207], v[104:107]
    ds_read_b64_tr_b16 v[182:183], v236 offset:48128
    s_waitcnt lgkmcnt(15)
    v_mfma_f32_16x16x32_bf16 v[108:111], v[160:163], v[188:191], v[108:111]
    ds_read_b64_tr_b16 v[184:185], v237 offset:43008
    v_mfma_f32_16x16x32_bf16 v[112:115], v[160:163], v[192:195], v[112:115]
    ds_read_b64_tr_b16 v[186:187], v237 offset:48128
    s_add_u32 m0, s78, 45056
    v_mfma_f32_16x16x32_bf16 v[116:119], v[160:163], v[196:199], v[116:119]
    v_mfma_f32_16x16x32_bf16 v[120:123], v[160:163], v[200:203], v[120:123]
    v_mfma_f32_16x16x32_bf16 v[124:127], v[160:163], v[204:207], v[124:127]
    buffer_load_dwordx4 v252, s[40:43], s79 offen lds
    s_waitcnt lgkmcnt(15)
    v_mfma_f32_16x16x32_bf16 v[128:131], v[164:167], v[188:191], v[128:131]
    v_mfma_f32_16x16x32_bf16 v[132:135], v[164:167], v[192:195], v[132:135]
    v_mfma_f32_16x16x32_bf16 v[136:139], v[164:167], v[196:199], v[136:139]
    v_mfma_f32_16x16x32_bf16 v[140:143], v[164:167], v[200:203], v[140:143]
    v_mfma_f32_16x16x32_bf16 v[144:147], v[164:167], v[204:207], v[144:147]
    s_waitcnt vmcnt(5) lgkmcnt(0)
    s_barrier
    v_mfma_f32_16x16x32_bf16 v[48:51], v[168:171], v[208:211], v[48:51]
    ds_read_b128 v[188:191], v8
    v_mfma_f32_16x16x32_bf16 v[52:55], v[168:171], v[212:215], v[52:55]
    ds_read_b64_tr_b16 v[148:149], v233 offset:12288
    s_add_u32 m0, s78, 20480
    s_add_u32 s48, s72, 40960
    v_mfma_f32_16x16x32_bf16 v[56:59], v[168:171], v[216:219], v[56:59]
    ds_read_b64_tr_b16 v[150:151], v233 offset:17408
    v_mfma_f32_16x16x32_bf16 v[60:63], v[168:171], v[220:223], v[60:63]
    ds_read_b128 v[192:195], v8 offset:1024
    v_mfma_f32_16x16x32_bf16 v[64:67], v[168:171], v[224:227], v[64:67]
    ds_read_b128 v[196:199], v8 offset:2048
    buffer_load_dwordx4 v253, s[24:27], s48 offen lds
    v_mfma_f32_16x16x32_bf16 v[68:71], v[172:175], v[208:211], v[68:71]
    v_mfma_f32_16x16x32_bf16 v[72:75], v[172:175], v[212:215], v[72:75]
    ds_read_b64_tr_b16 v[152:153], v234 offset:12288
    v_mfma_f32_16x16x32_bf16 v[76:79], v[172:175], v[216:219], v[76:79]
    ds_read_b64_tr_b16 v[154:155], v234 offset:17408
    buffer_load_dwordx4 v253, s[24:27], s48 offen offset:1024 lds
    v_mfma_f32_16x16x32_bf16 v[80:83], v[172:175], v[220:223], v[80:83]
    ds_read_b128 v[200:203], v8 offset:3072
    v_mfma_f32_16x16x32_bf16 v[84:87], v[172:175], v[224:227], v[84:87]
    ds_read_b128 v[204:207], v8 offset:4096
    v_mfma_f32_16x16x32_bf16 v[88:91], v[176:179], v[208:211], v[88:91]
    ds_read_b64_tr_b16 v[156:157], v235 offset:12288
    buffer_load_dwordx4 v253, s[24:27], s48 offen offset:2048 lds
    v_mfma_f32_16x16x32_bf16 v[92:95], v[176:179], v[212:215], v[92:95]
    v_mfma_f32_16x16x32_bf16 v[96:99], v[176:179], v[216:219], v[96:99]
    ds_read_b64_tr_b16 v[158:159], v235 offset:17408
    v_mfma_f32_16x16x32_bf16 v[100:103], v[176:179], v[220:223], v[100:103]
    ds_read_b64_tr_b16 v[160:161], v236 offset:12288
    v_mfma_f32_16x16x32_bf16 v[104:107], v[176:179], v[224:227], v[104:107]
    ds_read_b64_tr_b16 v[162:163], v236 offset:17408
    buffer_load_dwordx4 v253, s[24:27], s48 offen offset:3072 lds
    v_mfma_f32_16x16x32_bf16 v[108:111], v[180:183], v[208:211], v[108:111]
    ds_read_b64_tr_b16 v[164:165], v237 offset:12288
    v_mfma_f32_16x16x32_bf16 v[112:115], v[180:183], v[212:215], v[112:115]
    ds_read_b64_tr_b16 v[166:167], v237 offset:17408
    v_mfma_f32_16x16x32_bf16 v[116:119], v[180:183], v[216:219], v[116:119]
    s_add_u32 m0, s78, 24576
    s_add_u32 s48, s72, 45056
    v_mfma_f32_16x16x32_bf16 v[120:123], v[180:183], v[220:223], v[120:123]
    v_mfma_f32_16x16x32_bf16 v[124:127], v[180:183], v[224:227], v[124:127]
    v_mfma_f32_16x16x32_bf16 v[128:131], v[184:187], v[208:211], v[128:131]
    buffer_load_dwordx4 v253, s[24:27], s48 offen lds
    v_mfma_f32_16x16x32_bf16 v[132:135], v[184:187], v[212:215], v[132:135]
    v_mfma_f32_16x16x32_bf16 v[136:139], v[184:187], v[216:219], v[136:139]
    v_mfma_f32_16x16x32_bf16 v[140:143], v[184:187], v[220:223], v[140:143]
    v_mfma_f32_16x16x32_bf16 v[144:147], v[184:187], v[224:227], v[144:147]
    s_waitcnt lgkmcnt(12)
    v_mfma_f32_16x16x32_bf16 v[48:51], v[148:151], v[188:191], v[48:51]
    ds_read_b128 v[208:211], v8 offset:10240
    s_add_u32 m0, s78, 81920
    s_add_u32 s79, s69, 163840
    v_and_b32 v1, 15, v0
    v_lshrrev_b32 v2, 4, v0
    v_lshrrev_b32 v3, 1, v1
    s_waitcnt lgkmcnt(12)
    v_mfma_f32_16x16x32_bf16 v[52:55], v[148:151], v[192:195], v[52:55]
    ds_read_b64_tr_b16 v[168:169], v233 offset:22528
    v_mul_u32_u24 v3, 0xd080, v3
    v_and_b32 v4, 1, v1
    s_waitcnt lgkmcnt(12)
    v_mfma_f32_16x16x32_bf16 v[56:59], v[148:151], v[196:199], v[56:59]
    ds_read_b64_tr_b16 v[170:171], v233 offset:27648
    v_lshl_add_u32 v3, v4, 6, v3
    v_lshl_add_u32 v3, v2, 4, v3
    s_waitcnt lgkmcnt(10)
    v_mfma_f32_16x16x32_bf16 v[60:63], v[148:151], v[200:203], v[60:63]
    ds_read_b128 v[212:215], v8 offset:11264
    buffer_load_dwordx4 v248, s[40:43], s79 offen lds
    s_lshl_b32 s98, s29, 2
    s_add_u32 s98, s98, s75
    s_mul_i32 s98, s98, 427008
    s_waitcnt lgkmcnt(10)
    v_mfma_f32_16x16x32_bf16 v[64:67], v[148:151], v[204:207], v[64:67]
    ds_read_b128 v[216:219], v8 offset:12288
    s_add_u32 s98, s98, 16777216
    s_mul_i32 s99, s28, 1664
    v_mfma_f32_16x16x32_bf16 v[68:71], v[152:155], v[188:191], v[68:71]
    s_add_u32 s98, s98, s99
    s_mul_i32 s99, s74, 53376
    v_mfma_f32_16x16x32_bf16 v[72:75], v[152:155], v[192:195], v[72:75]
    ds_read_b64_tr_b16 v[172:173], v234 offset:22528
    buffer_load_dwordx4 v249, s[40:43], s79 offen offset:1024 lds
    s_add_u32 s100, s98, s99
    s_mul_i32 s99, s74, 6656
    s_add_u32 s98, s98, s99
    v_mfma_f32_16x16x32_bf16 v[76:79], v[152:155], v[196:199], v[76:79]
    ds_read_b64_tr_b16 v[174:175], v234 offset:27648
    v_add_u32 v12, s98, v3
    v_lshlrev_b32 v13, 4, v0
    v_mfma_f32_16x16x32_bf16 v[80:83], v[152:155], v[200:203], v[80:83]
    ds_read_b128 v[220:223], v8 offset:13312
    v_cmp_gt_u32 vcc, 40, v0
    v_mov_b32 v42, 0x7ffffff0
    v_add_u32 v43, 0x400, v13
    v_cndmask_b32 v18, v42, v43, vcc
    s_mul_i32 s49, s29, 160
    v_mfma_f32_16x16x32_bf16 v[84:87], v[152:155], v[204:207], v[84:87]
    ds_read_b128 v[224:227], v8 offset:14336
    buffer_load_dwordx4 v250, s[40:43], s79 offen offset:2048 lds
    s_mul_i32 s31, s96, 80
    s_add_u32 s49, s49, s31
    s_lshl_b32 s31, s74, 1
    s_waitcnt lgkmcnt(13)
    v_mfma_f32_16x16x32_bf16 v[88:91], v[156:159], v[188:191], v[88:91]
    ds_read_b64_tr_b16 v[176:177], v235 offset:22528
    s_add_u32 s49, s49, s31
    s_mul_i32 s49, s49, 1280
    v_mfma_f32_16x16x32_bf16 v[92:95], v[156:159], v[192:195], v[92:95]
    s_mul_i32 s31, s75, 320
    s_mul_i32 s99, s97, 160
    v_mfma_f32_16x16x32_bf16 v[96:99], v[156:159], v[196:199], v[96:99]
    ds_read_b64_tr_b16 v[178:179], v235 offset:27648
    s_add_u32 s31, s31, s99
    s_add_u32 s50, s49, s31
    v_add_u32 v21, 0, v0
    v_mfma_f32_16x16x32_bf16 v[100:103], v[156:159], v[200:203], v[100:103]
    ds_read_b64_tr_b16 v[180:181], v236 offset:22528
    buffer_load_dwordx4 v251, s[40:43], s79 offen offset:3072 lds
    v_lshrrev_b32 v22, 3, v21
    v_lshl_add_u32 v23, v22, 1, 0
    v_mfma_f32_16x16x32_bf16 v[104:107], v[156:159], v[204:207], v[104:107]
    ds_read_b64_tr_b16 v[182:183], v236 offset:27648
    v_mul_u32_u24 v24, 52, v23
    v_lshrrev_b32 v24, 8, v24
    s_waitcnt lgkmcnt(15)
    v_mfma_f32_16x16x32_bf16 v[108:111], v[160:163], v[188:191], v[108:111]
    ds_read_b64_tr_b16 v[184:185], v237 offset:22528
    v_mul_u32_u24 v26, 5, v24
    v_sub_u32 v25, v23, v26
    v_lshlrev_b32 v19, 4, v25
    v_mfma_f32_16x16x32_bf16 v[112:115], v[160:163], v[192:195], v[112:115]
    ds_read_b64_tr_b16 v[186:187], v237 offset:27648
    s_add_u32 m0, s78, 86016
    v_bfe_u32 v26, v21, 2, 1
    v_add_u32 v19, v19, v26
    v_mfma_f32_16x16x32_bf16 v[116:119], v[160:163], v[196:199], v[116:119]
    v_mul_u32_u24 v19, 0x500, v19
    v_lshlrev_b32 v20, 5, v24
    v_mfma_f32_16x16x32_bf16 v[120:123], v[160:163], v[200:203], v[120:123]
    v_and_b32 v26, 3, v21
    v_lshl_add_u32 v20, v26, 3, v20
    v_add_u32 v19, v19, v20
    v_mfma_f32_16x16x32_bf16 v[124:127], v[160:163], v[204:207], v[124:127]
    buffer_load_dwordx4 v252, s[40:43], s79 offen lds
    v_add_u32 v19, s50, v19
    s_mul_i32 s99, s96, 10
    s_waitcnt lgkmcnt(15)
    v_mfma_f32_16x16x32_bf16 v[128:131], v[164:167], v[188:191], v[128:131]
    v_lshlrev_b32 v38, 1, v25
    v_add_u32 v38, s99, v38
    v_mfma_f32_16x16x32_bf16 v[132:135], v[164:167], v[192:195], v[132:135]
    v_bfe_u32 v39, v21, 2, 1
    v_add_u32 v38, v38, v39
    v_mul_u32_u24 v38, 0x140, v38
    v_mfma_f32_16x16x32_bf16 v[136:139], v[164:167], v[196:199], v[136:139]
    s_mul_i32 s99, s97, 160
    v_add_u32 v38, s99, v38
    v_mfma_f32_16x16x32_bf16 v[140:143], v[164:167], v[200:203], v[140:143]
    v_add_u32 v38, v38, v20
    v_cmp_gt_u32 vcc, 25, v23
    v_mov_b32 v39, 0x4000
    s_nop 0
    v_cndmask_b32 v31, v39, v38, vcc
    v_mfma_f32_16x16x32_bf16 v[144:147], v[164:167], v[204:207], v[144:147]
    v_cmp_gt_u32 vcc, 25, v23
    v_mov_b32 v26, 0x7ffffff0
    s_nop 0
    v_cndmask_b32 v14, v26, v19, vcc
    v_lshl_add_u32 v23, v22, 1, 1
    s_waitcnt vmcnt(5) lgkmcnt(0)
    s_barrier
    v_mfma_f32_16x16x32_bf16 v[48:51], v[168:171], v[208:211], v[48:51]
    ds_read_b128 v[188:191], v8 offset:20480
    v_mfma_f32_16x16x32_bf16 v[52:55], v[168:171], v[212:215], v[52:55]
    ds_read_b64_tr_b16 v[148:149], v228 offset:40960
    s_add_u32 m0, s78, 0
    s_add_u32 s48, s73, 40960
    v_mfma_f32_16x16x32_bf16 v[56:59], v[168:171], v[216:219], v[56:59]
    ds_read_b64_tr_b16 v[150:151], v228 offset:46080
    v_mfma_f32_16x16x32_bf16 v[60:63], v[168:171], v[220:223], v[60:63]
    ds_read_b128 v[192:195], v8 offset:21504
    v_mfma_f32_16x16x32_bf16 v[64:67], v[168:171], v[224:227], v[64:67]
    ds_read_b128 v[196:199], v8 offset:22528
    buffer_load_dwordx4 v253, s[24:27], s48 offen lds
    v_mfma_f32_16x16x32_bf16 v[68:71], v[172:175], v[208:211], v[68:71]
    v_mfma_f32_16x16x32_bf16 v[72:75], v[172:175], v[212:215], v[72:75]
    ds_read_b64_tr_b16 v[152:153], v229 offset:40960
    v_mfma_f32_16x16x32_bf16 v[76:79], v[172:175], v[216:219], v[76:79]
    ds_read_b64_tr_b16 v[154:155], v229 offset:46080
    buffer_load_dwordx4 v253, s[24:27], s48 offen offset:1024 lds
    v_mfma_f32_16x16x32_bf16 v[80:83], v[172:175], v[220:223], v[80:83]
    ds_read_b128 v[200:203], v8 offset:23552
    v_mfma_f32_16x16x32_bf16 v[84:87], v[172:175], v[224:227], v[84:87]
    ds_read_b128 v[204:207], v8 offset:24576
    v_mfma_f32_16x16x32_bf16 v[88:91], v[176:179], v[208:211], v[88:91]
    ds_read_b64_tr_b16 v[156:157], v230 offset:40960
    buffer_load_dwordx4 v253, s[24:27], s48 offen offset:2048 lds
    v_mfma_f32_16x16x32_bf16 v[92:95], v[176:179], v[212:215], v[92:95]
    v_mfma_f32_16x16x32_bf16 v[96:99], v[176:179], v[216:219], v[96:99]
    ds_read_b64_tr_b16 v[158:159], v230 offset:46080
    v_mfma_f32_16x16x32_bf16 v[100:103], v[176:179], v[220:223], v[100:103]
    ds_read_b64_tr_b16 v[160:161], v231 offset:40960
    v_mfma_f32_16x16x32_bf16 v[104:107], v[176:179], v[224:227], v[104:107]
    ds_read_b64_tr_b16 v[162:163], v231 offset:46080
    buffer_load_dwordx4 v253, s[24:27], s48 offen offset:3072 lds
    v_mfma_f32_16x16x32_bf16 v[108:111], v[180:183], v[208:211], v[108:111]
    ds_read_b64_tr_b16 v[164:165], v232 offset:40960
    v_mfma_f32_16x16x32_bf16 v[112:115], v[180:183], v[212:215], v[112:115]
    ds_read_b64_tr_b16 v[166:167], v232 offset:46080
    v_mfma_f32_16x16x32_bf16 v[116:119], v[180:183], v[216:219], v[116:119]
    s_add_u32 m0, s78, 4096
    s_add_u32 s48, s73, 45056
    v_mfma_f32_16x16x32_bf16 v[120:123], v[180:183], v[220:223], v[120:123]
    v_mfma_f32_16x16x32_bf16 v[124:127], v[180:183], v[224:227], v[124:127]
    v_mfma_f32_16x16x32_bf16 v[128:131], v[184:187], v[208:211], v[128:131]
    buffer_load_dwordx4 v253, s[24:27], s48 offen lds
    v_mfma_f32_16x16x32_bf16 v[132:135], v[184:187], v[212:215], v[132:135]
    v_mfma_f32_16x16x32_bf16 v[136:139], v[184:187], v[216:219], v[136:139]
    v_mfma_f32_16x16x32_bf16 v[140:143], v[184:187], v[220:223], v[140:143]
    v_mfma_f32_16x16x32_bf16 v[144:147], v[184:187], v[224:227], v[144:147]
    s_waitcnt lgkmcnt(12)
    v_mfma_f32_16x16x32_bf16 v[48:51], v[148:151], v[188:191], v[48:51]
    ds_read_b128 v[208:211], v8 offset:30720
    v_mul_u32_u24 v24, 52, v23
    v_lshrrev_b32 v24, 8, v24
    v_mul_u32_u24 v26, 5, v24
    s_waitcnt lgkmcnt(12)
    v_mfma_f32_16x16x32_bf16 v[52:55], v[148:151], v[192:195], v[52:55]
    ds_read_b64_tr_b16 v[168:169], v228 offset:51200
    v_sub_u32 v25, v23, v26
    v_lshlrev_b32 v19, 4, v25
    s_waitcnt lgkmcnt(12)
    v_mfma_f32_16x16x32_bf16 v[56:59], v[148:151], v[196:199], v[56:59]
    ds_read_b64_tr_b16 v[170:171], v228 offset:56320
    v_bfe_u32 v26, v21, 2, 1
    v_add_u32 v19, v19, v26
    s_waitcnt lgkmcnt(10)
    v_mfma_f32_16x16x32_bf16 v[60:63], v[148:151], v[200:203], v[60:63]
    ds_read_b128 v[212:215], v8 offset:31744
    v_mul_u32_u24 v19, 0x500, v19
    v_lshlrev_b32 v20, 5, v24
    v_and_b32 v26, 3, v21
    s_waitcnt lgkmcnt(10)
    v_mfma_f32_16x16x32_bf16 v[64:67], v[148:151], v[204:207], v[64:67]
    ds_read_b128 v[216:219], v8 offset:32768
    v_lshl_add_u32 v20, v26, 3, v20
    v_add_u32 v19, v19, v20
    v_mfma_f32_16x16x32_bf16 v[68:71], v[152:155], v[188:191], v[68:71]
    v_add_u32 v19, s50, v19
    s_mul_i32 s99, s96, 10
    v_mfma_f32_16x16x32_bf16 v[72:75], v[152:155], v[192:195], v[72:75]
    ds_read_b64_tr_b16 v[172:173], v229 offset:51200
    v_lshlrev_b32 v38, 1, v25
    v_add_u32 v38, s99, v38
    v_bfe_u32 v39, v21, 2, 1
    v_mfma_f32_16x16x32_bf16 v[76:79], v[152:155], v[196:199], v[76:79]
    ds_read_b64_tr_b16 v[174:175], v229 offset:56320
    v_add_u32 v38, v38, v39
    v_mul_u32_u24 v38, 0x140, v38
    v_mfma_f32_16x16x32_bf16 v[80:83], v[152:155], v[200:203], v[80:83]
    ds_read_b128 v[220:223], v8 offset:33792
    s_mul_i32 s99, s97, 160
    v_add_u32 v38, s99, v38
    v_mfma_f32_16x16x32_bf16 v[84:87], v[152:155], v[204:207], v[84:87]
    ds_read_b128 v[224:227], v8 offset:34816
    v_add_u32 v38, v38, v20
    v_cmp_gt_u32 vcc, 25, v23
    v_mov_b32 v39, 0x4000
    s_nop 0
    v_cndmask_b32 v32, v39, v38, vcc
    v_cmp_gt_u32 vcc, 25, v23
    v_mov_b32 v26, 0x7ffffff0
    s_nop 0
    v_cndmask_b32 v15, v26, v19, vcc
    s_waitcnt lgkmcnt(13)
    v_mfma_f32_16x16x32_bf16 v[88:91], v[156:159], v[188:191], v[88:91]
    ds_read_b64_tr_b16 v[176:177], v230 offset:51200
    v_add_u32 v21, 64, v0
    v_lshrrev_b32 v22, 3, v21
    v_mfma_f32_16x16x32_bf16 v[92:95], v[156:159], v[192:195], v[92:95]
    v_lshl_add_u32 v23, v22, 1, 0
    v_mul_u32_u24 v24, 52, v23
    v_mfma_f32_16x16x32_bf16 v[96:99], v[156:159], v[196:199], v[96:99]
    ds_read_b64_tr_b16 v[178:179], v230 offset:56320
    v_lshrrev_b32 v24, 8, v24
    v_mul_u32_u24 v26, 5, v24
    v_sub_u32 v25, v23, v26
    v_mfma_f32_16x16x32_bf16 v[100:103], v[156:159], v[200:203], v[100:103]
    ds_read_b64_tr_b16 v[180:181], v231 offset:51200
    v_lshlrev_b32 v19, 4, v25
    v_bfe_u32 v26, v21, 2, 1
    v_mfma_f32_16x16x32_bf16 v[104:107], v[156:159], v[204:207], v[104:107]
    ds_read_b64_tr_b16 v[182:183], v231 offset:56320
    v_add_u32 v19, v19, v26
    v_mul_u32_u24 v19, 0x500, v19
    s_waitcnt lgkmcnt(15)
    v_mfma_f32_16x16x32_bf16 v[108:111], v[160:163], v[188:191], v[108:111]
    ds_read_b64_tr_b16 v[184:185], v232 offset:51200
    v_lshlrev_b32 v20, 5, v24
    v_and_b32 v26, 3, v21
    v_lshl_add_u32 v20, v26, 3, v20
    v_mfma_f32_16x16x32_bf16 v[112:115], v[160:163], v[192:195], v[112:115]
    ds_read_b64_tr_b16 v[186:187], v232 offset:56320
    v_add_u32 v19, v19, v20
    v_add_u32 v19, s50, v19
    v_mfma_f32_16x16x32_bf16 v[116:119], v[160:163], v[196:199], v[116:119]
    s_mul_i32 s99, s96, 10
    v_lshlrev_b32 v38, 1, v25
    v_mfma_f32_16x16x32_bf16 v[120:123], v[160:163], v[200:203], v[120:123]
    v_add_u32 v38, s99, v38
    v_bfe_u32 v39, v21, 2, 1
    v_add_u32 v38, v38, v39
    v_mfma_f32_16x16x32_bf16 v[124:127], v[160:163], v[204:207], v[124:127]
    v_mul_u32_u24 v38, 0x140, v38
    s_mul_i32 s99, s97, 160
    s_waitcnt lgkmcnt(15)
    v_mfma_f32_16x16x32_bf16 v[128:131], v[164:167], v[188:191], v[128:131]
    v_add_u32 v38, s99, v38
    v_add_u32 v38, v38, v20
    v_mfma_f32_16x16x32_bf16 v[132:135], v[164:167], v[192:195], v[132:135]
    v_cmp_gt_u32 vcc, 25, v23
    v_mov_b32 v39, 0x4000
    s_nop 0
    v_cndmask_b32 v33, v39, v38, vcc
    v_cmp_gt_u32 vcc, 25, v23
    v_mov_b32 v26, 0x7ffffff0
    s_nop 0
    v_cndmask_b32 v16, v26, v19, vcc
    v_lshl_add_u32 v23, v22, 1, 1
    v_mfma_f32_16x16x32_bf16 v[136:139], v[164:167], v[196:199], v[136:139]
    v_mul_u32_u24 v24, 52, v23
    v_lshrrev_b32 v24, 8, v24
    v_mfma_f32_16x16x32_bf16 v[140:143], v[164:167], v[200:203], v[140:143]
    v_mul_u32_u24 v26, 5, v24
    v_sub_u32 v25, v23, v26
    v_mfma_f32_16x16x32_bf16 v[144:147], v[164:167], v[204:207], v[144:147]
    v_lshlrev_b32 v19, 4, v25
    v_bfe_u32 v26, v21, 2, 1
    s_waitcnt vmcnt(0) lgkmcnt(0)
    s_barrier
    v_mfma_f32_16x16x32_bf16 v[48:51], v[168:171], v[208:211], v[48:51]
    ds_read_b128 v[188:191], v8
    v_mfma_f32_16x16x32_bf16 v[52:55], v[168:171], v[212:215], v[52:55]
    ds_read_b64_tr_b16 v[148:149], v233 offset:32768
    v_mfma_f32_16x16x32_bf16 v[56:59], v[168:171], v[216:219], v[56:59]
    ds_read_b64_tr_b16 v[150:151], v233 offset:37888
    v_mfma_f32_16x16x32_bf16 v[60:63], v[168:171], v[220:223], v[60:63]
    ds_read_b128 v[192:195], v8 offset:1024
    v_mfma_f32_16x16x32_bf16 v[64:67], v[168:171], v[224:227], v[64:67]
    ds_read_b128 v[196:199], v8 offset:2048
    v_mfma_f32_16x16x32_bf16 v[68:71], v[172:175], v[208:211], v[68:71]
    v_mfma_f32_16x16x32_bf16 v[72:75], v[172:175], v[212:215], v[72:75]
    ds_read_b64_tr_b16 v[152:153], v234 offset:32768
    v_mfma_f32_16x16x32_bf16 v[76:79], v[172:175], v[216:219], v[76:79]
    ds_read_b64_tr_b16 v[154:155], v234 offset:37888
    v_mfma_f32_16x16x32_bf16 v[80:83], v[172:175], v[220:223], v[80:83]
    ds_read_b128 v[200:203], v8 offset:3072
    v_mfma_f32_16x16x32_bf16 v[84:87], v[172:175], v[224:227], v[84:87]
    ds_read_b128 v[204:207], v8 offset:4096
    v_mfma_f32_16x16x32_bf16 v[88:91], v[176:179], v[208:211], v[88:91]
    ds_read_b64_tr_b16 v[156:157], v235 offset:32768
    v_mfma_f32_16x16x32_bf16 v[92:95], v[176:179], v[212:215], v[92:95]
    v_mfma_f32_16x16x32_bf16 v[96:99], v[176:179], v[216:219], v[96:99]
    ds_read_b64_tr_b16 v[158:159], v235 offset:37888
    v_mfma_f32_16x16x32_bf16 v[100:103], v[176:179], v[220:223], v[100:103]
    ds_read_b64_tr_b16 v[160:161], v236 offset:32768
    v_mfma_f32_16x16x32_bf16 v[104:107], v[176:179], v[224:227], v[104:107]
    ds_read_b64_tr_b16 v[162:163], v236 offset:37888
    v_mfma_f32_16x16x32_bf16 v[108:111], v[180:183], v[208:211], v[108:111]
    ds_read_b64_tr_b16 v[164:165], v237 offset:32768
    v_mfma_f32_16x16x32_bf16 v[112:115], v[180:183], v[212:215], v[112:115]
    ds_read_b64_tr_b16 v[166:167], v237 offset:37888
    v_mfma_f32_16x16x32_bf16 v[116:119], v[180:183], v[216:219], v[116:119]
    v_mfma_f32_16x16x32_bf16 v[120:123], v[180:183], v[220:223], v[120:123]
    v_mfma_f32_16x16x32_bf16 v[124:127], v[180:183], v[224:227], v[124:127]
    v_mfma_f32_16x16x32_bf16 v[128:131], v[184:187], v[208:211], v[128:131]
    v_mfma_f32_16x16x32_bf16 v[132:135], v[184:187], v[212:215], v[132:135]
    v_mfma_f32_16x16x32_bf16 v[136:139], v[184:187], v[216:219], v[136:139]
    v_mfma_f32_16x16x32_bf16 v[140:143], v[184:187], v[220:223], v[140:143]
    v_mfma_f32_16x16x32_bf16 v[144:147], v[184:187], v[224:227], v[144:147]
    s_waitcnt lgkmcnt(12)
    v_mfma_f32_16x16x32_bf16 v[48:51], v[148:151], v[188:191], v[48:51]
    ds_read_b128 v[208:211], v8 offset:10240
    v_add_u32 v19, v19, v26
    v_mul_u32_u24 v19, 0x500, v19
    v_lshlrev_b32 v20, 5, v24
    s_waitcnt lgkmcnt(12)
    v_mfma_f32_16x16x32_bf16 v[52:55], v[148:151], v[192:195], v[52:55]
    ds_read_b64_tr_b16 v[168:169], v233 offset:43008
    v_and_b32 v26, 3, v21
    v_lshl_add_u32 v20, v26, 3, v20
    s_waitcnt lgkmcnt(12)
    v_mfma_f32_16x16x32_bf16 v[56:59], v[148:151], v[196:199], v[56:59]
    ds_read_b64_tr_b16 v[170:171], v233 offset:48128
    v_add_u32 v19, v19, v20
    v_add_u32 v19, s50, v19
    s_mul_i32 s99, s96, 10
    s_waitcnt lgkmcnt(10)
    v_mfma_f32_16x16x32_bf16 v[60:63], v[148:151], v[200:203], v[60:63]
    ds_read_b128 v[212:215], v8 offset:11264
    v_lshlrev_b32 v38, 1, v25
    v_add_u32 v38, s99, v38
    s_waitcnt lgkmcnt(10)
    v_mfma_f32_16x16x32_bf16 v[64:67], v[148:151], v[204:207], v[64:67]
    ds_read_b128 v[216:219], v8 offset:12288
    v_bfe_u32 v39, v21, 2, 1
    v_add_u32 v38, v38, v39
    v_mfma_f32_16x16x32_bf16 v[68:71], v[152:155], v[188:191], v[68:71]
    v_mul_u32_u24 v38, 0x140, v38
    s_mul_i32 s99, s97, 160
    v_add_u32 v38, s99, v38
    v_mfma_f32_16x16x32_bf16 v[72:75], v[152:155], v[192:195], v[72:75]
    ds_read_b64_tr_b16 v[172:173], v234 offset:43008
    v_add_u32 v38, v38, v20
    v_cmp_gt_u32 vcc, 25, v23
    v_mov_b32 v39, 0x4000
    s_nop 0
    v_cndmask_b32 v34, v39, v38, vcc
    v_mfma_f32_16x16x32_bf16 v[76:79], v[152:155], v[196:199], v[76:79]
    ds_read_b64_tr_b16 v[174:175], v234 offset:48128
    v_cmp_gt_u32 vcc, 25, v23
    v_mov_b32 v26, 0x7ffffff0
    s_nop 0
    v_cndmask_b32 v17, v26, v19, vcc
    s_lshl_b32 s99, s28, 6
    v_mfma_f32_16x16x32_bf16 v[80:83], v[152:155], v[200:203], v[80:83]
    ds_read_b128 v[220:223], v8 offset:13312
    v_add_u32 v38, s99, v0
    v_mul_u32_u24 v39, 0xccd, v38
    v_lshrrev_b32 v39, 16, v39
    v_mfma_f32_16x16x32_bf16 v[84:87], v[152:155], v[204:207], v[84:87]
    ds_read_b128 v[224:227], v8 offset:14336
    v_mul_u32_u24 v40, 20, v39
    v_sub_u32 v40, v38, v40
    s_waitcnt lgkmcnt(13)
    v_mfma_f32_16x16x32_bf16 v[88:91], v[156:159], v[188:191], v[88:91]
    ds_read_b64_tr_b16 v[176:177], v235 offset:43008
    v_lshrrev_b32 v41, 1, v39
    v_lshlrev_b32 v41, 4, v41
    v_mfma_f32_16x16x32_bf16 v[92:95], v[156:159], v[192:195], v[92:95]
    v_and_b32 v39, 1, v39
    v_add_u32 v41, v41, v39
    v_mul_u32_u24 v41, 0x500, v41
    v_mfma_f32_16x16x32_bf16 v[96:99], v[156:159], v[196:199], v[96:99]
    ds_read_b64_tr_b16 v[178:179], v235 offset:48128
    v_lshl_add_u32 v41, v40, 4, v41
    s_mul_i32 s99, s29, 160
    v_mfma_f32_16x16x32_bf16 v[100:103], v[156:159], v[200:203], v[100:103]
    ds_read_b64_tr_b16 v[180:181], v236 offset:43008
    s_lshl_b32 s98, s74, 1
    s_add_u32 s99, s99, s98
    s_mul_i32 s99, s99, 1280
    v_mfma_f32_16x16x32_bf16 v[104:107], v[156:159], v[204:207], v[104:107]
    ds_read_b64_tr_b16 v[182:183], v236 offset:48128
    s_mul_i32 s98, s75, 320
    s_add_u32 s99, s99, s98
    s_waitcnt lgkmcnt(15)
    v_mfma_f32_16x16x32_bf16 v[108:111], v[160:163], v[188:191], v[108:111]
    ds_read_b64_tr_b16 v[184:185], v237 offset:43008
    v_add_u32 v41, s99, v41
    v_cmp_gt_u32 vcc, 0x190, v38
    v_mov_b32 v40, 0x7ffffff0
    s_nop 0
    v_cndmask_b32 v36, v40, v41, vcc
    v_mfma_f32_16x16x32_bf16 v[112:115], v[160:163], v[192:195], v[112:115]
    ds_read_b64_tr_b16 v[186:187], v237 offset:48128
    s_lshl_b32 s99, s28, 6
    v_add_u32 v38, s99, v0
    v_add_u32 v38, 0x100, v38
    v_mfma_f32_16x16x32_bf16 v[116:119], v[160:163], v[196:199], v[116:119]
    v_mul_u32_u24 v39, 0xccd, v38
    v_lshrrev_b32 v39, 16, v39
    v_mfma_f32_16x16x32_bf16 v[120:123], v[160:163], v[200:203], v[120:123]
    v_mul_u32_u24 v40, 20, v39
    v_sub_u32 v40, v38, v40
    v_mfma_f32_16x16x32_bf16 v[124:127], v[160:163], v[204:207], v[124:127]
    v_lshrrev_b32 v41, 1, v39
    v_lshlrev_b32 v41, 4, v41
    v_and_b32 v39, 1, v39
    s_waitcnt lgkmcnt(15)
    v_mfma_f32_16x16x32_bf16 v[128:131], v[164:167], v[188:191], v[128:131]
    v_add_u32 v41, v41, v39
    v_mul_u32_u24 v41, 0x500, v41
    v_mfma_f32_16x16x32_bf16 v[132:135], v[164:167], v[192:195], v[132:135]
    v_lshl_add_u32 v41, v40, 4, v41
    s_mul_i32 s99, s29, 160
    v_mfma_f32_16x16x32_bf16 v[136:139], v[164:167], v[196:199], v[136:139]
    s_lshl_b32 s98, s74, 1
    s_add_u32 s99, s99, s98
    s_mul_i32 s99, s99, 1280
    v_mfma_f32_16x16x32_bf16 v[140:143], v[164:167], v[200:203], v[140:143]
    s_mul_i32 s98, s75, 320
    s_add_u32 s99, s99, s98
    v_mfma_f32_16x16x32_bf16 v[144:147], v[164:167], v[204:207], v[144:147]
    v_add_u32 v41, s99, v41
    v_cmp_gt_u32 vcc, 0x190, v38
    v_mov_b32 v40, 0x7ffffff0
    s_nop 0
    v_cndmask_b32 v37, v40, v41, vcc
    s_waitcnt lgkmcnt(0)
    s_barrier
    v_mfma_f32_16x16x32_bf16 v[48:51], v[168:171], v[208:211], v[48:51]
    v_mfma_f32_16x16x32_bf16 v[52:55], v[168:171], v[212:215], v[52:55]
    v_mfma_f32_16x16x32_bf16 v[56:59], v[168:171], v[216:219], v[56:59]
    v_mfma_f32_16x16x32_bf16 v[60:63], v[168:171], v[220:223], v[60:63]
    v_mfma_f32_16x16x32_bf16 v[64:67], v[168:171], v[224:227], v[64:67]
    v_mfma_f32_16x16x32_bf16 v[68:71], v[172:175], v[208:211], v[68:71]
    s_nop 2
    v_cvt_pk_bf16_f32 v148, v48, v49
    v_cvt_pk_bf16_f32 v149, v50, v51
    v_cvt_pk_bf16_f32 v150, v52, v53
    v_cvt_pk_bf16_f32 v151, v54, v55
    buffer_store_dwordx4 v[148:151], v12, s[24:27], 0 offen sc1
    v_mfma_f32_16x16x32_bf16 v[72:75], v[172:175], v[212:215], v[72:75]
    v_mfma_f32_16x16x32_bf16 v[76:79], v[172:175], v[216:219], v[76:79]
    v_cvt_pk_bf16_f32 v152, v56, v57
    v_cvt_pk_bf16_f32 v153, v58, v59
    v_cvt_pk_bf16_f32 v154, v60, v61
    v_cvt_pk_bf16_f32 v155, v62, v63
    buffer_store_dwordx4 v[152:155], v12, s[24:27], 0 offen offset:128 sc1
    v_mfma_f32_16x16x32_bf16 v[80:83], v[172:175], v[220:223], v[80:83]
    v_mfma_f32_16x16x32_bf16 v[84:87], v[172:175], v[224:227], v[84:87]
    v_cvt_pk_bf16_f32 v156, v64, v65
    v_cvt_pk_bf16_f32 v157, v66, v67
    v_cvt_pk_bf16_f32 v158, v68, v69
    v_cvt_pk_bf16_f32 v159, v70, v71
    buffer_store_dwordx4 v[156:159], v12, s[24:27], 0 offen offset:256 sc1
    v_mfma_f32_16x16x32_bf16 v[88:91], v[176:179], v[208:211], v[88:91]
    v_mfma_f32_16x16x32_bf16 v[92:95], v[176:179], v[212:215], v[92:95]
    v_cvt_pk_bf16_f32 v160, v72, v73
    v_cvt_pk_bf16_f32 v161, v74, v75
    v_cvt_pk_bf16_f32 v162, v76, v77
    v_cvt_pk_bf16_f32 v163, v78, v79
    buffer_store_dwordx4 v[160:163], v12, s[24:27], 0 offen offset:384 sc1
    v_mfma_f32_16x16x32_bf16 v[96:99], v[176:179], v[216:219], v[96:99]
    v_mfma_f32_16x16x32_bf16 v[100:103], v[176:179], v[220:223], v[100:103]
    v_cvt_pk_bf16_f32 v164, v80, v81
    v_cvt_pk_bf16_f32 v165, v82, v83
    v_cvt_pk_bf16_f32 v166, v84, v85
    v_cvt_pk_bf16_f32 v167, v86, v87
    buffer_store_dwordx4 v[164:167], v12, s[24:27], 0 offen offset:512 sc1
    v_mfma_f32_16x16x32_bf16 v[104:107], v[176:179], v[224:227], v[104:107]
    v_mfma_f32_16x16x32_bf16 v[108:111], v[180:183], v[208:211], v[108:111]
    v_cvt_pk_bf16_f32 v188, v88, v89
    v_cvt_pk_bf16_f32 v189, v90, v91
    v_cvt_pk_bf16_f32 v190, v92, v93
    v_cvt_pk_bf16_f32 v191, v94, v95
    buffer_store_dwordx4 v[188:191], v12, s[24:27], 0 offen offset:640 sc1
    v_mfma_f32_16x16x32_bf16 v[112:115], v[180:183], v[212:215], v[112:115]
    v_mfma_f32_16x16x32_bf16 v[116:119], v[180:183], v[216:219], v[116:119]
    v_cvt_pk_bf16_f32 v192, v96, v97
    v_cvt_pk_bf16_f32 v193, v98, v99
    v_cvt_pk_bf16_f32 v194, v100, v101
    v_cvt_pk_bf16_f32 v195, v102, v103
    buffer_store_dwordx4 v[192:195], v12, s[24:27], 0 offen offset:768 sc1
    v_mfma_f32_16x16x32_bf16 v[120:123], v[180:183], v[220:223], v[120:123]
    v_mfma_f32_16x16x32_bf16 v[124:127], v[180:183], v[224:227], v[124:127]
    v_cvt_pk_bf16_f32 v196, v104, v105
    v_cvt_pk_bf16_f32 v197, v106, v107
    v_cvt_pk_bf16_f32 v198, v108, v109
    v_cvt_pk_bf16_f32 v199, v110, v111
    buffer_store_dwordx4 v[196:199], v12, s[24:27], 0 offen offset:896 sc1
    v_mfma_f32_16x16x32_bf16 v[128:131], v[184:187], v[208:211], v[128:131]
    v_mfma_f32_16x16x32_bf16 v[132:135], v[184:187], v[212:215], v[132:135]
    v_cvt_pk_bf16_f32 v200, v112, v113
    v_cvt_pk_bf16_f32 v201, v114, v115
    v_cvt_pk_bf16_f32 v202, v116, v117
    v_cvt_pk_bf16_f32 v203, v118, v119
    buffer_store_dwordx4 v[200:203], v12, s[24:27], 0 offen offset:1024 sc1
    v_mfma_f32_16x16x32_bf16 v[136:139], v[184:187], v[216:219], v[136:139]
    v_mfma_f32_16x16x32_bf16 v[140:143], v[184:187], v[220:223], v[140:143]
    v_cvt_pk_bf16_f32 v204, v120, v121
    v_cvt_pk_bf16_f32 v205, v122, v123
    v_cvt_pk_bf16_f32 v206, v124, v125
    v_cvt_pk_bf16_f32 v207, v126, v127
    buffer_store_dwordx4 v[204:207], v12, s[24:27], 0 offen offset:1152 sc1
    v_mfma_f32_16x16x32_bf16 v[144:147], v[184:187], v[224:227], v[144:147]
    v_cvt_pk_bf16_f32 v228, v128, v129
    v_cvt_pk_bf16_f32 v229, v130, v131
    v_cvt_pk_bf16_f32 v230, v132, v133
    v_cvt_pk_bf16_f32 v231, v134, v135
    buffer_store_dwordx4 v[228:231], v12, s[24:27], 0 offen offset:1280 sc1
    v_cvt_pk_bf16_f32 v232, v136, v137
    v_cvt_pk_bf16_f32 v233, v138, v139
    v_cvt_pk_bf16_f32 v234, v140, v141
    v_cvt_pk_bf16_f32 v235, v142, v143
    buffer_store_dwordx4 v[232:235], v12, s[24:27], 0 offen offset:1408 sc1
    v_cvt_pk_bf16_f32 v236, v144, v145
    v_cvt_pk_bf16_f32 v237, v146, v147
    v_cvt_pk_bf16_f32 v238, v144, v145
    v_cvt_pk_bf16_f32 v239, v146, v147
    buffer_store_dwordx4 v[236:239], v12, s[24:27], 0 offen offset:1536 sc1
    s_waitcnt vmcnt(0)
    s_barrier
    s_cmp_eq_u32 s28, 0
    s_cbranch_scc0 L_FS2
    s_lshl_b32 s48, s74, 2
    s_add_u32 s48, s48, s77
    v_mov_b32 v6, 1
    v_mov_b32 v7, 0
    s_mov_b64 exec, 1
    buffer_store_dword v6, v7, s[24:27], s48 offen sc1
    s_mov_b64 exec, -1
L_FS2:
    s_cmp_eq_u32 s28, 0
    s_cbranch_scc0 L_P2_SKIP
    v_and_b32 v6, 7, v0
    v_lshlrev_b32 v6, 2, v6
    buffer_load_dword v7, v6, s[24:27], s77 offen sc1
    s_waitcnt vmcnt(0)
    s_mov_b32 s39, 200000
L_P2_L:
    v_cmp_eq_u32 vcc, 1, v7
    s_nop 4
    s_cmp_eq_u64 vcc, -1
    s_cbranch_scc1 L_P2_D
    s_sub_u32 s39, s39, 1
    s_cmp_eq_u32 s39, 0
    s_cbranch_scc1 L_P2_D
    buffer_load_dword v7, v6, s[24:27], s77 offen sc1
    s_waitcnt vmcnt(0)
    s_branch L_P2_L
L_P2_D:
L_P2_SKIP:
    s_barrier
    s_add_u32 s48, s100, 0
    buffer_load_dwordx4 v[48:51], v13, s[24:27], s48 offen sc1
    buffer_load_dwordx4 v[52:55], v18, s[24:27], s48 offen sc1
    s_add_u32 s48, s100, 6656
    buffer_load_dwordx4 v[56:59], v13, s[24:27], s48 offen sc1
    buffer_load_dwordx4 v[60:63], v18, s[24:27], s48 offen sc1
    s_add_u32 s48, s100, 13312
    buffer_load_dwordx4 v[64:67], v13, s[24:27], s48 offen sc1
    buffer_load_dwordx4 v[68:71], v18, s[24:27], s48 offen sc1
    s_add_u32 s48, s100, 19968
    buffer_load_dwordx4 v[72:75], v13, s[24:27], s48 offen sc1
    buffer_load_dwordx4 v[76:79], v18, s[24:27], s48 offen sc1
    s_add_u32 s48, s100, 26624
    buffer_load_dwordx4 v[80:83], v13, s[24:27], s48 offen sc1
    buffer_load_dwordx4 v[84:87], v18, s[24:27], s48 offen sc1
    s_add_u32 s48, s100, 33280
    buffer_load_dwordx4 v[88:91], v13, s[24:27], s48 offen sc1
    buffer_load_dwordx4 v[92:95], v18, s[24:27], s48 offen sc1
    s_add_u32 s48, s100, 39936
    buffer_load_dwordx4 v[96:99], v13, s[24:27], s48 offen sc1
    buffer_load_dwordx4 v[100:103], v18, s[24:27], s48 offen sc1
    s_add_u32 s48, s100, 46592
    buffer_load_dwordx4 v[104:107], v13, s[24:27], s48 offen sc1
    buffer_load_dwordx4 v[108:111], v18, s[24:27], s48 offen sc1
    s_waitcnt vmcnt(15)
    v_lshlrev_b32 v148, 16, v48
    v_and_b32 v149, 0xffff0000, v48
    v_lshlrev_b32 v150, 16, v49
    v_and_b32 v151, 0xffff0000, v49
    v_lshlrev_b32 v152, 16, v50
    v_and_b32 v153, 0xffff0000, v50
    v_lshlrev_b32 v154, 16, v51
    v_and_b32 v155, 0xffff0000, v51
    s_waitcnt vmcnt(14)
    v_lshlrev_b32 v156, 16, v52
    v_and_b32 v157, 0xffff0000, v52
    v_lshlrev_b32 v158, 16, v53
    v_and_b32 v159, 0xffff0000, v53
    v_lshlrev_b32 v160, 16, v54
    v_and_b32 v161, 0xffff0000, v54
    v_lshlrev_b32 v162, 16, v55
    v_and_b32 v163, 0xffff0000, v55
    s_waitcnt vmcnt(13)
    v_lshlrev_b32 v170, 16, v56
    v_and_b32 v171, 0xffff0000, v56
    v_add_f32 v148, v148, v170
    v_add_f32 v149, v149, v171
    v_lshlrev_b32 v170, 16, v57
    v_and_b32 v171, 0xffff0000, v57
    v_add_f32 v150, v150, v170
    v_add_f32 v151, v151, v171
    v_lshlrev_b32 v170, 16, v58
    v_and_b32 v171, 0xffff0000, v58
    v_add_f32 v152, v152, v170
    v_add_f32 v153, v153, v171
    v_lshlrev_b32 v170, 16, v59
    v_and_b32 v171, 0xffff0000, v59
    v_add_f32 v154, v154, v170
    v_add_f32 v155, v155, v171
    s_waitcnt vmcnt(12)
    v_lshlrev_b32 v170, 16, v60
    v_and_b32 v171, 0xffff0000, v60
    v_add_f32 v156, v156, v170
    v_add_f32 v157, v157, v171
    v_lshlrev_b32 v170, 16, v61
    v_and_b32 v171, 0xffff0000, v61
    v_add_f32 v158, v158, v170
    v_add_f32 v159, v159, v171
    v_lshlrev_b32 v170, 16, v62
    v_and_b32 v171, 0xffff0000, v62
    v_add_f32 v160, v160, v170
    v_add_f32 v161, v161, v171
    v_lshlrev_b32 v170, 16, v63
    v_and_b32 v171, 0xffff0000, v63
    v_add_f32 v162, v162, v170
    v_add_f32 v163, v163, v171
    s_waitcnt vmcnt(11)
    v_lshlrev_b32 v170, 16, v64
    v_and_b32 v171, 0xffff0000, v64
    v_add_f32 v148, v148, v170
    v_add_f32 v149, v149, v171
    v_lshlrev_b32 v170, 16, v65
    v_and_b32 v171, 0xffff0000, v65
    v_add_f32 v150, v150, v170
    v_add_f32 v151, v151, v171
    v_lshlrev_b32 v170, 16, v66
    v_and_b32 v171, 0xffff0000, v66
    v_add_f32 v152, v152, v170
    v_add_f32 v153, v153, v171
    v_lshlrev_b32 v170, 16, v67
    v_and_b32 v171, 0xffff0000, v67
    v_add_f32 v154, v154, v170
    v_add_f32 v155, v155, v171
    s_waitcnt vmcnt(10)
    v_lshlrev_b32 v170, 16, v68
    v_and_b32 v171, 0xffff0000, v68
    v_add_f32 v156, v156, v170
    v_add_f32 v157, v157, v171
    v_lshlrev_b32 v170, 16, v69
    v_and_b32 v171, 0xffff0000, v69
    v_add_f32 v158, v158, v170
    v_add_f32 v159, v159, v171
    v_lshlrev_b32 v170, 16, v70
    v_and_b32 v171, 0xffff0000, v70
    v_add_f32 v160, v160, v170
    v_add_f32 v161, v161, v171
    v_lshlrev_b32 v170, 16, v71
    v_and_b32 v171, 0xffff0000, v71
    v_add_f32 v162, v162, v170
    v_add_f32 v163, v163, v171
    s_waitcnt vmcnt(9)
    v_lshlrev_b32 v170, 16, v72
    v_and_b32 v171, 0xffff0000, v72
    v_add_f32 v148, v148, v170
    v_add_f32 v149, v149, v171
    v_lshlrev_b32 v170, 16, v73
    v_and_b32 v171, 0xffff0000, v73
    v_add_f32 v150, v150, v170
    v_add_f32 v151, v151, v171
    v_lshlrev_b32 v170, 16, v74
    v_and_b32 v171, 0xffff0000, v74
    v_add_f32 v152, v152, v170
    v_add_f32 v153, v153, v171
    v_lshlrev_b32 v170, 16, v75
    v_and_b32 v171, 0xffff0000, v75
    v_add_f32 v154, v154, v170
    v_add_f32 v155, v155, v171
    s_waitcnt vmcnt(8)
    v_lshlrev_b32 v170, 16, v76
    v_and_b32 v171, 0xffff0000, v76
    v_add_f32 v156, v156, v170
    v_add_f32 v157, v157, v171
    v_lshlrev_b32 v170, 16, v77
    v_and_b32 v171, 0xffff0000, v77
    v_add_f32 v158, v158, v170
    v_add_f32 v159, v159, v171
    v_lshlrev_b32 v170, 16, v78
    v_and_b32 v171, 0xffff0000, v78
    v_add_f32 v160, v160, v170
    v_add_f32 v161, v161, v171
    v_lshlrev_b32 v170, 16, v79
    v_and_b32 v171, 0xffff0000, v79
    v_add_f32 v162, v162, v170
    v_add_f32 v163, v163, v171
    s_waitcnt vmcnt(7)
    v_lshlrev_b32 v170, 16, v80
    v_and_b32 v171, 0xffff0000, v80
    v_add_f32 v148, v148, v170
    v_add_f32 v149, v149, v171
    v_lshlrev_b32 v170, 16, v81
    v_and_b32 v171, 0xffff0000, v81
    v_add_f32 v150, v150, v170
    v_add_f32 v151, v151, v171
    v_lshlrev_b32 v170, 16, v82
    v_and_b32 v171, 0xffff0000, v82
    v_add_f32 v152, v152, v170
    v_add_f32 v153, v153, v171
    v_lshlrev_b32 v170, 16, v83
    v_and_b32 v171, 0xffff0000, v83
    v_add_f32 v154, v154, v170
    v_add_f32 v155, v155, v171
    s_waitcnt vmcnt(6)
    v_lshlrev_b32 v170, 16, v84
    v_and_b32 v171, 0xffff0000, v84
    v_add_f32 v156, v156, v170
    v_add_f32 v157, v157, v171
    v_lshlrev_b32 v170, 16, v85
    v_and_b32 v171, 0xffff0000, v85
    v_add_f32 v158, v158, v170
    v_add_f32 v159, v159, v171
    v_lshlrev_b32 v170, 16, v86
    v_and_b32 v171, 0xffff0000, v86
    v_add_f32 v160, v160, v170
    v_add_f32 v161, v161, v171
    v_lshlrev_b32 v170, 16, v87
    v_and_b32 v171, 0xffff0000, v87
    v_add_f32 v162, v162, v170
    v_add_f32 v163, v163, v171
    s_waitcnt vmcnt(5)
    v_lshlrev_b32 v170, 16, v88
    v_and_b32 v171, 0xffff0000, v88
    v_add_f32 v148, v148, v170
    v_add_f32 v149, v149, v171
    v_lshlrev_b32 v170, 16, v89
    v_and_b32 v171, 0xffff0000, v89
    v_add_f32 v150, v150, v170
    v_add_f32 v151, v151, v171
    v_lshlrev_b32 v170, 16, v90
    v_and_b32 v171, 0xffff0000, v90
    v_add_f32 v152, v152, v170
    v_add_f32 v153, v153, v171
    v_lshlrev_b32 v170, 16, v91
    v_and_b32 v171, 0xffff0000, v91
    v_add_f32 v154, v154, v170
    v_add_f32 v155, v155, v171
    s_waitcnt vmcnt(4)
    v_lshlrev_b32 v170, 16, v92
    v_and_b32 v171, 0xffff0000, v92
    v_add_f32 v156, v156, v170
    v_add_f32 v157, v157, v171
    v_lshlrev_b32 v170, 16, v93
    v_and_b32 v171, 0xffff0000, v93
    v_add_f32 v158, v158, v170
    v_add_f32 v159, v159, v171
    v_lshlrev_b32 v170, 16, v94
    v_and_b32 v171, 0xffff0000, v94
    v_add_f32 v160, v160, v170
    v_add_f32 v161, v161, v171
    v_lshlrev_b32 v170, 16, v95
    v_and_b32 v171, 0xffff0000, v95
    v_add_f32 v162, v162, v170
    v_add_f32 v163, v163, v171
    s_waitcnt vmcnt(3)
    v_lshlrev_b32 v170, 16, v96
    v_and_b32 v171, 0xffff0000, v96
    v_add_f32 v148, v148, v170
    v_add_f32 v149, v149, v171
    v_lshlrev_b32 v170, 16, v97
    v_and_b32 v171, 0xffff0000, v97
    v_add_f32 v150, v150, v170
    v_add_f32 v151, v151, v171
    v_lshlrev_b32 v170, 16, v98
    v_and_b32 v171, 0xffff0000, v98
    v_add_f32 v152, v152, v170
    v_add_f32 v153, v153, v171
    v_lshlrev_b32 v170, 16, v99
    v_and_b32 v171, 0xffff0000, v99
    v_add_f32 v154, v154, v170
    v_add_f32 v155, v155, v171
    s_waitcnt vmcnt(2)
    v_lshlrev_b32 v170, 16, v100
    v_and_b32 v171, 0xffff0000, v100
    v_add_f32 v156, v156, v170
    v_add_f32 v157, v157, v171
    v_lshlrev_b32 v170, 16, v101
    v_and_b32 v171, 0xffff0000, v101
    v_add_f32 v158, v158, v170
    v_add_f32 v159, v159, v171
    v_lshlrev_b32 v170, 16, v102
    v_and_b32 v171, 0xffff0000, v102
    v_add_f32 v160, v160, v170
    v_add_f32 v161, v161, v171
    v_lshlrev_b32 v170, 16, v103
    v_and_b32 v171, 0xffff0000, v103
    v_add_f32 v162, v162, v170
    v_add_f32 v163, v163, v171
    s_waitcnt vmcnt(1)
    v_lshlrev_b32 v170, 16, v104
    v_and_b32 v171, 0xffff0000, v104
    v_add_f32 v148, v148, v170
    v_add_f32 v149, v149, v171
    v_lshlrev_b32 v170, 16, v105
    v_and_b32 v171, 0xffff0000, v105
    v_add_f32 v150, v150, v170
    v_add_f32 v151, v151, v171
    v_lshlrev_b32 v170, 16, v106
    v_and_b32 v171, 0xffff0000, v106
    v_add_f32 v152, v152, v170
    v_add_f32 v153, v153, v171
    v_lshlrev_b32 v170, 16, v107
    v_and_b32 v171, 0xffff0000, v107
    v_add_f32 v154, v154, v170
    v_add_f32 v155, v155, v171
    s_waitcnt vmcnt(0)
    v_lshlrev_b32 v170, 16, v108
    v_and_b32 v171, 0xffff0000, v108
    v_add_f32 v156, v156, v170
    v_add_f32 v157, v157, v171
    v_lshlrev_b32 v170, 16, v109
    v_and_b32 v171, 0xffff0000, v109
    v_add_f32 v158, v158, v170
    v_add_f32 v159, v159, v171
    v_lshlrev_b32 v170, 16, v110
    v_and_b32 v171, 0xffff0000, v110
    v_add_f32 v160, v160, v170
    v_add_f32 v161, v161, v171
    v_lshlrev_b32 v170, 16, v111
    v_and_b32 v171, 0xffff0000, v111
    v_add_f32 v162, v162, v170
    v_add_f32 v163, v163, v171
    v_cvt_pk_bf16_f32 v172, v148, v149
    v_cvt_pk_bf16_f32 v173, v150, v151
    ds_write_b64 v31, v[172:173]
    v_cvt_pk_bf16_f32 v174, v152, v153
    v_cvt_pk_bf16_f32 v175, v154, v155
    ds_write_b64 v32, v[174:175]
    v_cvt_pk_bf16_f32 v176, v156, v157
    v_cvt_pk_bf16_f32 v177, v158, v159
    ds_write_b64 v33, v[176:177]
    v_cvt_pk_bf16_f32 v178, v160, v161
    v_cvt_pk_bf16_f32 v179, v162, v163
    ds_write_b64 v34, v[178:179]
    s_waitcnt lgkmcnt(0)
    s_barrier
    v_lshlrev_b32 v180, 4, v0
    s_lshl_b32 s48, s28, 10
    v_add_u32 v180, s48, v180
    ds_read_b128 v[184:187], v180
    ds_read_b128 v[188:191], v180 offset:4096
    s_waitcnt lgkmcnt(1)
    buffer_store_dwordx4 v[184:187], v36, s[44:47], 0 offen
    s_waitcnt lgkmcnt(0)
    buffer_store_dwordx4 v[188:191], v37, s[44:47], 0 offen
L_END:
    s_endpgm
L_CODE_END:
.section .rodata,"a"
.p2align 6
.amdhsa_kernel standalone__mha_block_cached__near_ridge_kernel
  .amdhsa_next_free_vgpr 512
  .amdhsa_next_free_sgpr 102
  .amdhsa_accum_offset 256
  .amdhsa_group_segment_fixed_size 0
  .amdhsa_kernarg_size 64
  .amdhsa_user_sgpr_count 2
  .amdhsa_user_sgpr_kernarg_segment_ptr 1
  .amdhsa_system_sgpr_workgroup_id_x 1
  .amdhsa_float_denorm_mode_32 3
.end_amdhsa_kernel
```
